```python
import torch

def _softmax(x, axis=-1):
    return torch.softmax(x, dim=axis)
def _gelu(x):
    return torch.nn.functional.gelu(x, approximate="tanh")
def _silu(x):
    return torch.nn.functional.silu(x)
def _sigmoid(x):
    return torch.sigmoid(x)
def _layernorm(x, axis=-1, eps=1e-5):
    m = x.mean(dim=axis, keepdim=True)
    v = x.var(dim=axis, keepdim=True, unbiased=False)
    return (x - m) / torch.sqrt(v + eps)
def _scatter_add(tgt, idx, src, axis=0):
    return tgt.clone().index_add_(axis, idx, src)
def _segment_sum(src, seg, n):
    out = torch.zeros((n,) + src.shape[1:], dtype=src.dtype)
    return out.index_add_(0, seg, src)
def _pad(x, pw):
    flat = tuple(v for pair in reversed(pw) for v in pair)
    return torch.nn.functional.pad(x, flat)

kernel_name = 'interleave_layers__linear_attn_block__glu_gated_geglu__prompt'

def setup_inputs():

    _w = (lambda a: (lambda t: t.to(torch.bfloat16) if t.is_floating_point() else t)(torch.as_tensor(a)))
    def _A_setup():
        B, S, D = 1, 2048, 512
        return {
            "x": _w((lambda *s: torch.randn(*s, dtype=torch.bfloat16) * 0.05)(B, S, D)),
            "wqkv": _w((lambda *s: torch.randn(*s, dtype=torch.bfloat16) * 0.05)(D, 3 * D)),
            "wo": _w((lambda *s: torch.randn(*s, dtype=torch.bfloat16) * 0.05)(D, D)),
        }
    _A_in = _A_setup()

    def _B_setup():
        B, S, Dm, Df = 1, 2048, 512, 1792
        return {
            "x": _w((lambda *s: torch.randn(*s, dtype=torch.bfloat16) * 0.05)(B, S, Dm)),
            "w_gate": _w((lambda *s: torch.randn(*s, dtype=torch.bfloat16) * 0.8)(Dm, Df) * (Dm ** -0.5)),
            "w_up": _w((lambda *s: torch.randn(*s, dtype=torch.bfloat16) * 0.8)(Dm, Df) * (Dm ** -0.5)),
            "w_down": _w((lambda *s: torch.randn(*s, dtype=torch.bfloat16) * 0.8)(Df, Dm) * (Df ** -0.5)),
        }
    _B_in = _B_setup()

    return {
        "A_x": _A_in["x"],
        "A_wqkv": _A_in["wqkv"],
        "A_wo": _A_in["wo"],
        "B_x": _B_in["x"],
        "B_w_gate": _B_in["w_gate"],
        "B_w_up": _B_in["w_up"],
        "B_w_down": _B_in["w_down"],
    }

def reference(A_x, A_wqkv, A_wo, B_x, B_w_gate, B_w_up, B_w_down):
    def _A_ref(x, wqkv, wo):
        B, S, D = x.shape
        H = 32; Dh = D // H
        qkv = (lambda x, *d: x.permute(*d))((x @ wqkv).reshape(B, S, 3, H, Dh), 2, 0, 3, 1, 4)
        q, k, v = qkv[0], qkv[1], qkv[2]
        phi = lambda t: torch.where(t > 0, t + 1, torch.exp(t)) + 1e-6
        pq, pk = phi(q), phi(k)
        kv = torch.einsum("bhsd,bhse->bhde", pk, v)
        z = torch.einsum("bhsd->bhd", pk)
        num = torch.einsum("bhqd,bhde->bhqe", pq, kv)
        den = torch.einsum("bhqd,bhd->bhq", pq, z)[..., None] + 1e-6
        o = num / den
        return (lambda x, *d: x.permute(*d))(o, 0, 2, 1, 3).reshape(B, S, D) @ wo

    def _B_ref(x, w_gate, w_up, w_down):
        g = torch.einsum("bsd,df->bsf", x, w_gate)
        u = torch.einsum("bsd,df->bsf", x, w_up)
        h = _gelu(g) * u
        return torch.einsum("bsf,fd->bsd", h, w_down)

    x = A_x
    x = x + _A_ref(_layernorm(x, axis=-1), A_wqkv, A_wo)
    x = x + _B_ref(_layernorm(x, axis=-1), B_w_gate, B_w_up, B_w_down)
    x = x + _A_ref(_layernorm(x, axis=-1), A_wqkv, A_wo)
    x = x + _B_ref(_layernorm(x, axis=-1), B_w_gate, B_w_up, B_w_down)
    return x
```

```asm
; @launch kernel=f1_kernel grid=(256,1,1) block=(512,1,1) lds=139264
; @launch kernel=fk_kernel grid=(256,1,1) block=(512,1,1) lds=163840
.amdgcn_target "amdgcn-amd-amdhsa--gfx950"
.text
.globl f1_kernel
.p2align 8
.type f1_kernel,@function
f1_kernel:
    s_cmp_ge_u32 s2, 256
    s_cbranch_scc1 F1_done
    s_load_dwordx16 s[16:31], s[0:1], 0
    s_load_dwordx4 s[32:35], s[0:1], 64
    s_mov_b32 s44, 1
    v_lshlrev_b32 v4, 4, v0
    s_lshl_b32 s40, s2, 13
    s_mov_b32 s14, 2097152
    s_mov_b32 s15, 0x20000
    s_mov_b32 s38, 1572864
    s_mov_b32 s39, 0x20000
    v_lshrrev_b32 v1, 6, v0
    v_and_b32 v2, 63, v0
    s_waitcnt lgkmcnt(0)
    s_mov_b32 s12, s16
    s_mov_b32 s13, s17
    s_mov_b32 s36, s18
    s_mov_b32 s37, s19
    buffer_load_dwordx4 v[252:255], v4, s[36:39], s40 offen
    buffer_load_dwordx4 v[252:255], v4, s[12:15], s40 offen
    v_readfirstlane_b32 s3, v1
    v_lshlrev_b32 v3, 4, v2
    s_and_b32 s4, s3, 3
    s_and_b32 s5, s2, 7
    s_lshr_b32 s6, s2, 3
    s_mul_i32 s7, s6, 10923
    s_lshr_b32 s7, s7, 16
    s_mul_i32 s40, s7, 6
    s_sub_u32 s6, s6, s40
    s_lshr_b32 s40, s5, 1
    s_lshl_b32 s40, s40, 2
    s_add_u32 s7, s7, s40
    s_and_b32 s5, s5, 1
    s_mul_i32 s5, s5, 6
    s_add_u32 s6, s6, s5
    s_lshl_b32 s40, s7, 2
    s_add_u32 s40, s40, s4
    s_lshl_b32 s41, s40, 15
    s_waitcnt lgkmcnt(0)
    s_mov_b32 s8, s34
    s_mov_b32 s9, s35
    s_mov_b32 s10, 0x2200000
    s_mov_b32 s11, 0x20000
    s_mov_b32 s52, s32
    s_mov_b32 s53, s33
    s_mov_b32 s54, 256
    s_mov_b32 s55, 0x20000
    s_mov_b32 s15, 0x20000
    s_mov_b32 s39, 0x20000
    s_cmp_ge_u32 s2, 192
    s_cbranch_scc1 F1_pack
    s_mov_b32 s12, s16
    s_mov_b32 s13, s17
    s_mov_b32 s14, 2097152
    s_mov_b32 s36, s18
    s_mov_b32 s37, s19
    s_mov_b32 s38, 1572864
    s_cmp_lt_u32 s3, 4
    s_cbranch_scc1 F1_comp
    v_lshrrev_b32 v4, 3, v2
    v_lshlrev_b32 v4, 10, v4
    v_lshrrev_b32 v5, 4, v2
    v_and_b32 v6, 7, v2
    v_xor_b32 v7, v6, v5
    v_lshlrev_b32 v7, 4, v7
    v_add_u32 v8, v4, v7
    v_xor_b32 v7, 64, v7
    v_add_u32 v9, v4, v7
    v_and_b32 v6, 15, v2
    v_lshlrev_b32 v7, 2, v5
    v_xor_b32 v6, v6, v7
    s_lshl_b32 s43, s6, 8
    s_lshl_b32 s45, s6, 7
    s_add_u32 s45, s45, 512
    s_cmp_lt_u32 s6, 4
    s_cselect_b32 s42, 7, 10
    s_cselect_b32 s43, s43, s45
    v_lshrrev_b32 v7, 3, v6
    v_lshlrev_b32 v7, s42, v7
    v_and_b32 v6, 7, v6
    v_lshlrev_b32 v6, 4, v6
    v_add_u32 v6, v6, v7
    v_mul_u32_u24 v5, 3072, v5
    v_add_u32 v10, v5, v6
    s_mul_i32 s45, s4, 49152
    s_add_u32 s43, s43, s45
    s_lshl_b32 s46, s4, 12
    s_add_u32 s47, s46, 16384
    s_mov_b32 m0, s47
    s_add_u32 s48, s43, 0
    buffer_load_dwordx4 v10, s[36:39], s48 offen lds
    s_add_u32 s47, s46, 17408
    s_mov_b32 m0, s47
    s_add_u32 s48, s43, 12288
    buffer_load_dwordx4 v10, s[36:39], s48 offen lds
    s_add_u32 s47, s46, 18432
    s_mov_b32 m0, s47
    s_add_u32 s48, s43, 24576
    buffer_load_dwordx4 v10, s[36:39], s48 offen lds
    s_add_u32 s47, s46, 19456
    s_mov_b32 m0, s47
    s_add_u32 s48, s43, 36864
    buffer_load_dwordx4 v10, s[36:39], s48 offen lds
    s_add_u32 s47, s46, 0
    s_mov_b32 m0, s47
    s_add_u32 s48, s41, 0
    buffer_load_dwordx4 v8, s[12:15], s48 offen lds
    s_add_u32 s47, s46, 1024
    s_mov_b32 m0, s47
    s_add_u32 s48, s41, 8192
    buffer_load_dwordx4 v9, s[12:15], s48 offen lds
    s_add_u32 s47, s46, 2048
    s_mov_b32 m0, s47
    s_add_u32 s48, s41, 16384
    buffer_load_dwordx4 v8, s[12:15], s48 offen lds
    s_add_u32 s47, s46, 3072
    s_mov_b32 m0, s47
    s_add_u32 s48, s41, 24576
    buffer_load_dwordx4 v9, s[12:15], s48 offen lds
    s_lshl_b32 s5, s7, 2
    s_add_u32 s5, s5, s6
    s_lshl_b32 s40, s7, 3
    s_add_u32 s40, s40, s6
    s_add_u32 s40, s40, 60
    s_cmp_lt_u32 s6, 4
    s_cselect_b32 s5, s5, s40
    s_lshl_b32 s5, s5, 2
    s_add_u32 s5, s5, s4
    s_mov_b32 s63, 0x20000
    s_mov_b32 s60, s18
    s_mov_b32 s61, s19
    s_mov_b32 s62, 1572864
    s_mul_i32 s40, s5, 2731
    s_lshr_b32 s40, s40, 16
    s_mul_i32 s49, s40, 24
    s_sub_u32 s49, s5, s49
    s_mul_i32 s50, s40, 196608
    s_lshl_b32 s51, s49, 7
    s_add_u32 s50, s50, s51
    s_lshl_b32 s51, s49, 1
    s_and_b32 s51, s51, 15
    s_mul_i32 s51, s51, 102400
    s_lshr_b32 s42, s49, 3
    s_add_u32 s42, s42, 2
    s_cmp_ge_u32 s42, 3
    s_cselect_b32 s45, 3, 0
    s_sub_u32 s42, s42, s45
    s_mul_i32 s40, s40, 12
    s_add_u32 s40, s40, s42
    s_lshl_b32 s40, s40, 10
    s_add_u32 s51, s51, s40
    s_mov_b32 s56, 3072
    s_mov_b32 s57, 102400
    s_mov_b32 s58, 3072
    s_lshl_b32 s59, s58, 3
    v_lshrrev_b32 v52, 3, v2
    v_mul_lo_u32 v52, v52, s58
    v_and_b32 v5, 7, v2
    v_lshlrev_b32 v5, 4, v5
    v_add_u32 v52, v52, v5
    s_lshl_b32 s49, s4, 13
    v_lshrrev_b32 v5, 5, v2
    v_lshlrev_b32 v5, 2, v5
    v_bfe_u32 v6, v2, 2, 2
    v_add_u32 v5, v5, v6
    v_lshlrev_b32 v5, 7, v5
    v_bfe_u32 v6, v2, 4, 1
    v_lshlrev_b32 v6, 5, v6
    v_add_u32 v5, v5, v6
    v_and_b32 v6, 3, v2
    v_lshlrev_b32 v6, 3, v6
    v_add_u32 v5, v5, v6
    v_add_u32 v53, s49, v5
    s_add_u32 s47, s46, 49152
    s_mov_b32 m0, s47
    s_add_u32 s48, s43, 196608
    buffer_load_dwordx4 v10, s[36:39], s48 offen lds
    s_add_u32 s47, s46, 50176
    s_mov_b32 m0, s47
    s_add_u32 s48, s43, 208896
    buffer_load_dwordx4 v10, s[36:39], s48 offen lds
    s_add_u32 s47, s46, 51200
    s_mov_b32 m0, s47
    s_add_u32 s48, s43, 221184
    buffer_load_dwordx4 v10, s[36:39], s48 offen lds
    s_add_u32 s47, s46, 52224
    s_mov_b32 m0, s47
    s_add_u32 s48, s43, 233472
    buffer_load_dwordx4 v10, s[36:39], s48 offen lds
    s_add_u32 s47, s46, 32768
    s_mov_b32 m0, s47
    s_add_u32 s48, s41, 128
    buffer_load_dwordx4 v8, s[12:15], s48 offen lds
    s_add_u32 s47, s46, 33792
    s_mov_b32 m0, s47
    s_add_u32 s48, s41, 8320
    buffer_load_dwordx4 v9, s[12:15], s48 offen lds
    s_add_u32 s47, s46, 34816
    s_mov_b32 m0, s47
    s_add_u32 s48, s41, 16512
    buffer_load_dwordx4 v8, s[12:15], s48 offen lds
    s_add_u32 s47, s46, 35840
    s_mov_b32 m0, s47
    s_add_u32 s48, s41, 24704
    buffer_load_dwordx4 v9, s[12:15], s48 offen lds
    s_waitcnt vmcnt(8)
    s_barrier
    s_add_u32 s47, s46, 81920
    s_mov_b32 m0, s47
    s_add_u32 s48, s43, 393216
    buffer_load_dwordx4 v10, s[36:39], s48 offen lds
    s_add_u32 s47, s46, 82944
    s_mov_b32 m0, s47
    s_add_u32 s48, s43, 405504
    buffer_load_dwordx4 v10, s[36:39], s48 offen lds
    s_add_u32 s47, s46, 83968
    s_mov_b32 m0, s47
    s_add_u32 s48, s43, 417792
    buffer_load_dwordx4 v10, s[36:39], s48 offen lds
    s_add_u32 s47, s46, 84992
    s_mov_b32 m0, s47
    s_add_u32 s48, s43, 430080
    buffer_load_dwordx4 v10, s[36:39], s48 offen lds
    s_add_u32 s47, s46, 65536
    s_mov_b32 m0, s47
    s_add_u32 s48, s41, 256
    buffer_load_dwordx4 v8, s[12:15], s48 offen lds
    s_add_u32 s47, s46, 66560
    s_mov_b32 m0, s47
    s_add_u32 s48, s41, 8448
    buffer_load_dwordx4 v9, s[12:15], s48 offen lds
    s_add_u32 s47, s46, 67584
    s_mov_b32 m0, s47
    s_add_u32 s48, s41, 16640
    buffer_load_dwordx4 v8, s[12:15], s48 offen lds
    s_add_u32 s47, s46, 68608
    s_mov_b32 m0, s47
    s_add_u32 s48, s41, 24832
    buffer_load_dwordx4 v9, s[12:15], s48 offen lds
    s_add_u32 s47, s46, 114688
    s_mov_b32 m0, s47
    s_add_u32 s48, s43, 589824
    buffer_load_dwordx4 v10, s[36:39], s48 offen lds
    s_add_u32 s47, s46, 115712
    s_mov_b32 m0, s47
    s_add_u32 s48, s43, 602112
    buffer_load_dwordx4 v10, s[36:39], s48 offen lds
    s_add_u32 s47, s46, 116736
    s_mov_b32 m0, s47
    s_add_u32 s48, s43, 614400
    buffer_load_dwordx4 v10, s[36:39], s48 offen lds
    s_add_u32 s47, s46, 117760
    s_mov_b32 m0, s47
    s_add_u32 s48, s43, 626688
    buffer_load_dwordx4 v10, s[36:39], s48 offen lds
    s_add_u32 s47, s46, 98304
    s_mov_b32 m0, s47
    s_add_u32 s48, s41, 384
    buffer_load_dwordx4 v8, s[12:15], s48 offen lds
    s_add_u32 s47, s46, 99328
    s_mov_b32 m0, s47
    s_add_u32 s48, s41, 8576
    buffer_load_dwordx4 v9, s[12:15], s48 offen lds
    s_add_u32 s47, s46, 100352
    s_mov_b32 m0, s47
    s_add_u32 s48, s41, 16768
    buffer_load_dwordx4 v8, s[12:15], s48 offen lds
    s_add_u32 s47, s46, 101376
    s_mov_b32 m0, s47
    s_add_u32 s48, s41, 24960
    buffer_load_dwordx4 v9, s[12:15], s48 offen lds
    s_waitcnt vmcnt(16)
    s_barrier
    s_add_u32 s47, s46, 16384
    s_mov_b32 m0, s47
    s_add_u32 s48, s43, 786432
    buffer_load_dwordx4 v10, s[36:39], s48 offen lds
    s_add_u32 s47, s46, 17408
    s_mov_b32 m0, s47
    s_add_u32 s48, s43, 798720
    buffer_load_dwordx4 v10, s[36:39], s48 offen lds
    s_add_u32 s47, s46, 18432
    s_mov_b32 m0, s47
    s_add_u32 s48, s43, 811008
    buffer_load_dwordx4 v10, s[36:39], s48 offen lds
    s_add_u32 s47, s46, 19456
    s_mov_b32 m0, s47
    s_add_u32 s48, s43, 823296
    buffer_load_dwordx4 v10, s[36:39], s48 offen lds
    s_add_u32 s47, s46, 0
    s_mov_b32 m0, s47
    s_add_u32 s48, s41, 512
    buffer_load_dwordx4 v8, s[12:15], s48 offen lds
    s_add_u32 s47, s46, 1024
    s_mov_b32 m0, s47
    s_add_u32 s48, s41, 8704
    buffer_load_dwordx4 v9, s[12:15], s48 offen lds
    s_add_u32 s47, s46, 2048
    s_mov_b32 m0, s47
    s_add_u32 s48, s41, 16896
    buffer_load_dwordx4 v8, s[12:15], s48 offen lds
    s_add_u32 s47, s46, 3072
    s_mov_b32 m0, s47
    s_add_u32 s48, s41, 25088
    buffer_load_dwordx4 v9, s[12:15], s48 offen lds
    s_cmp_ge_u32 s5, 192
    s_cbranch_scc1 F1_sl
    buffer_load_dwordx4 v[96:99], v52, s[60:63], s50 offen
    s_add_u32 s50, s50, s59
    buffer_load_dwordx4 v[100:103], v52, s[60:63], s50 offen
    s_add_u32 s50, s50, s59
    buffer_load_dwordx4 v[104:107], v52, s[60:63], s50 offen
    s_add_u32 s50, s50, s59
    buffer_load_dwordx4 v[108:111], v52, s[60:63], s50 offen
    s_add_u32 s50, s50, s59
    buffer_load_dwordx4 v[112:115], v52, s[60:63], s50 offen
    s_add_u32 s50, s50, s59
    buffer_load_dwordx4 v[116:119], v52, s[60:63], s50 offen
    s_add_u32 s50, s50, s59
    buffer_load_dwordx4 v[120:123], v52, s[60:63], s50 offen
    s_add_u32 s50, s50, s59
    buffer_load_dwordx4 v[124:127], v52, s[60:63], s50 offen
    s_add_u32 s50, s50, s59
    s_branch F1_sl2
F1_sl:
    s_sub_u32 s47, s5, 192
    s_lshl_b32 s47, s47, 12
    s_add_u32 s47, s47, 10485760
    s_add_u32 s48, s47, 4096
    v_mov_b32 v56, 0
    v_mov_b32 v57, 0
    v_mov_b32 v58, 0
    v_mov_b32 v59, 0
    buffer_store_dwordx4 v[56:59], v3, s[8:11], s47 offen offset:0 sc0 sc1
    buffer_store_dwordx4 v[56:59], v3, s[8:11], s47 offen offset:1024 sc0 sc1
    buffer_store_dwordx4 v[56:59], v3, s[8:11], s47 offen offset:2048 sc0 sc1
    buffer_store_dwordx4 v[56:59], v3, s[8:11], s47 offen offset:3072 sc0 sc1
F1_sl2:
    s_waitcnt vmcnt(20)
    s_barrier
    s_add_u32 s47, s46, 49152
    s_mov_b32 m0, s47
    s_add_u32 s48, s43, 983040
    buffer_load_dwordx4 v10, s[36:39], s48 offen lds
    s_add_u32 s47, s46, 50176
    s_mov_b32 m0, s47
    s_add_u32 s48, s43, 995328
    buffer_load_dwordx4 v10, s[36:39], s48 offen lds
    s_add_u32 s47, s46, 51200
    s_mov_b32 m0, s47
    s_add_u32 s48, s43, 1007616
    buffer_load_dwordx4 v10, s[36:39], s48 offen lds
    s_add_u32 s47, s46, 52224
    s_mov_b32 m0, s47
    s_add_u32 s48, s43, 1019904
    buffer_load_dwordx4 v10, s[36:39], s48 offen lds
    s_add_u32 s47, s46, 32768
    s_mov_b32 m0, s47
    s_add_u32 s48, s41, 640
    buffer_load_dwordx4 v8, s[12:15], s48 offen lds
    s_add_u32 s47, s46, 33792
    s_mov_b32 m0, s47
    s_add_u32 s48, s41, 8832
    buffer_load_dwordx4 v9, s[12:15], s48 offen lds
    s_add_u32 s47, s46, 34816
    s_mov_b32 m0, s47
    s_add_u32 s48, s41, 17024
    buffer_load_dwordx4 v8, s[12:15], s48 offen lds
    s_add_u32 s47, s46, 35840
    s_mov_b32 m0, s47
    s_add_u32 s48, s41, 25216
    buffer_load_dwordx4 v9, s[12:15], s48 offen lds
    s_waitcnt vmcnt(20)
    s_barrier
    s_add_u32 s47, s46, 81920
    s_mov_b32 m0, s47
    s_add_u32 s48, s43, 1179648
    buffer_load_dwordx4 v10, s[36:39], s48 offen lds
    s_add_u32 s47, s46, 82944
    s_mov_b32 m0, s47
    s_add_u32 s48, s43, 1191936
    buffer_load_dwordx4 v10, s[36:39], s48 offen lds
    s_add_u32 s47, s46, 83968
    s_mov_b32 m0, s47
    s_add_u32 s48, s43, 1204224
    buffer_load_dwordx4 v10, s[36:39], s48 offen lds
    s_add_u32 s47, s46, 84992
    s_mov_b32 m0, s47
    s_add_u32 s48, s43, 1216512
    buffer_load_dwordx4 v10, s[36:39], s48 offen lds
    s_add_u32 s47, s46, 65536
    s_mov_b32 m0, s47
    s_add_u32 s48, s41, 768
    buffer_load_dwordx4 v8, s[12:15], s48 offen lds
    s_add_u32 s47, s46, 66560
    s_mov_b32 m0, s47
    s_add_u32 s48, s41, 8960
    buffer_load_dwordx4 v9, s[12:15], s48 offen lds
    s_add_u32 s47, s46, 67584
    s_mov_b32 m0, s47
    s_add_u32 s48, s41, 17152
    buffer_load_dwordx4 v8, s[12:15], s48 offen lds
    s_add_u32 s47, s46, 68608
    s_mov_b32 m0, s47
    s_add_u32 s48, s41, 25344
    buffer_load_dwordx4 v9, s[12:15], s48 offen lds
    s_waitcnt vmcnt(20)
    s_barrier
    s_add_u32 s47, s46, 114688
    s_mov_b32 m0, s47
    s_add_u32 s48, s43, 1376256
    buffer_load_dwordx4 v10, s[36:39], s48 offen lds
    s_add_u32 s47, s46, 115712
    s_mov_b32 m0, s47
    s_add_u32 s48, s43, 1388544
    buffer_load_dwordx4 v10, s[36:39], s48 offen lds
    s_add_u32 s47, s46, 116736
    s_mov_b32 m0, s47
    s_add_u32 s48, s43, 1400832
    buffer_load_dwordx4 v10, s[36:39], s48 offen lds
    s_add_u32 s47, s46, 117760
    s_mov_b32 m0, s47
    s_add_u32 s48, s43, 1413120
    buffer_load_dwordx4 v10, s[36:39], s48 offen lds
    s_add_u32 s47, s46, 98304
    s_mov_b32 m0, s47
    s_add_u32 s48, s41, 896
    buffer_load_dwordx4 v8, s[12:15], s48 offen lds
    s_add_u32 s47, s46, 99328
    s_mov_b32 m0, s47
    s_add_u32 s48, s41, 9088
    buffer_load_dwordx4 v9, s[12:15], s48 offen lds
    s_add_u32 s47, s46, 100352
    s_mov_b32 m0, s47
    s_add_u32 s48, s41, 17280
    buffer_load_dwordx4 v8, s[12:15], s48 offen lds
    s_add_u32 s47, s46, 101376
    s_mov_b32 m0, s47
    s_add_u32 s48, s41, 25472
    buffer_load_dwordx4 v9, s[12:15], s48 offen lds
    s_waitcnt vmcnt(16)
    s_barrier
    s_cmp_ge_u32 s5, 192
    s_cbranch_scc1 F1_sw
    v_add_u32 v54, s49, v3
    ds_write_b128 v54, v[96:99] offset:0
    ds_write_b128 v54, v[100:103] offset:1024
    ds_write_b128 v54, v[104:107] offset:2048
    ds_write_b128 v54, v[108:111] offset:3072
    ds_write_b128 v54, v[112:115] offset:4096
    ds_write_b128 v54, v[116:119] offset:5120
    ds_write_b128 v54, v[120:123] offset:6144
    ds_write_b128 v54, v[124:127] offset:7168
    s_waitcnt lgkmcnt(0)
    ds_read_b64_tr_b16 v[64:65], v53 offset:0
    ds_read_b64_tr_b16 v[66:67], v53 offset:1024
    ds_read_b64_tr_b16 v[68:69], v53 offset:64
    ds_read_b64_tr_b16 v[70:71], v53 offset:1088
    ds_read_b64_tr_b16 v[72:73], v53 offset:2048
    ds_read_b64_tr_b16 v[74:75], v53 offset:3072
    ds_read_b64_tr_b16 v[76:77], v53 offset:2112
    ds_read_b64_tr_b16 v[78:79], v53 offset:3136
    ds_read_b64_tr_b16 v[80:81], v53 offset:4096
    ds_read_b64_tr_b16 v[82:83], v53 offset:5120
    ds_read_b64_tr_b16 v[84:85], v53 offset:4160
    ds_read_b64_tr_b16 v[86:87], v53 offset:5184
    ds_read_b64_tr_b16 v[88:89], v53 offset:6144
    ds_read_b64_tr_b16 v[90:91], v53 offset:7168
    ds_read_b64_tr_b16 v[92:93], v53 offset:6208
    ds_read_b64_tr_b16 v[94:95], v53 offset:7232
    s_waitcnt lgkmcnt(0)
F1_sw:
    s_waitcnt vmcnt(8)
    s_barrier
    s_waitcnt vmcnt(0)
    s_barrier
    s_barrier
    s_cmp_ge_u32 s5, 192
    s_cbranch_scc1 F1_lend
    s_add_u32 s47, s51, s57
    buffer_store_dwordx4 v[64:67], v3, s[8:11], s51 offen sc0 sc1
    buffer_store_dwordx4 v[68:71], v3, s[8:11], s47 offen sc0 sc1
    s_add_u32 s51, s51, s56
    s_add_u32 s47, s51, s57
    buffer_store_dwordx4 v[72:75], v3, s[8:11], s51 offen sc0 sc1
    buffer_store_dwordx4 v[76:79], v3, s[8:11], s47 offen sc0 sc1
    s_add_u32 s51, s51, s56
    s_add_u32 s47, s51, s57
    buffer_store_dwordx4 v[80:83], v3, s[8:11], s51 offen sc0 sc1
    buffer_store_dwordx4 v[84:87], v3, s[8:11], s47 offen sc0 sc1
    s_add_u32 s51, s51, s56
    s_add_u32 s47, s51, s57
    buffer_store_dwordx4 v[88:91], v3, s[8:11], s51 offen sc0 sc1
    buffer_store_dwordx4 v[92:95], v3, s[8:11], s47 offen sc0 sc1
    s_add_u32 s51, s51, s56
F1_lend:
    s_barrier
    s_cmp_lg_u32 s4, 0
    s_cbranch_scc1 F1_zok
    s_cmp_lt_u32 s6, 4
    s_cbranch_scc1 F1_zok
    v_mov_b32 v14, 0
    s_mov_b32 s45, 0
F1_zw:
    buffer_load_dword v15, v14, s[52:55], 0 offen sc1
    s_waitcnt vmcnt(0)
    v_readfirstlane_b32 s42, v15
    s_cmp_ge_u32 s42, 2
    s_cbranch_scc1 F1_zok
    s_add_u32 s45, s45, 1
    s_cmp_gt_u32 s45, 0x40000
    s_cbranch_scc1 F1_zok
    s_sleep 8
    s_branch F1_zw
F1_zok:
    s_endpgm
F1_comp:
    v_lshlrev_b32 v1, 3, v2
    s_lshl_b32 s47, s2, 2
    s_add_u32 s47, s47, s4
    s_mul_i32 s48, s47, 3072
    s_lshl_b32 s49, s47, 11
    s_getpc_b64 s[56:57]
F1_pc:
    s_sub_u32 s56, s56, F1_pc-f1_kernel
    s_subb_u32 s57, s57, 0
    s_mov_b32 s58, CODE_END-f1_kernel
    s_mov_b32 s59, 0x20000
    s_lshr_b32 s50, s2, 3
    s_lshl_b32 s50, s50, 2
    s_add_u32 s50, s50, s4
    s_lshl_b32 s50, s50, 10
    buffer_load_dwordx4 v[252:255], v3, s[56:59], s50 offen
    v_and_b32 v4, 31, v2
    v_lshrrev_b32 v5, 5, v2
    v_bfe_u32 v6, v2, 1, 3
    v_xor_b32 v6, v6, v5
    v_lshlrev_b32 v4, 7, v4
    s_lshl_b32 s46, s4, 12
    v_add_u32 v4, s46, v4
    s_and_b32 s45, s4, 2
    s_lshl_b32 s45, s45, 1
    v_xor_b32 v6, s45, v6
    v_xor_b32 v7, 0, v6
    v_lshlrev_b32 v7, 4, v7
    v_add_u32 v48, v4, v7
    v_xor_b32 v7, 2, v6
    v_lshlrev_b32 v7, 4, v7
    v_add_u32 v49, v4, v7
    v_xor_b32 v7, 4, v6
    v_lshlrev_b32 v7, 4, v7
    v_add_u32 v50, v4, v7
    v_xor_b32 v7, 6, v6
    v_lshlrev_b32 v7, 4, v7
    v_add_u32 v51, v4, v7
    v_bfe_u32 v6, v2, 2, 2
    v_lshlrev_b32 v4, 3, v5
    v_add_u32 v4, v4, v6
    v_lshlrev_b32 v4, 8, v4
    v_bfe_u32 v7, v2, 4, 1
    v_lshlrev_b32 v7, 5, v7
    v_add_u32 v4, v4, v7
    v_and_b32 v7, 3, v2
    v_lshlrev_b32 v7, 3, v7
    v_add_u32 v4, v4, v7
    v_add_u32 v4, 16384, v4
    s_and_b32 s45, s4, 1
    v_xor_b32 v6, s45, v6
    s_and_b32 s45, s4, 2
    s_lshl_b32 s45, s45, 12
    s_xor_b32 s51, s45, 8192
    v_xor_b32 v7, 0, v6
    v_lshlrev_b32 v7, 6, v7
    v_add_u32 v7, v4, v7
    v_add_u32 v52, s45, v7
    v_add_u32 v8, s51, v7
    v_xor_b32 v7, 1, v6
    v_lshlrev_b32 v7, 6, v7
    v_add_u32 v7, v4, v7
    v_add_u32 v53, s45, v7
    v_add_u32 v9, s51, v7
    v_xor_b32 v7, 2, v6
    v_lshlrev_b32 v7, 6, v7
    v_add_u32 v7, v4, v7
    v_add_u32 v54, s45, v7
    v_add_u32 v10, s51, v7
    v_xor_b32 v7, 3, v6
    v_lshlrev_b32 v7, 6, v7
    v_add_u32 v7, v4, v7
    v_add_u32 v55, s45, v7
    v_add_u32 v11, s51, v7
    v_mov_b32 v64, 0
    v_mov_b32 v65, 0
    v_mov_b32 v66, 0
    v_mov_b32 v67, 0
    v_mov_b32 v68, 0
    v_mov_b32 v69, 0
    v_mov_b32 v70, 0
    v_mov_b32 v71, 0
    v_mov_b32 v72, 0
    v_mov_b32 v73, 0
    v_mov_b32 v74, 0
    v_mov_b32 v75, 0
    v_mov_b32 v76, 0
    v_mov_b32 v77, 0
    v_mov_b32 v78, 0
    v_mov_b32 v79, 0
    v_mov_b32 v80, 0
    v_mov_b32 v81, 0
    v_mov_b32 v82, 0
    v_mov_b32 v83, 0
    v_mov_b32 v84, 0
    v_mov_b32 v85, 0
    v_mov_b32 v86, 0
    v_mov_b32 v87, 0
    v_mov_b32 v88, 0
    v_mov_b32 v89, 0
    v_mov_b32 v90, 0
    v_mov_b32 v91, 0
    v_mov_b32 v92, 0
    v_mov_b32 v93, 0
    v_mov_b32 v94, 0
    v_mov_b32 v95, 0
    v_mov_b32 v96, 0
    v_mov_b32 v97, 0
    v_mov_b32 v98, 0
    v_mov_b32 v99, 0
    v_mov_b32 v100, 0
    v_mov_b32 v101, 0
    v_mov_b32 v102, 0
    v_mov_b32 v103, 0
    v_mov_b32 v104, 0
    v_mov_b32 v105, 0
    v_mov_b32 v106, 0
    v_mov_b32 v107, 0
    v_mov_b32 v108, 0
    v_mov_b32 v109, 0
    v_mov_b32 v110, 0
    v_mov_b32 v111, 0
    v_mov_b32 v112, 0
    v_mov_b32 v113, 0
    v_mov_b32 v114, 0
    v_mov_b32 v115, 0
    v_mov_b32 v116, 0
    v_mov_b32 v117, 0
    v_mov_b32 v118, 0
    v_mov_b32 v119, 0
    v_mov_b32 v120, 0
    v_mov_b32 v121, 0
    v_mov_b32 v122, 0
    v_mov_b32 v123, 0
    v_mov_b32 v124, 0
    v_mov_b32 v125, 0
    v_mov_b32 v126, 0
    v_mov_b32 v127, 0
    v_mov_b32 v56, 0
    v_mov_b32 v57, 0
    v_mov_b32 v58, 0
    v_mov_b32 v59, 0
    v_mov_b32 v60, 0
    v_mov_b32 v61, 0
    v_mov_b32 v62, 0
    v_mov_b32 v63, 0
    v_mov_b32 v14, 0x3f803f80
    s_mov_b32 s50, 0
    s_cmp_lt_u32 s6, 4
    s_cbranch_scc1 F1_preT
F1_preN:
    s_waitcnt vmcnt(0)
    s_barrier
    ds_read_b128 v[16:19], v48 offset:0
    ds_read_b128 v[20:23], v49 offset:0
    ds_read_b128 v[24:27], v50 offset:0
    ds_read_b128 v[28:31], v51 offset:0
    ds_read_b64_tr_b16 v[128:129], v52 offset:0
    ds_read_b64_tr_b16 v[130:131], v52 offset:1024
    ds_read_b64_tr_b16 v[136:137], v54 offset:0
    ds_read_b64_tr_b16 v[138:139], v54 offset:1024
    ds_read_b64_tr_b16 v[144:145], v52 offset:4096
    ds_read_b64_tr_b16 v[146:147], v52 offset:5120
    ds_read_b64_tr_b16 v[152:153], v54 offset:4096
    ds_read_b64_tr_b16 v[154:155], v54 offset:5120
    ds_read_b64_tr_b16 v[132:133], v53 offset:0
    ds_read_b64_tr_b16 v[134:135], v53 offset:1024
    ds_read_b64_tr_b16 v[140:141], v55 offset:0
    ds_read_b64_tr_b16 v[142:143], v55 offset:1024
    ds_read_b64_tr_b16 v[148:149], v53 offset:4096
    ds_read_b64_tr_b16 v[150:151], v53 offset:5120
    ds_read_b64_tr_b16 v[156:157], v55 offset:4096
    ds_read_b64_tr_b16 v[158:159], v55 offset:5120
    ds_read_b64_tr_b16 v[160:161], v8 offset:0
    ds_read_b64_tr_b16 v[162:163], v8 offset:1024
    ds_read_b64_tr_b16 v[164:165], v9 offset:0
    ds_read_b64_tr_b16 v[166:167], v9 offset:1024
    ds_read_b64_tr_b16 v[168:169], v10 offset:0
    ds_read_b64_tr_b16 v[170:171], v10 offset:1024
    ds_read_b64_tr_b16 v[172:173], v11 offset:0
    ds_read_b64_tr_b16 v[174:175], v11 offset:1024
    ds_read_b64_tr_b16 v[176:177], v8 offset:4096
    ds_read_b64_tr_b16 v[178:179], v8 offset:5120
    ds_read_b64_tr_b16 v[180:181], v9 offset:4096
    ds_read_b64_tr_b16 v[182:183], v9 offset:5120
    ds_read_b64_tr_b16 v[184:185], v10 offset:4096
    ds_read_b64_tr_b16 v[186:187], v10 offset:5120
    ds_read_b64_tr_b16 v[188:189], v11 offset:4096
    ds_read_b64_tr_b16 v[190:191], v11 offset:5120
F1_loopN:
    s_waitcnt lgkmcnt(0)
    v_dot2_f32_bf16 v60, v16, v14, v60
    v_dot2_f32_bf16 v61, v16, v16, v61
    v_dot2_f32_bf16 v62, v17, v14, v62
    v_dot2_f32_bf16 v63, v17, v17, v63
    v_dot2_f32_bf16 v60, v18, v14, v60
    v_dot2_f32_bf16 v61, v18, v18, v61
    v_dot2_f32_bf16 v62, v19, v14, v62
    v_dot2_f32_bf16 v63, v19, v19, v63
    v_dot2_f32_bf16 v60, v20, v14, v60
    v_dot2_f32_bf16 v61, v20, v20, v61
    v_dot2_f32_bf16 v62, v21, v14, v62
    v_dot2_f32_bf16 v63, v21, v21, v63
    v_dot2_f32_bf16 v60, v22, v14, v60
    v_dot2_f32_bf16 v61, v22, v22, v61
    v_dot2_f32_bf16 v62, v23, v14, v62
    v_dot2_f32_bf16 v63, v23, v23, v63
    v_dot2_f32_bf16 v60, v24, v14, v60
    v_dot2_f32_bf16 v61, v24, v24, v61
    v_dot2_f32_bf16 v62, v25, v14, v62
    v_dot2_f32_bf16 v63, v25, v25, v63
    v_dot2_f32_bf16 v60, v26, v14, v60
    v_dot2_f32_bf16 v61, v26, v26, v61
    v_dot2_f32_bf16 v62, v27, v14, v62
    v_dot2_f32_bf16 v63, v27, v27, v63
    v_dot2_f32_bf16 v60, v28, v14, v60
    v_dot2_f32_bf16 v61, v28, v28, v61
    v_dot2_f32_bf16 v62, v29, v14, v62
    v_dot2_f32_bf16 v63, v29, v29, v63
    v_dot2_f32_bf16 v60, v30, v14, v60
    v_dot2_f32_bf16 v61, v30, v30, v61
    v_dot2_f32_bf16 v62, v31, v14, v62
    v_dot2_f32_bf16 v63, v31, v31, v63
    v_dot2_f32_bf16 v56, v128, v14, v56
    v_dot2_f32_bf16 v58, v136, v14, v58
    v_dot2_f32_bf16 v56, v129, v14, v56
    v_dot2_f32_bf16 v58, v137, v14, v58
    v_dot2_f32_bf16 v56, v130, v14, v56
    v_dot2_f32_bf16 v58, v138, v14, v58
    v_dot2_f32_bf16 v56, v131, v14, v56
    v_dot2_f32_bf16 v58, v139, v14, v58
    v_dot2_f32_bf16 v56, v144, v14, v56
    v_dot2_f32_bf16 v58, v152, v14, v58
    v_dot2_f32_bf16 v56, v145, v14, v56
    v_dot2_f32_bf16 v58, v153, v14, v58
    v_dot2_f32_bf16 v56, v146, v14, v56
    v_dot2_f32_bf16 v58, v154, v14, v58
    v_dot2_f32_bf16 v56, v147, v14, v56
    v_dot2_f32_bf16 v58, v155, v14, v58
    s_barrier
    v_mfma_f32_32x32x16_bf16 v[64:79], v[16:19], v[128:131], v[64:79]
    ds_read_b128 v[32:35], v48 offset:32768
    ds_read_b128 v[36:39], v49 offset:32768
    ds_read_b128 v[40:43], v50 offset:32768
    v_mfma_f32_32x32x16_bf16 v[80:95], v[16:19], v[132:135], v[80:95]
    ds_read_b128 v[44:47], v51 offset:32768
    ds_read_b64_tr_b16 v[192:193], v52 offset:32768
    ds_read_b64_tr_b16 v[194:195], v52 offset:33792
    v_mfma_f32_32x32x16_bf16 v[96:111], v[16:19], v[136:139], v[96:111]
    ds_read_b64_tr_b16 v[200:201], v54 offset:32768
    ds_read_b64_tr_b16 v[202:203], v54 offset:33792
    ds_read_b64_tr_b16 v[208:209], v52 offset:36864
    v_mfma_f32_32x32x16_bf16 v[112:127], v[16:19], v[140:143], v[112:127]
    ds_read_b64_tr_b16 v[210:211], v52 offset:37888
    ds_read_b64_tr_b16 v[216:217], v54 offset:36864
    ds_read_b64_tr_b16 v[218:219], v54 offset:37888
    v_mfma_f32_32x32x16_bf16 v[64:79], v[20:23], v[144:147], v[64:79]
    ds_read_b64_tr_b16 v[196:197], v53 offset:32768
    ds_read_b64_tr_b16 v[198:199], v53 offset:33792
    ds_read_b64_tr_b16 v[204:205], v55 offset:32768
    v_mfma_f32_32x32x16_bf16 v[80:95], v[20:23], v[148:151], v[80:95]
    ds_read_b64_tr_b16 v[206:207], v55 offset:33792
    ds_read_b64_tr_b16 v[212:213], v53 offset:36864
    ds_read_b64_tr_b16 v[214:215], v53 offset:37888
    v_mfma_f32_32x32x16_bf16 v[96:111], v[20:23], v[152:155], v[96:111]
    ds_read_b64_tr_b16 v[220:221], v55 offset:36864
    ds_read_b64_tr_b16 v[222:223], v55 offset:37888
    ds_read_b64_tr_b16 v[224:225], v8 offset:32768
    v_mfma_f32_32x32x16_bf16 v[112:127], v[20:23], v[156:159], v[112:127]
    ds_read_b64_tr_b16 v[226:227], v8 offset:33792
    ds_read_b64_tr_b16 v[228:229], v9 offset:32768
    ds_read_b64_tr_b16 v[230:231], v9 offset:33792
    v_mfma_f32_32x32x16_bf16 v[64:79], v[24:27], v[160:163], v[64:79]
    ds_read_b64_tr_b16 v[232:233], v10 offset:32768
    ds_read_b64_tr_b16 v[234:235], v10 offset:33792
    ds_read_b64_tr_b16 v[236:237], v11 offset:32768
    v_mfma_f32_32x32x16_bf16 v[80:95], v[24:27], v[164:167], v[80:95]
    ds_read_b64_tr_b16 v[238:239], v11 offset:33792
    ds_read_b64_tr_b16 v[240:241], v8 offset:36864
    ds_read_b64_tr_b16 v[242:243], v8 offset:37888
    v_mfma_f32_32x32x16_bf16 v[96:111], v[24:27], v[168:171], v[96:111]
    ds_read_b64_tr_b16 v[244:245], v9 offset:36864
    ds_read_b64_tr_b16 v[246:247], v9 offset:37888
    ds_read_b64_tr_b16 v[248:249], v10 offset:36864
    v_mfma_f32_32x32x16_bf16 v[112:127], v[24:27], v[172:175], v[112:127]
    ds_read_b64_tr_b16 v[250:251], v10 offset:37888
    ds_read_b64_tr_b16 v[252:253], v11 offset:36864
    ds_read_b64_tr_b16 v[254:255], v11 offset:37888
    v_mfma_f32_32x32x16_bf16 v[64:79], v[28:31], v[176:179], v[64:79]
    v_mfma_f32_32x32x16_bf16 v[80:95], v[28:31], v[180:183], v[80:95]
    v_mfma_f32_32x32x16_bf16 v[96:111], v[28:31], v[184:187], v[96:111]
    v_mfma_f32_32x32x16_bf16 v[112:127], v[28:31], v[188:191], v[112:127]
    s_waitcnt lgkmcnt(0)
    v_dot2_f32_bf16 v60, v32, v14, v60
    v_dot2_f32_bf16 v61, v32, v32, v61
    v_dot2_f32_bf16 v62, v33, v14, v62
    v_dot2_f32_bf16 v63, v33, v33, v63
    v_dot2_f32_bf16 v60, v34, v14, v60
    v_dot2_f32_bf16 v61, v34, v34, v61
    v_dot2_f32_bf16 v62, v35, v14, v62
    v_dot2_f32_bf16 v63, v35, v35, v63
    v_dot2_f32_bf16 v60, v36, v14, v60
    v_dot2_f32_bf16 v61, v36, v36, v61
    v_dot2_f32_bf16 v62, v37, v14, v62
    v_dot2_f32_bf16 v63, v37, v37, v63
    v_dot2_f32_bf16 v60, v38, v14, v60
    v_dot2_f32_bf16 v61, v38, v38, v61
    v_dot2_f32_bf16 v62, v39, v14, v62
    v_dot2_f32_bf16 v63, v39, v39, v63
    v_dot2_f32_bf16 v60, v40, v14, v60
    v_dot2_f32_bf16 v61, v40, v40, v61
    v_dot2_f32_bf16 v62, v41, v14, v62
    v_dot2_f32_bf16 v63, v41, v41, v63
    v_dot2_f32_bf16 v60, v42, v14, v60
    v_dot2_f32_bf16 v61, v42, v42, v61
    v_dot2_f32_bf16 v62, v43, v14, v62
    v_dot2_f32_bf16 v63, v43, v43, v63
    v_dot2_f32_bf16 v60, v44, v14, v60
    v_dot2_f32_bf16 v61, v44, v44, v61
    v_dot2_f32_bf16 v62, v45, v14, v62
    v_dot2_f32_bf16 v63, v45, v45, v63
    v_dot2_f32_bf16 v60, v46, v14, v60
    v_dot2_f32_bf16 v61, v46, v46, v61
    v_dot2_f32_bf16 v62, v47, v14, v62
    v_dot2_f32_bf16 v63, v47, v47, v63
    v_dot2_f32_bf16 v56, v192, v14, v56
    v_dot2_f32_bf16 v58, v200, v14, v58
    v_dot2_f32_bf16 v56, v193, v14, v56
    v_dot2_f32_bf16 v58, v201, v14, v58
    v_dot2_f32_bf16 v56, v194, v14, v56
    v_dot2_f32_bf16 v58, v202, v14, v58
    v_dot2_f32_bf16 v56, v195, v14, v56
    v_dot2_f32_bf16 v58, v203, v14, v58
    v_dot2_f32_bf16 v56, v208, v14, v56
    v_dot2_f32_bf16 v58, v216, v14, v58
    v_dot2_f32_bf16 v56, v209, v14, v56
    v_dot2_f32_bf16 v58, v217, v14, v58
    v_dot2_f32_bf16 v56, v210, v14, v56
    v_dot2_f32_bf16 v58, v218, v14, v58
    v_dot2_f32_bf16 v56, v211, v14, v56
    v_dot2_f32_bf16 v58, v219, v14, v58
    v_xor_b32 v48, 0x10000, v48
    v_xor_b32 v52, 0x10000, v52
    v_xor_b32 v8, 0x10000, v8
    v_xor_b32 v49, 0x10000, v49
    v_xor_b32 v53, 0x10000, v53
    v_xor_b32 v9, 0x10000, v9
    v_xor_b32 v50, 0x10000, v50
    v_xor_b32 v54, 0x10000, v54
    v_xor_b32 v10, 0x10000, v10
    v_xor_b32 v51, 0x10000, v51
    v_xor_b32 v55, 0x10000, v55
    v_xor_b32 v11, 0x10000, v11
    s_barrier
    v_mfma_f32_32x32x16_bf16 v[64:79], v[32:35], v[192:195], v[64:79]
    ds_read_b128 v[16:19], v48 offset:0
    ds_read_b128 v[20:23], v49 offset:0
    ds_read_b128 v[24:27], v50 offset:0
    v_mfma_f32_32x32x16_bf16 v[80:95], v[32:35], v[196:199], v[80:95]
    ds_read_b128 v[28:31], v51 offset:0
    ds_read_b64_tr_b16 v[128:129], v52 offset:0
    ds_read_b64_tr_b16 v[130:131], v52 offset:1024
    v_mfma_f32_32x32x16_bf16 v[96:111], v[32:35], v[200:203], v[96:111]
    ds_read_b64_tr_b16 v[136:137], v54 offset:0
    ds_read_b64_tr_b16 v[138:139], v54 offset:1024
    ds_read_b64_tr_b16 v[144:145], v52 offset:4096
    v_mfma_f32_32x32x16_bf16 v[112:127], v[32:35], v[204:207], v[112:127]
    ds_read_b64_tr_b16 v[146:147], v52 offset:5120
    ds_read_b64_tr_b16 v[152:153], v54 offset:4096
    ds_read_b64_tr_b16 v[154:155], v54 offset:5120
    v_mfma_f32_32x32x16_bf16 v[64:79], v[36:39], v[208:211], v[64:79]
    ds_read_b64_tr_b16 v[132:133], v53 offset:0
    ds_read_b64_tr_b16 v[134:135], v53 offset:1024
    ds_read_b64_tr_b16 v[140:141], v55 offset:0
    v_mfma_f32_32x32x16_bf16 v[80:95], v[36:39], v[212:215], v[80:95]
    ds_read_b64_tr_b16 v[142:143], v55 offset:1024
    ds_read_b64_tr_b16 v[148:149], v53 offset:4096
    ds_read_b64_tr_b16 v[150:151], v53 offset:5120
    v_mfma_f32_32x32x16_bf16 v[96:111], v[36:39], v[216:219], v[96:111]
    ds_read_b64_tr_b16 v[156:157], v55 offset:4096
    ds_read_b64_tr_b16 v[158:159], v55 offset:5120
    ds_read_b64_tr_b16 v[160:161], v8 offset:0
    v_mfma_f32_32x32x16_bf16 v[112:127], v[36:39], v[220:223], v[112:127]
    ds_read_b64_tr_b16 v[162:163], v8 offset:1024
    ds_read_b64_tr_b16 v[164:165], v9 offset:0
    ds_read_b64_tr_b16 v[166:167], v9 offset:1024
    v_mfma_f32_32x32x16_bf16 v[64:79], v[40:43], v[224:227], v[64:79]
    ds_read_b64_tr_b16 v[168:169], v10 offset:0
    ds_read_b64_tr_b16 v[170:171], v10 offset:1024
    ds_read_b64_tr_b16 v[172:173], v11 offset:0
    v_mfma_f32_32x32x16_bf16 v[80:95], v[40:43], v[228:231], v[80:95]
    ds_read_b64_tr_b16 v[174:175], v11 offset:1024
    ds_read_b64_tr_b16 v[176:177], v8 offset:4096
    ds_read_b64_tr_b16 v[178:179], v8 offset:5120
    v_mfma_f32_32x32x16_bf16 v[96:111], v[40:43], v[232:235], v[96:111]
    ds_read_b64_tr_b16 v[180:181], v9 offset:4096
    ds_read_b64_tr_b16 v[182:183], v9 offset:5120
    ds_read_b64_tr_b16 v[184:185], v10 offset:4096
    v_mfma_f32_32x32x16_bf16 v[112:127], v[40:43], v[236:239], v[112:127]
    ds_read_b64_tr_b16 v[186:187], v10 offset:5120
    ds_read_b64_tr_b16 v[188:189], v11 offset:4096
    ds_read_b64_tr_b16 v[190:191], v11 offset:5120
    v_mfma_f32_32x32x16_bf16 v[64:79], v[44:47], v[240:243], v[64:79]
    v_mfma_f32_32x32x16_bf16 v[80:95], v[44:47], v[244:247], v[80:95]
    v_mfma_f32_32x32x16_bf16 v[96:111], v[44:47], v[248:251], v[96:111]
    v_mfma_f32_32x32x16_bf16 v[112:127], v[44:47], v[252:255], v[112:127]
    s_add_u32 s50, s50, 1
    s_cmp_lt_u32 s50, 4
    s_cbranch_scc1 F1_loopN
    s_waitcnt lgkmcnt(0)
    s_and_b32 s45, s4, 1
    s_lshl_b32 s45, s45, 9
    s_lshr_b32 s51, s4, 1
    s_lshl_b32 s51, s51, 8
    s_add_u32 s51, s51, s45
    s_add_u32 s51, s51, 132096
    v_lshlrev_b32 v5, 2, v2
    v_add_u32 v6, s51, v5
    ds_write_b32 v6, v56
    ds_write_b32 v6, v58 offset:1024
    s_add_u32 s51, s45, 132096
    v_add_u32 v6, s51, v5
    s_xor_b32 s45, s45, 512
    s_add_u32 s51, s45, 132096
    v_add_u32 v7, s51, v5
    v_add_f32 v60, v60, v62
    v_add_f32 v61, v61, v63
    v_mov_b32 v62, v60
    v_mov_b32 v63, v61
    s_nop 0
    v_permlane32_swap_b32 v60, v62
    v_permlane32_swap_b32 v61, v63
    v_add_f32 v60, v60, v62
    v_add_f32 v61, v61, v63
    v_mul_f32 v60, 0xbb000000, v60
    v_mul_f32 v61, 0x3b000000, v61
    v_fma_f32 v61, -v60, v60, v61
    v_max_f32 v61, 0, v61
    v_add_f32 v13, 0x3727c5ac, v61
    v_rsq_f32 v12, v13
    v_cvt_pk_bf16_f32 v8, v60, v60
    v_and_b32 v62, 0xffff0000, v8
    v_sub_f32 v62, v60, v62
    v_cvt_pk_bf16_f32 v9, v60, v62
    v_and_b32 v63, 0xffff0000, v9
    v_sub_f32 v63, v62, v63
    v_cvt_pk_bf16_f32 v10, v62, v63
    v_mov_b32 v11, 0
    s_waitcnt lgkmcnt(0)
    s_barrier
    ds_read2st64_b32 v[16:17], v6 offset0:0 offset1:1
    ds_read2st64_b32 v[18:19], v7 offset0:0 offset1:1
    ds_read2st64_b32 v[20:21], v6 offset0:4 offset1:5
    ds_read2st64_b32 v[22:23], v7 offset0:4 offset1:5
    v_cmp_gt_u32 vcc, 32, v2
    s_waitcnt lgkmcnt(0)
    v_add_f32 v56, v16, v17
    v_mov_b32 v4, v56
    s_nop 1
    v_permlane32_swap_b32 v56, v4
    v_add_f32 v56, v56, v4
    v_cndmask_b32 v56, 0, v56, vcc
    v_cvt_pk_bf16_f32 v4, v56, v56
    v_and_b32 v4, 0xffff0000, v4
    v_sub_f32 v5, v56, v4
    v_cvt_pk_bf16_f32 v4, v5, v5
    v_and_b32 v4, 0xffff0000, v4
    v_sub_f32 v6, v5, v4
    v_cvt_pk_bf16_f32 v32, v56, v5
    v_cvt_pk_bf16_f32 v33, v6, v56
    v_cvt_pk_bf16_f32 v34, v5, v56
    v_mov_b32 v35, 0
    v_add_f32 v57, v18, v19
    v_mov_b32 v4, v57
    s_nop 1
    v_permlane32_swap_b32 v57, v4
    v_add_f32 v57, v57, v4
    v_cndmask_b32 v57, 0, v57, vcc
    v_cvt_pk_bf16_f32 v4, v57, v57
    v_and_b32 v4, 0xffff0000, v4
    v_sub_f32 v5, v57, v4
    v_cvt_pk_bf16_f32 v4, v5, v5
    v_and_b32 v4, 0xffff0000, v4
    v_sub_f32 v6, v5, v4
    v_cvt_pk_bf16_f32 v36, v57, v5
    v_cvt_pk_bf16_f32 v37, v6, v57
    v_cvt_pk_bf16_f32 v38, v5, v57
    v_mov_b32 v39, 0
    v_add_f32 v58, v20, v21
    v_mov_b32 v4, v58
    s_nop 1
    v_permlane32_swap_b32 v58, v4
    v_add_f32 v58, v58, v4
    v_cndmask_b32 v58, 0, v58, vcc
    v_cvt_pk_bf16_f32 v4, v58, v58
    v_and_b32 v4, 0xffff0000, v4
    v_sub_f32 v5, v58, v4
    v_cvt_pk_bf16_f32 v4, v5, v5
    v_and_b32 v4, 0xffff0000, v4
    v_sub_f32 v6, v5, v4
    v_cvt_pk_bf16_f32 v40, v58, v5
    v_cvt_pk_bf16_f32 v41, v6, v58
    v_cvt_pk_bf16_f32 v42, v5, v58
    v_mov_b32 v43, 0
    v_add_f32 v59, v22, v23
    v_mov_b32 v4, v59
    s_nop 1
    v_permlane32_swap_b32 v59, v4
    v_add_f32 v59, v59, v4
    v_cndmask_b32 v59, 0, v59, vcc
    v_cvt_pk_bf16_f32 v4, v59, v59
    v_and_b32 v4, 0xffff0000, v4
    v_sub_f32 v5, v59, v4
    v_cvt_pk_bf16_f32 v4, v5, v5
    v_and_b32 v4, 0xffff0000, v4
    v_sub_f32 v6, v5, v4
    v_cvt_pk_bf16_f32 v44, v59, v5
    v_cvt_pk_bf16_f32 v45, v6, v59
    v_cvt_pk_bf16_f32 v46, v5, v59
    v_mov_b32 v47, 0
    v_mfma_f32_32x32x16_bf16 v[64:79], v[8:11], v[32:35], v[64:79]
    v_mfma_f32_32x32x16_bf16 v[80:95], v[8:11], v[36:39], v[80:95]
    v_mfma_f32_32x32x16_bf16 v[96:111], v[8:11], v[40:43], v[96:111]
    v_mfma_f32_32x32x16_bf16 v[112:127], v[8:11], v[44:47], v[112:127]
    s_or_b32 s51, s7, s4
    s_cmp_lg_u32 s51, 0
    s_cbranch_scc1 F1_ncN
    s_sub_u32 s51, s6, 4
    s_mul_i32 s51, s51, 204800
    s_add_u32 s51, s51, 98304
    s_add_u32 s45, s51, 102400
    buffer_store_dwordx4 v[32:35], v3, s[8:11], s51 offen offset:0 sc0 sc1
    buffer_store_dwordx4 v[36:39], v3, s[8:11], s45 offen offset:0 sc0 sc1
    buffer_store_dwordx4 v[40:43], v3, s[8:11], s51 offen offset:1024 sc0 sc1
    buffer_store_dwordx4 v[44:47], v3, s[8:11], s45 offen offset:1024 sc0 sc1
F1_ncN:
    s_nop 1
    s_lshl_b32 s18, s4, 7
    s_add_u32 s18, s18, 131072
    v_and_b32 v5, 31, v2
    v_lshlrev_b32 v5, 2, v5
    v_add_u32 v5, s18, v5
    v_lshrrev_b32 v6, 5, v2
    v_lshlrev_b32 v6, 4, v6
    v_add_u32 v6, s18, v6
    ds_write_b32 v5, v12
    s_waitcnt lgkmcnt(0)
    ds_read_b128 v[160:163], v6 offset:0
    ds_read_b128 v[164:167], v6 offset:32
    ds_read_b128 v[168:171], v6 offset:64
    ds_read_b128 v[172:175], v6 offset:96
    v_and_b32 v4, 16, v2
    v_cmp_eq_u32 vcc, 0, v4
    s_mul_i32 s18, s4, 4352
    s_add_u32 s18, s18, 32768
    s_and_b32 s45, s4, 1
    s_mul_i32 s45, s45, 2176
    s_add_u32 s19, s18, s45
    v_add_u32 v44, s19, v3
    s_sub_u32 s45, 2176, s45
    s_add_u32 s20, s18, s45
    v_add_u32 v47, s20, v3
    v_and_b32 v45, 16, v2
    v_lshlrev_b32 v45, 1, v45
    v_lshrrev_b32 v48, 5, v2
    v_lshlrev_b32 v48, 4, v48
    v_add_u32 v48, v48, v45
    v_add_u32 v48, s19, v48
    v_and_b32 v45, 16, v2
    v_lshlrev_b32 v45, 1, v45
    v_lshrrev_b32 v49, 5, v2
    v_lshlrev_b32 v49, 4, v49
    v_add_u32 v49, v49, v45
    v_add_u32 v49, s20, v49
    s_lshl_b32 s18, s4, 9
    v_lshlrev_b32 v46, 2, v2
    v_add_u32 v45, s18, v46
    s_waitcnt lgkmcnt(0)
    v_mov_b32 v152, 0x358637bd
    v_mov_b32 v153, 0x358637bd
    v_mov_b32 v154, 0x3fb8aa3b
    v_mov_b32 v155, 0x3fb8aa3b
    v_pk_mul_f32 v[128:129], v[160:161], v[154:155]
    v_pk_mul_f32 v[130:131], v[162:163], v[154:155]
    v_pk_mul_f32 v[132:133], v[164:165], v[154:155]
    v_pk_mul_f32 v[134:135], v[166:167], v[154:155]
    v_pk_mul_f32 v[136:137], v[168:169], v[154:155]
    v_pk_mul_f32 v[138:139], v[170:171], v[154:155]
    v_pk_mul_f32 v[140:141], v[172:173], v[154:155]
    v_pk_mul_f32 v[142:143], v[174:175], v[154:155]
    v_pk_mul_f32 v[144:145], v[64:65], v[128:129]
    v_pk_mul_f32 v[146:147], v[66:67], v[130:131]
    v_pk_mul_f32 v[148:149], v[68:69], v[132:133]
    v_pk_mul_f32 v[150:151], v[70:71], v[134:135]
    v_max_f32 v64, 0, v64
    v_max_f32 v65, 0, v65
    v_max_f32 v66, 0, v66
    v_max_f32 v67, 0, v67
    v_max_f32 v68, 0, v68
    v_max_f32 v69, 0, v69
    v_max_f32 v70, 0, v70
    v_max_f32 v71, 0, v71
    v_min_f32 v144, 0, v144
    v_min_f32 v145, 0, v145
    v_min_f32 v146, 0, v146
    v_min_f32 v147, 0, v147
    v_min_f32 v148, 0, v148
    v_min_f32 v149, 0, v149
    v_min_f32 v150, 0, v150
    v_min_f32 v151, 0, v151
    v_exp_f32 v144, v144
    v_exp_f32 v145, v145
    v_exp_f32 v146, v146
    v_exp_f32 v147, v147
    v_exp_f32 v148, v148
    v_exp_f32 v149, v149
    v_exp_f32 v150, v150
    v_exp_f32 v151, v151
    v_pk_fma_f32 v[64:65], v[64:65], v[160:161], v[152:153]
    v_pk_fma_f32 v[66:67], v[66:67], v[162:163], v[152:153]
    v_pk_fma_f32 v[68:69], v[68:69], v[164:165], v[152:153]
    v_pk_fma_f32 v[70:71], v[70:71], v[166:167], v[152:153]
    v_pk_mul_f32 v[96:97], v[96:97], v[160:161]
    v_pk_mul_f32 v[98:99], v[98:99], v[162:163]
    v_pk_mul_f32 v[100:101], v[100:101], v[164:165]
    v_pk_mul_f32 v[102:103], v[102:103], v[166:167]
    v_pk_add_f32 v[64:65], v[64:65], v[144:145]
    v_pk_add_f32 v[66:67], v[66:67], v[146:147]
    v_pk_add_f32 v[68:69], v[68:69], v[148:149]
    v_pk_add_f32 v[70:71], v[70:71], v[150:151]
    v_pk_mul_f32 v[144:145], v[72:73], v[136:137]
    v_pk_mul_f32 v[146:147], v[74:75], v[138:139]
    v_pk_mul_f32 v[148:149], v[76:77], v[140:141]
    v_pk_mul_f32 v[150:151], v[78:79], v[142:143]
    v_max_f32 v72, 0, v72
    v_max_f32 v73, 0, v73
    v_max_f32 v74, 0, v74
    v_max_f32 v75, 0, v75
    v_max_f32 v76, 0, v76
    v_max_f32 v77, 0, v77
    v_max_f32 v78, 0, v78
    v_max_f32 v79, 0, v79
    v_min_f32 v144, 0, v144
    v_min_f32 v145, 0, v145
    v_min_f32 v146, 0, v146
    v_min_f32 v147, 0, v147
    v_min_f32 v148, 0, v148
    v_min_f32 v149, 0, v149
    v_min_f32 v150, 0, v150
    v_min_f32 v151, 0, v151
    v_exp_f32 v144, v144
    v_exp_f32 v145, v145
    v_exp_f32 v146, v146
    v_exp_f32 v147, v147
    v_exp_f32 v148, v148
    v_exp_f32 v149, v149
    v_exp_f32 v150, v150
    v_exp_f32 v151, v151
    v_pk_fma_f32 v[72:73], v[72:73], v[168:169], v[152:153]
    v_pk_fma_f32 v[74:75], v[74:75], v[170:171], v[152:153]
    v_pk_fma_f32 v[76:77], v[76:77], v[172:173], v[152:153]
    v_pk_fma_f32 v[78:79], v[78:79], v[174:175], v[152:153]
    v_pk_mul_f32 v[104:105], v[104:105], v[168:169]
    v_pk_mul_f32 v[106:107], v[106:107], v[170:171]
    v_pk_mul_f32 v[108:109], v[108:109], v[172:173]
    v_pk_mul_f32 v[110:111], v[110:111], v[174:175]
    v_pk_add_f32 v[72:73], v[72:73], v[144:145]
    v_pk_add_f32 v[74:75], v[74:75], v[146:147]
    v_pk_add_f32 v[76:77], v[76:77], v[148:149]
    v_pk_add_f32 v[78:79], v[78:79], v[150:151]
    v_cvt_pk_bf16_f32 v64, v64, v65
    v_cvt_pk_bf16_f32 v96, v96, v97
    v_cvt_pk_bf16_f32 v65, v66, v67
    v_cvt_pk_bf16_f32 v97, v98, v99
    v_cvt_pk_bf16_f32 v66, v68, v69
    v_cvt_pk_bf16_f32 v98, v100, v101
    v_cvt_pk_bf16_f32 v67, v70, v71
    v_cvt_pk_bf16_f32 v99, v102, v103
    v_cvt_pk_bf16_f32 v68, v72, v73
    v_cvt_pk_bf16_f32 v100, v104, v105
    v_cvt_pk_bf16_f32 v69, v74, v75
    v_cvt_pk_bf16_f32 v101, v106, v107
    v_cvt_pk_bf16_f32 v70, v76, v77
    v_cvt_pk_bf16_f32 v102, v108, v109
    v_cvt_pk_bf16_f32 v71, v78, v79
    v_cvt_pk_bf16_f32 v103, v110, v111
    v_cndmask_b32 v72, v14, v96, vcc
    v_cndmask_b32 v104, v96, v14, vcc
    v_cndmask_b32 v73, v14, v97, vcc
    v_cndmask_b32 v105, v97, v14, vcc
    v_cndmask_b32 v74, v14, v98, vcc
    v_cndmask_b32 v106, v98, v14, vcc
    v_cndmask_b32 v75, v14, v99, vcc
    v_cndmask_b32 v107, v99, v14, vcc
    v_cndmask_b32 v76, v14, v100, vcc
    v_cndmask_b32 v108, v100, v14, vcc
    v_cndmask_b32 v77, v14, v101, vcc
    v_cndmask_b32 v109, v101, v14, vcc
    v_cndmask_b32 v78, v14, v102, vcc
    v_cndmask_b32 v110, v102, v14, vcc
    v_cndmask_b32 v79, v14, v103, vcc
    v_cndmask_b32 v111, v103, v14, vcc
    v_mfma_f32_32x32x16_bf16 v[176:191], v[64:67], v[72:75], 0
    v_mfma_f32_32x32x16_bf16 v[192:207], v[64:67], v[104:107], 0
    v_mfma_f32_32x32x16_bf16 v[176:191], v[68:71], v[76:79], v[176:191]
    v_mfma_f32_32x32x16_bf16 v[192:207], v[68:71], v[108:111], v[192:207]
    v_pk_mul_f32 v[144:145], v[80:81], v[128:129]
    v_pk_mul_f32 v[146:147], v[82:83], v[130:131]
    v_pk_mul_f32 v[148:149], v[84:85], v[132:133]
    v_pk_mul_f32 v[150:151], v[86:87], v[134:135]
    v_max_f32 v80, 0, v80
    v_max_f32 v81, 0, v81
    v_max_f32 v82, 0, v82
    v_max_f32 v83, 0, v83
    v_max_f32 v84, 0, v84
    v_max_f32 v85, 0, v85
    v_max_f32 v86, 0, v86
    v_max_f32 v87, 0, v87
    v_min_f32 v144, 0, v144
    v_min_f32 v145, 0, v145
    v_min_f32 v146, 0, v146
    v_min_f32 v147, 0, v147
    v_min_f32 v148, 0, v148
    v_min_f32 v149, 0, v149
    v_min_f32 v150, 0, v150
    v_min_f32 v151, 0, v151
    v_exp_f32 v144, v144
    v_exp_f32 v145, v145
    v_exp_f32 v146, v146
    v_exp_f32 v147, v147
    v_exp_f32 v148, v148
    v_exp_f32 v149, v149
    v_exp_f32 v150, v150
    v_exp_f32 v151, v151
    v_pk_fma_f32 v[80:81], v[80:81], v[160:161], v[152:153]
    v_pk_fma_f32 v[82:83], v[82:83], v[162:163], v[152:153]
    v_pk_fma_f32 v[84:85], v[84:85], v[164:165], v[152:153]
    v_pk_fma_f32 v[86:87], v[86:87], v[166:167], v[152:153]
    v_pk_mul_f32 v[112:113], v[112:113], v[160:161]
    v_pk_mul_f32 v[114:115], v[114:115], v[162:163]
    v_pk_mul_f32 v[116:117], v[116:117], v[164:165]
    v_pk_mul_f32 v[118:119], v[118:119], v[166:167]
    v_pk_add_f32 v[80:81], v[80:81], v[144:145]
    v_pk_add_f32 v[82:83], v[82:83], v[146:147]
    v_pk_add_f32 v[84:85], v[84:85], v[148:149]
    v_pk_add_f32 v[86:87], v[86:87], v[150:151]
    v_pk_mul_f32 v[144:145], v[88:89], v[136:137]
    v_pk_mul_f32 v[146:147], v[90:91], v[138:139]
    v_pk_mul_f32 v[148:149], v[92:93], v[140:141]
    v_pk_mul_f32 v[150:151], v[94:95], v[142:143]
    v_max_f32 v88, 0, v88
    v_max_f32 v89, 0, v89
    v_max_f32 v90, 0, v90
    v_max_f32 v91, 0, v91
    v_max_f32 v92, 0, v92
    v_max_f32 v93, 0, v93
    v_max_f32 v94, 0, v94
    v_max_f32 v95, 0, v95
    v_min_f32 v144, 0, v144
    v_min_f32 v145, 0, v145
    v_min_f32 v146, 0, v146
    v_min_f32 v147, 0, v147
    v_min_f32 v148, 0, v148
    v_min_f32 v149, 0, v149
    v_min_f32 v150, 0, v150
    v_min_f32 v151, 0, v151
    v_exp_f32 v144, v144
    v_exp_f32 v145, v145
    v_exp_f32 v146, v146
    v_exp_f32 v147, v147
    v_exp_f32 v148, v148
    v_exp_f32 v149, v149
    v_exp_f32 v150, v150
    v_exp_f32 v151, v151
    v_pk_fma_f32 v[88:89], v[88:89], v[168:169], v[152:153]
    v_pk_fma_f32 v[90:91], v[90:91], v[170:171], v[152:153]
    v_pk_fma_f32 v[92:93], v[92:93], v[172:173], v[152:153]
    v_pk_fma_f32 v[94:95], v[94:95], v[174:175], v[152:153]
    v_pk_mul_f32 v[120:121], v[120:121], v[168:169]
    v_pk_mul_f32 v[122:123], v[122:123], v[170:171]
    v_pk_mul_f32 v[124:125], v[124:125], v[172:173]
    v_pk_mul_f32 v[126:127], v[126:127], v[174:175]
    v_pk_add_f32 v[88:89], v[88:89], v[144:145]
    v_pk_add_f32 v[90:91], v[90:91], v[146:147]
    v_pk_add_f32 v[92:93], v[92:93], v[148:149]
    v_pk_add_f32 v[94:95], v[94:95], v[150:151]
    v_cvt_pk_bf16_f32 v80, v80, v81
    v_cvt_pk_bf16_f32 v112, v112, v113
    v_cvt_pk_bf16_f32 v81, v82, v83
    v_cvt_pk_bf16_f32 v113, v114, v115
    v_cvt_pk_bf16_f32 v82, v84, v85
    v_cvt_pk_bf16_f32 v114, v116, v117
    v_cvt_pk_bf16_f32 v83, v86, v87
    v_cvt_pk_bf16_f32 v115, v118, v119
    v_cvt_pk_bf16_f32 v84, v88, v89
    v_cvt_pk_bf16_f32 v116, v120, v121
    v_cvt_pk_bf16_f32 v85, v90, v91
    v_cvt_pk_bf16_f32 v117, v122, v123
    v_cvt_pk_bf16_f32 v86, v92, v93
    v_cvt_pk_bf16_f32 v118, v124, v125
    v_cvt_pk_bf16_f32 v87, v94, v95
    v_cvt_pk_bf16_f32 v119, v126, v127
    v_cndmask_b32 v88, v14, v112, vcc
    v_cndmask_b32 v120, v112, v14, vcc
    v_cndmask_b32 v89, v14, v113, vcc
    v_cndmask_b32 v121, v113, v14, vcc
    v_cndmask_b32 v90, v14, v114, vcc
    v_cndmask_b32 v122, v114, v14, vcc
    v_cndmask_b32 v91, v14, v115, vcc
    v_cndmask_b32 v123, v115, v14, vcc
    v_cndmask_b32 v92, v14, v116, vcc
    v_cndmask_b32 v124, v116, v14, vcc
    v_cndmask_b32 v93, v14, v117, vcc
    v_cndmask_b32 v125, v117, v14, vcc
    v_cndmask_b32 v94, v14, v118, vcc
    v_cndmask_b32 v126, v118, v14, vcc
    v_cndmask_b32 v95, v14, v119, vcc
    v_cndmask_b32 v127, v119, v14, vcc
    v_mfma_f32_32x32x16_bf16 v[208:223], v[80:83], v[88:91], 0
    v_mfma_f32_32x32x16_bf16 v[224:239], v[80:83], v[120:123], 0
    v_mfma_f32_32x32x16_bf16 v[208:223], v[84:87], v[92:95], v[208:223]
    v_mfma_f32_32x32x16_bf16 v[224:239], v[84:87], v[124:127], v[224:239]
    v_cndmask_b32 v192, v176, v200, vcc
    v_cndmask_b32 v193, v177, v201, vcc
    v_cndmask_b32 v194, v178, v202, vcc
    v_cndmask_b32 v195, v179, v203, vcc
    v_cndmask_b32 v196, v180, v204, vcc
    v_cndmask_b32 v197, v181, v205, vcc
    v_cndmask_b32 v198, v182, v206, vcc
    v_cndmask_b32 v199, v183, v207, vcc
    v_cndmask_b32 v176, v200, v176, vcc
    v_cndmask_b32 v177, v201, v177, vcc
    v_cndmask_b32 v178, v202, v178, vcc
    v_cndmask_b32 v179, v203, v179, vcc
    v_cndmask_b32 v180, v204, v180, vcc
    v_cndmask_b32 v181, v205, v181, vcc
    v_cndmask_b32 v182, v206, v182, vcc
    v_cndmask_b32 v183, v207, v183, vcc
    ds_write_b128 v44, v[176:179]
    ds_write_b128 v44, v[180:183] offset:1024
    s_mov_b32 exec_lo, 0x00010001
    s_mov_b32 exec_hi, 0x00010001
    ds_write_b128 v48, v[192:195] offset:2048
    ds_write_b128 v48, v[196:199] offset:2112
    s_mov_b64 exec, -1
    v_cndmask_b32 v224, v208, v232, vcc
    v_cndmask_b32 v225, v209, v233, vcc
    v_cndmask_b32 v226, v210, v234, vcc
    v_cndmask_b32 v227, v211, v235, vcc
    v_cndmask_b32 v228, v212, v236, vcc
    v_cndmask_b32 v229, v213, v237, vcc
    v_cndmask_b32 v230, v214, v238, vcc
    v_cndmask_b32 v231, v215, v239, vcc
    v_cndmask_b32 v208, v232, v208, vcc
    v_cndmask_b32 v209, v233, v209, vcc
    v_cndmask_b32 v210, v234, v210, vcc
    v_cndmask_b32 v211, v235, v211, vcc
    v_cndmask_b32 v212, v236, v212, vcc
    v_cndmask_b32 v213, v237, v213, vcc
    v_cndmask_b32 v214, v238, v214, vcc
    v_cndmask_b32 v215, v239, v215, vcc
    ds_write_b128 v47, v[208:211]
    ds_write_b128 v47, v[212:215] offset:1024
    s_mov_b32 exec_lo, 0x00010001
    s_mov_b32 exec_hi, 0x00010001
    ds_write_b128 v49, v[224:227] offset:2048
    ds_write_b128 v49, v[228:231] offset:2112
    s_mov_b64 exec, -1
    s_waitcnt lgkmcnt(0)
    s_barrier
    ds_read_b32 v64, v45 offset:32768
    ds_read_b32 v65, v45 offset:37120
    ds_read_b32 v66, v45 offset:41472
    ds_read_b32 v67, v45 offset:45824
    ds_read_b32 v68, v45 offset:33024
    ds_read_b32 v69, v45 offset:37376
    ds_read_b32 v70, v45 offset:41728
    ds_read_b32 v71, v45 offset:46080
    ds_read_b32 v80, v46 offset:34816
    ds_read_b32 v81, v46 offset:39168
    ds_read_b32 v82, v46 offset:43520
    ds_read_b32 v83, v46 offset:47872
    ds_read_b32 v72, v45 offset:34944
    ds_read_b32 v73, v45 offset:39296
    ds_read_b32 v74, v45 offset:43648
    ds_read_b32 v75, v45 offset:48000
    ds_read_b32 v76, v45 offset:35200
    ds_read_b32 v77, v45 offset:39552
    ds_read_b32 v78, v45 offset:43904
    ds_read_b32 v79, v45 offset:48256
    ds_read_b32 v84, v46 offset:36992
    ds_read_b32 v85, v46 offset:41344
    ds_read_b32 v86, v46 offset:45696
    ds_read_b32 v87, v46 offset:50048
    s_sub_u32 s20, s6, 4
    s_lshl_b32 s18, s20, 12
    s_add_u32 s18, s18, 27262976
    s_lshl_b32 s19, s4, 9
    s_add_u32 s18, s18, s19
    s_lshl_b32 s19, s20, 8
    s_add_u32 s19, s19, 27295744
    s_waitcnt lgkmcnt(0)
    v_add_f32 v64, v64, v65
    v_add_f32 v66, v66, v67
    v_add_f32 v68, v68, v69
    v_add_f32 v70, v70, v71
    v_add_f32 v72, v72, v73
    v_add_f32 v74, v74, v75
    v_add_f32 v76, v76, v77
    v_add_f32 v78, v78, v79
    v_add_f32 v80, v80, v81
    v_add_f32 v82, v82, v83
    v_add_f32 v84, v84, v85
    v_add_f32 v86, v86, v87
    v_add_f32 v64, v64, v66
    v_add_f32 v68, v68, v70
    v_add_f32 v72, v72, v74
    v_add_f32 v76, v76, v78
    v_add_f32 v80, v80, v82
    v_add_f32 v84, v84, v86
    buffer_atomic_add_f32 v64, v46, s[8:11], s18 offen offset:0
    buffer_atomic_add_f32 v68, v46, s[8:11], s18 offen offset:256
    buffer_atomic_add_f32 v72, v46, s[8:11], s18 offen offset:2048
    buffer_atomic_add_f32 v76, v46, s[8:11], s18 offen offset:2304
    s_cmp_lg_u32 s4, 0
    s_cbranch_scc1 F1_noz
    s_mov_b64 exec, 0xffffffff
    buffer_atomic_add_f32 v80, v46, s[8:11], s19 offen
    buffer_atomic_add_f32 v84, v46, s[8:11], s19 offen offset:128
    s_mov_b64 exec, -1
F1_noz:
    s_endpgm
F1_preT:
    s_waitcnt vmcnt(0)
    s_barrier
    ds_read_b128 v[16:19], v48 offset:0
    ds_read_b128 v[20:23], v49 offset:0
    ds_read_b128 v[24:27], v50 offset:0
    ds_read_b128 v[28:31], v51 offset:0
    ds_read_b64_tr_b16 v[128:129], v52 offset:0
    ds_read_b64_tr_b16 v[130:131], v52 offset:1024
    ds_read_b64_tr_b16 v[136:137], v54 offset:0
    ds_read_b64_tr_b16 v[138:139], v54 offset:1024
    ds_read_b64_tr_b16 v[144:145], v52 offset:4096
    ds_read_b64_tr_b16 v[146:147], v52 offset:5120
    ds_read_b64_tr_b16 v[152:153], v54 offset:4096
    ds_read_b64_tr_b16 v[154:155], v54 offset:5120
    ds_read_b64_tr_b16 v[132:133], v53 offset:0
    ds_read_b64_tr_b16 v[134:135], v53 offset:1024
    ds_read_b64_tr_b16 v[140:141], v55 offset:0
    ds_read_b64_tr_b16 v[142:143], v55 offset:1024
    ds_read_b64_tr_b16 v[148:149], v53 offset:4096
    ds_read_b64_tr_b16 v[150:151], v53 offset:5120
    ds_read_b64_tr_b16 v[156:157], v55 offset:4096
    ds_read_b64_tr_b16 v[158:159], v55 offset:5120
    ds_read_b64_tr_b16 v[160:161], v8 offset:0
    ds_read_b64_tr_b16 v[162:163], v8 offset:1024
    ds_read_b64_tr_b16 v[164:165], v9 offset:0
    ds_read_b64_tr_b16 v[166:167], v9 offset:1024
    ds_read_b64_tr_b16 v[168:169], v10 offset:0
    ds_read_b64_tr_b16 v[170:171], v10 offset:1024
    ds_read_b64_tr_b16 v[172:173], v11 offset:0
    ds_read_b64_tr_b16 v[174:175], v11 offset:1024
    ds_read_b64_tr_b16 v[176:177], v8 offset:4096
    ds_read_b64_tr_b16 v[178:179], v8 offset:5120
    ds_read_b64_tr_b16 v[180:181], v9 offset:4096
    ds_read_b64_tr_b16 v[182:183], v9 offset:5120
    ds_read_b64_tr_b16 v[184:185], v10 offset:4096
    ds_read_b64_tr_b16 v[186:187], v10 offset:5120
    ds_read_b64_tr_b16 v[188:189], v11 offset:4096
    ds_read_b64_tr_b16 v[190:191], v11 offset:5120
F1_loopT:
    s_waitcnt lgkmcnt(0)
    v_dot2_f32_bf16 v60, v16, v14, v60
    v_dot2_f32_bf16 v61, v16, v16, v61
    v_dot2_f32_bf16 v62, v17, v14, v62
    v_dot2_f32_bf16 v63, v17, v17, v63
    v_dot2_f32_bf16 v60, v18, v14, v60
    v_dot2_f32_bf16 v61, v18, v18, v61
    v_dot2_f32_bf16 v62, v19, v14, v62
    v_dot2_f32_bf16 v63, v19, v19, v63
    v_dot2_f32_bf16 v60, v20, v14, v60
    v_dot2_f32_bf16 v61, v20, v20, v61
    v_dot2_f32_bf16 v62, v21, v14, v62
    v_dot2_f32_bf16 v63, v21, v21, v63
    v_dot2_f32_bf16 v60, v22, v14, v60
    v_dot2_f32_bf16 v61, v22, v22, v61
    v_dot2_f32_bf16 v62, v23, v14, v62
    v_dot2_f32_bf16 v63, v23, v23, v63
    v_dot2_f32_bf16 v60, v24, v14, v60
    v_dot2_f32_bf16 v61, v24, v24, v61
    v_dot2_f32_bf16 v62, v25, v14, v62
    v_dot2_f32_bf16 v63, v25, v25, v63
    v_dot2_f32_bf16 v60, v26, v14, v60
    v_dot2_f32_bf16 v61, v26, v26, v61
    v_dot2_f32_bf16 v62, v27, v14, v62
    v_dot2_f32_bf16 v63, v27, v27, v63
    v_dot2_f32_bf16 v60, v28, v14, v60
    v_dot2_f32_bf16 v61, v28, v28, v61
    v_dot2_f32_bf16 v62, v29, v14, v62
    v_dot2_f32_bf16 v63, v29, v29, v63
    v_dot2_f32_bf16 v60, v30, v14, v60
    v_dot2_f32_bf16 v61, v30, v30, v61
    v_dot2_f32_bf16 v62, v31, v14, v62
    v_dot2_f32_bf16 v63, v31, v31, v63
    v_dot2_f32_bf16 v56, v128, v14, v56
    v_dot2_f32_bf16 v58, v136, v14, v58
    v_dot2_f32_bf16 v56, v129, v14, v56
    v_dot2_f32_bf16 v58, v137, v14, v58
    v_dot2_f32_bf16 v56, v130, v14, v56
    v_dot2_f32_bf16 v58, v138, v14, v58
    v_dot2_f32_bf16 v56, v131, v14, v56
    v_dot2_f32_bf16 v58, v139, v14, v58
    v_dot2_f32_bf16 v56, v144, v14, v56
    v_dot2_f32_bf16 v58, v152, v14, v58
    v_dot2_f32_bf16 v56, v145, v14, v56
    v_dot2_f32_bf16 v58, v153, v14, v58
    v_dot2_f32_bf16 v56, v146, v14, v56
    v_dot2_f32_bf16 v58, v154, v14, v58
    v_dot2_f32_bf16 v56, v147, v14, v56
    v_dot2_f32_bf16 v58, v155, v14, v58
    s_barrier
    v_mfma_f32_32x32x16_bf16 v[64:79], v[128:131], v[16:19], v[64:79]
    ds_read_b128 v[32:35], v48 offset:32768
    ds_read_b128 v[36:39], v49 offset:32768
    ds_read_b128 v[40:43], v50 offset:32768
    v_mfma_f32_32x32x16_bf16 v[80:95], v[132:135], v[16:19], v[80:95]
    ds_read_b128 v[44:47], v51 offset:32768
    ds_read_b64_tr_b16 v[192:193], v52 offset:32768
    ds_read_b64_tr_b16 v[194:195], v52 offset:33792
    v_mfma_f32_32x32x16_bf16 v[96:111], v[136:139], v[16:19], v[96:111]
    ds_read_b64_tr_b16 v[200:201], v54 offset:32768
    ds_read_b64_tr_b16 v[202:203], v54 offset:33792
    ds_read_b64_tr_b16 v[208:209], v52 offset:36864
    v_mfma_f32_32x32x16_bf16 v[112:127], v[140:143], v[16:19], v[112:127]
    ds_read_b64_tr_b16 v[210:211], v52 offset:37888
    ds_read_b64_tr_b16 v[216:217], v54 offset:36864
    ds_read_b64_tr_b16 v[218:219], v54 offset:37888
    v_mfma_f32_32x32x16_bf16 v[64:79], v[144:147], v[20:23], v[64:79]
    ds_read_b64_tr_b16 v[196:197], v53 offset:32768
    ds_read_b64_tr_b16 v[198:199], v53 offset:33792
    ds_read_b64_tr_b16 v[204:205], v55 offset:32768
    v_mfma_f32_32x32x16_bf16 v[80:95], v[148:151], v[20:23], v[80:95]
    ds_read_b64_tr_b16 v[206:207], v55 offset:33792
    ds_read_b64_tr_b16 v[212:213], v53 offset:36864
    ds_read_b64_tr_b16 v[214:215], v53 offset:37888
    v_mfma_f32_32x32x16_bf16 v[96:111], v[152:155], v[20:23], v[96:111]
    ds_read_b64_tr_b16 v[220:221], v55 offset:36864
    ds_read_b64_tr_b16 v[222:223], v55 offset:37888
    ds_read_b64_tr_b16 v[224:225], v8 offset:32768
    v_mfma_f32_32x32x16_bf16 v[112:127], v[156:159], v[20:23], v[112:127]
    ds_read_b64_tr_b16 v[226:227], v8 offset:33792
    ds_read_b64_tr_b16 v[228:229], v9 offset:32768
    ds_read_b64_tr_b16 v[230:231], v9 offset:33792
    v_mfma_f32_32x32x16_bf16 v[64:79], v[160:163], v[24:27], v[64:79]
    ds_read_b64_tr_b16 v[232:233], v10 offset:32768
    ds_read_b64_tr_b16 v[234:235], v10 offset:33792
    ds_read_b64_tr_b16 v[236:237], v11 offset:32768
    v_mfma_f32_32x32x16_bf16 v[80:95], v[164:167], v[24:27], v[80:95]
    ds_read_b64_tr_b16 v[238:239], v11 offset:33792
    ds_read_b64_tr_b16 v[240:241], v8 offset:36864
    ds_read_b64_tr_b16 v[242:243], v8 offset:37888
    v_mfma_f32_32x32x16_bf16 v[96:111], v[168:171], v[24:27], v[96:111]
    ds_read_b64_tr_b16 v[244:245], v9 offset:36864
    ds_read_b64_tr_b16 v[246:247], v9 offset:37888
    ds_read_b64_tr_b16 v[248:249], v10 offset:36864
    v_mfma_f32_32x32x16_bf16 v[112:127], v[172:175], v[24:27], v[112:127]
    ds_read_b64_tr_b16 v[250:251], v10 offset:37888
    ds_read_b64_tr_b16 v[252:253], v11 offset:36864
    ds_read_b64_tr_b16 v[254:255], v11 offset:37888
    v_mfma_f32_32x32x16_bf16 v[64:79], v[176:179], v[28:31], v[64:79]
    v_mfma_f32_32x32x16_bf16 v[80:95], v[180:183], v[28:31], v[80:95]
    v_mfma_f32_32x32x16_bf16 v[96:111], v[184:187], v[28:31], v[96:111]
    v_mfma_f32_32x32x16_bf16 v[112:127], v[188:191], v[28:31], v[112:127]
    s_waitcnt lgkmcnt(0)
    v_dot2_f32_bf16 v60, v32, v14, v60
    v_dot2_f32_bf16 v61, v32, v32, v61
    v_dot2_f32_bf16 v62, v33, v14, v62
    v_dot2_f32_bf16 v63, v33, v33, v63
    v_dot2_f32_bf16 v60, v34, v14, v60
    v_dot2_f32_bf16 v61, v34, v34, v61
    v_dot2_f32_bf16 v62, v35, v14, v62
    v_dot2_f32_bf16 v63, v35, v35, v63
    v_dot2_f32_bf16 v60, v36, v14, v60
    v_dot2_f32_bf16 v61, v36, v36, v61
    v_dot2_f32_bf16 v62, v37, v14, v62
    v_dot2_f32_bf16 v63, v37, v37, v63
    v_dot2_f32_bf16 v60, v38, v14, v60
    v_dot2_f32_bf16 v61, v38, v38, v61
    v_dot2_f32_bf16 v62, v39, v14, v62
    v_dot2_f32_bf16 v63, v39, v39, v63
    v_dot2_f32_bf16 v60, v40, v14, v60
    v_dot2_f32_bf16 v61, v40, v40, v61
    v_dot2_f32_bf16 v62, v41, v14, v62
    v_dot2_f32_bf16 v63, v41, v41, v63
    v_dot2_f32_bf16 v60, v42, v14, v60
    v_dot2_f32_bf16 v61, v42, v42, v61
    v_dot2_f32_bf16 v62, v43, v14, v62
    v_dot2_f32_bf16 v63, v43, v43, v63
    v_dot2_f32_bf16 v60, v44, v14, v60
    v_dot2_f32_bf16 v61, v44, v44, v61
    v_dot2_f32_bf16 v62, v45, v14, v62
    v_dot2_f32_bf16 v63, v45, v45, v63
    v_dot2_f32_bf16 v60, v46, v14, v60
    v_dot2_f32_bf16 v61, v46, v46, v61
    v_dot2_f32_bf16 v62, v47, v14, v62
    v_dot2_f32_bf16 v63, v47, v47, v63
    v_dot2_f32_bf16 v56, v192, v14, v56
    v_dot2_f32_bf16 v58, v200, v14, v58
    v_dot2_f32_bf16 v56, v193, v14, v56
    v_dot2_f32_bf16 v58, v201, v14, v58
    v_dot2_f32_bf16 v56, v194, v14, v56
    v_dot2_f32_bf16 v58, v202, v14, v58
    v_dot2_f32_bf16 v56, v195, v14, v56
    v_dot2_f32_bf16 v58, v203, v14, v58
    v_dot2_f32_bf16 v56, v208, v14, v56
    v_dot2_f32_bf16 v58, v216, v14, v58
    v_dot2_f32_bf16 v56, v209, v14, v56
    v_dot2_f32_bf16 v58, v217, v14, v58
    v_dot2_f32_bf16 v56, v210, v14, v56
    v_dot2_f32_bf16 v58, v218, v14, v58
    v_dot2_f32_bf16 v56, v211, v14, v56
    v_dot2_f32_bf16 v58, v219, v14, v58
    v_xor_b32 v48, 0x10000, v48
    v_xor_b32 v52, 0x10000, v52
    v_xor_b32 v8, 0x10000, v8
    v_xor_b32 v49, 0x10000, v49
    v_xor_b32 v53, 0x10000, v53
    v_xor_b32 v9, 0x10000, v9
    v_xor_b32 v50, 0x10000, v50
    v_xor_b32 v54, 0x10000, v54
    v_xor_b32 v10, 0x10000, v10
    v_xor_b32 v51, 0x10000, v51
    v_xor_b32 v55, 0x10000, v55
    v_xor_b32 v11, 0x10000, v11
    s_barrier
    v_mfma_f32_32x32x16_bf16 v[64:79], v[192:195], v[32:35], v[64:79]
    ds_read_b128 v[16:19], v48 offset:0
    ds_read_b128 v[20:23], v49 offset:0
    ds_read_b128 v[24:27], v50 offset:0
    v_mfma_f32_32x32x16_bf16 v[80:95], v[196:199], v[32:35], v[80:95]
    ds_read_b128 v[28:31], v51 offset:0
    ds_read_b64_tr_b16 v[128:129], v52 offset:0
    ds_read_b64_tr_b16 v[130:131], v52 offset:1024
    v_mfma_f32_32x32x16_bf16 v[96:111], v[200:203], v[32:35], v[96:111]
    ds_read_b64_tr_b16 v[136:137], v54 offset:0
    ds_read_b64_tr_b16 v[138:139], v54 offset:1024
    ds_read_b64_tr_b16 v[144:145], v52 offset:4096
    v_mfma_f32_32x32x16_bf16 v[112:127], v[204:207], v[32:35], v[112:127]
    ds_read_b64_tr_b16 v[146:147], v52 offset:5120
    ds_read_b64_tr_b16 v[152:153], v54 offset:4096
    ds_read_b64_tr_b16 v[154:155], v54 offset:5120
    v_mfma_f32_32x32x16_bf16 v[64:79], v[208:211], v[36:39], v[64:79]
    ds_read_b64_tr_b16 v[132:133], v53 offset:0
    ds_read_b64_tr_b16 v[134:135], v53 offset:1024
    ds_read_b64_tr_b16 v[140:141], v55 offset:0
    v_mfma_f32_32x32x16_bf16 v[80:95], v[212:215], v[36:39], v[80:95]
    ds_read_b64_tr_b16 v[142:143], v55 offset:1024
    ds_read_b64_tr_b16 v[148:149], v53 offset:4096
    ds_read_b64_tr_b16 v[150:151], v53 offset:5120
    v_mfma_f32_32x32x16_bf16 v[96:111], v[216:219], v[36:39], v[96:111]
    ds_read_b64_tr_b16 v[156:157], v55 offset:4096
    ds_read_b64_tr_b16 v[158:159], v55 offset:5120
    ds_read_b64_tr_b16 v[160:161], v8 offset:0
    v_mfma_f32_32x32x16_bf16 v[112:127], v[220:223], v[36:39], v[112:127]
    ds_read_b64_tr_b16 v[162:163], v8 offset:1024
    ds_read_b64_tr_b16 v[164:165], v9 offset:0
    ds_read_b64_tr_b16 v[166:167], v9 offset:1024
    v_mfma_f32_32x32x16_bf16 v[64:79], v[224:227], v[40:43], v[64:79]
    ds_read_b64_tr_b16 v[168:169], v10 offset:0
    ds_read_b64_tr_b16 v[170:171], v10 offset:1024
    ds_read_b64_tr_b16 v[172:173], v11 offset:0
    v_mfma_f32_32x32x16_bf16 v[80:95], v[228:231], v[40:43], v[80:95]
    ds_read_b64_tr_b16 v[174:175], v11 offset:1024
    ds_read_b64_tr_b16 v[176:177], v8 offset:4096
    ds_read_b64_tr_b16 v[178:179], v8 offset:5120
    v_mfma_f32_32x32x16_bf16 v[96:111], v[232:235], v[40:43], v[96:111]
    ds_read_b64_tr_b16 v[180:181], v9 offset:4096
    ds_read_b64_tr_b16 v[182:183], v9 offset:5120
    ds_read_b64_tr_b16 v[184:185], v10 offset:4096
    v_mfma_f32_32x32x16_bf16 v[112:127], v[236:239], v[40:43], v[112:127]
    ds_read_b64_tr_b16 v[186:187], v10 offset:5120
    ds_read_b64_tr_b16 v[188:189], v11 offset:4096
    ds_read_b64_tr_b16 v[190:191], v11 offset:5120
    v_mfma_f32_32x32x16_bf16 v[64:79], v[240:243], v[44:47], v[64:79]
    v_mfma_f32_32x32x16_bf16 v[80:95], v[244:247], v[44:47], v[80:95]
    v_mfma_f32_32x32x16_bf16 v[96:111], v[248:251], v[44:47], v[96:111]
    v_mfma_f32_32x32x16_bf16 v[112:127], v[252:255], v[44:47], v[112:127]
    s_add_u32 s50, s50, 1
    s_cmp_lt_u32 s50, 4
    s_cbranch_scc1 F1_loopT
    s_waitcnt lgkmcnt(0)
    s_and_b32 s45, s4, 1
    s_lshl_b32 s45, s45, 9
    s_lshr_b32 s51, s4, 1
    s_lshl_b32 s51, s51, 8
    s_add_u32 s51, s51, s45
    s_add_u32 s51, s51, 132096
    v_lshlrev_b32 v5, 2, v2
    v_add_u32 v6, s51, v5
    ds_write_b32 v6, v56
    ds_write_b32 v6, v58 offset:1024
    s_add_u32 s51, s45, 132096
    v_add_u32 v6, s51, v5
    s_xor_b32 s45, s45, 512
    s_add_u32 s51, s45, 132096
    v_add_u32 v7, s51, v5
    v_add_f32 v60, v60, v62
    v_add_f32 v61, v61, v63
    v_mov_b32 v62, v60
    v_mov_b32 v63, v61
    s_nop 0
    v_permlane32_swap_b32 v60, v62
    v_permlane32_swap_b32 v61, v63
    v_add_f32 v60, v60, v62
    v_add_f32 v61, v61, v63
    v_mul_f32 v60, 0xbb000000, v60
    v_mul_f32 v61, 0x3b000000, v61
    v_fma_f32 v61, -v60, v60, v61
    v_max_f32 v61, 0, v61
    v_add_f32 v13, 0x3727c5ac, v61
    v_rsq_f32 v12, v13
    v_cvt_pk_bf16_f32 v8, v60, v60
    v_and_b32 v62, 0xffff0000, v8
    v_sub_f32 v62, v60, v62
    v_cvt_pk_bf16_f32 v9, v60, v62
    v_and_b32 v63, 0xffff0000, v9
    v_sub_f32 v63, v62, v63
    v_cvt_pk_bf16_f32 v10, v62, v63
    v_mov_b32 v11, 0
    s_waitcnt lgkmcnt(0)
    s_barrier
    ds_read2st64_b32 v[16:17], v6 offset0:0 offset1:1
    ds_read2st64_b32 v[18:19], v7 offset0:0 offset1:1
    ds_read2st64_b32 v[20:21], v6 offset0:4 offset1:5
    ds_read2st64_b32 v[22:23], v7 offset0:4 offset1:5
    v_cmp_gt_u32 vcc, 32, v2
    s_waitcnt lgkmcnt(0)
    v_add_f32 v56, v16, v17
    v_mov_b32 v4, v56
    s_nop 1
    v_permlane32_swap_b32 v56, v4
    v_add_f32 v56, v56, v4
    v_cndmask_b32 v56, 0, v56, vcc
    v_cvt_pk_bf16_f32 v4, v56, v56
    v_and_b32 v4, 0xffff0000, v4
    v_sub_f32 v5, v56, v4
    v_cvt_pk_bf16_f32 v4, v5, v5
    v_and_b32 v4, 0xffff0000, v4
    v_sub_f32 v6, v5, v4
    v_cvt_pk_bf16_f32 v32, v56, v5
    v_cvt_pk_bf16_f32 v33, v6, v56
    v_cvt_pk_bf16_f32 v34, v5, v56
    v_mov_b32 v35, 0
    v_add_f32 v57, v18, v19
    v_mov_b32 v4, v57
    s_nop 1
    v_permlane32_swap_b32 v57, v4
    v_add_f32 v57, v57, v4
    v_cndmask_b32 v57, 0, v57, vcc
    v_cvt_pk_bf16_f32 v4, v57, v57
    v_and_b32 v4, 0xffff0000, v4
    v_sub_f32 v5, v57, v4
    v_cvt_pk_bf16_f32 v4, v5, v5
    v_and_b32 v4, 0xffff0000, v4
    v_sub_f32 v6, v5, v4
    v_cvt_pk_bf16_f32 v36, v57, v5
    v_cvt_pk_bf16_f32 v37, v6, v57
    v_cvt_pk_bf16_f32 v38, v5, v57
    v_mov_b32 v39, 0
    v_add_f32 v58, v20, v21
    v_mov_b32 v4, v58
    s_nop 1
    v_permlane32_swap_b32 v58, v4
    v_add_f32 v58, v58, v4
    v_cndmask_b32 v58, 0, v58, vcc
    v_cvt_pk_bf16_f32 v4, v58, v58
    v_and_b32 v4, 0xffff0000, v4
    v_sub_f32 v5, v58, v4
    v_cvt_pk_bf16_f32 v4, v5, v5
    v_and_b32 v4, 0xffff0000, v4
    v_sub_f32 v6, v5, v4
    v_cvt_pk_bf16_f32 v40, v58, v5
    v_cvt_pk_bf16_f32 v41, v6, v58
    v_cvt_pk_bf16_f32 v42, v5, v58
    v_mov_b32 v43, 0
    v_add_f32 v59, v22, v23
    v_mov_b32 v4, v59
    s_nop 1
    v_permlane32_swap_b32 v59, v4
    v_add_f32 v59, v59, v4
    v_cndmask_b32 v59, 0, v59, vcc
    v_cvt_pk_bf16_f32 v4, v59, v59
    v_and_b32 v4, 0xffff0000, v4
    v_sub_f32 v5, v59, v4
    v_cvt_pk_bf16_f32 v4, v5, v5
    v_and_b32 v4, 0xffff0000, v4
    v_sub_f32 v6, v5, v4
    v_cvt_pk_bf16_f32 v44, v59, v5
    v_cvt_pk_bf16_f32 v45, v6, v59
    v_cvt_pk_bf16_f32 v46, v5, v59
    v_mov_b32 v47, 0
    v_mfma_f32_32x32x16_bf16 v[64:79], v[32:35], v[8:11], v[64:79]
    v_mfma_f32_32x32x16_bf16 v[80:95], v[36:39], v[8:11], v[80:95]
    v_mfma_f32_32x32x16_bf16 v[96:111], v[40:43], v[8:11], v[96:111]
    v_mfma_f32_32x32x16_bf16 v[112:127], v[44:47], v[8:11], v[112:127]
    s_or_b32 s51, s7, s4
    s_cmp_lg_u32 s51, 0
    s_cbranch_scc1 F1_ncT
    s_mul_i32 s51, s6, 409600
    s_add_u32 s51, s51, 100352
    buffer_store_dwordx4 v[32:35], v3, s[8:11], s51 offen sc0 sc1
    s_add_u32 s51, s51, 102400
    buffer_store_dwordx4 v[36:39], v3, s[8:11], s51 offen sc0 sc1
    s_add_u32 s51, s51, 102400
    buffer_store_dwordx4 v[40:43], v3, s[8:11], s51 offen sc0 sc1
    s_add_u32 s51, s51, 102400
    buffer_store_dwordx4 v[44:47], v3, s[8:11], s51 offen sc0 sc1
    s_add_u32 s51, s51, 102400
F1_ncT:
    s_nop 1
    v_mul_f32 v15, 0x3fb8aa3b, v12
    s_lshl_b32 s17, s6, 13
    s_add_u32 s17, s17, s41
    s_add_u32 s17, s17, 16777216
    s_and_b32 s45, s4, 1
    s_lshl_b32 s45, s45, 11
    s_add_u32 s56, s17, s45
    s_xor_b32 s45, s45, 2048
    s_add_u32 s57, s17, s45
    s_add_u32 s58, s56, 4096
    s_add_u32 s59, s57, 4096
    v_mul_f32 v4, v15, v64
    v_mul_f32 v5, v15, v65
    v_mul_f32 v6, v15, v66
    v_mul_f32 v7, v15, v67
    v_min_f32 v4, 0, v4
    v_min_f32 v5, 0, v5
    v_min_f32 v6, 0, v6
    v_min_f32 v7, 0, v7
    v_exp_f32 v4, v4
    v_exp_f32 v5, v5
    v_exp_f32 v6, v6
    v_exp_f32 v7, v7
    v_max_f32 v64, 0, v64
    v_max_f32 v65, 0, v65
    v_max_f32 v66, 0, v66
    v_max_f32 v67, 0, v67
    v_add_f32 v4, 0x358637bd, v4
    v_add_f32 v5, 0x358637bd, v5
    v_add_f32 v6, 0x358637bd, v6
    v_add_f32 v7, 0x358637bd, v7
    v_fma_f32 v64, v64, v12, v4
    v_fma_f32 v65, v65, v12, v5
    v_fma_f32 v66, v66, v12, v6
    v_fma_f32 v67, v67, v12, v7
    v_mul_f32 v4, v15, v68
    v_mul_f32 v5, v15, v69
    v_mul_f32 v6, v15, v70
    v_mul_f32 v7, v15, v71
    v_min_f32 v4, 0, v4
    v_min_f32 v5, 0, v5
    v_min_f32 v6, 0, v6
    v_min_f32 v7, 0, v7
    v_exp_f32 v4, v4
    v_exp_f32 v5, v5
    v_exp_f32 v6, v6
    v_exp_f32 v7, v7
    v_max_f32 v68, 0, v68
    v_max_f32 v69, 0, v69
    v_max_f32 v70, 0, v70
    v_max_f32 v71, 0, v71
    v_add_f32 v4, 0x358637bd, v4
    v_add_f32 v5, 0x358637bd, v5
    v_add_f32 v6, 0x358637bd, v6
    v_add_f32 v7, 0x358637bd, v7
    v_fma_f32 v68, v68, v12, v4
    v_fma_f32 v69, v69, v12, v5
    v_fma_f32 v70, v70, v12, v6
    v_fma_f32 v71, v71, v12, v7
    v_mul_f32 v4, v15, v72
    v_mul_f32 v5, v15, v73
    v_mul_f32 v6, v15, v74
    v_mul_f32 v7, v15, v75
    v_min_f32 v4, 0, v4
    v_min_f32 v5, 0, v5
    v_min_f32 v6, 0, v6
    v_min_f32 v7, 0, v7
    v_exp_f32 v4, v4
    v_exp_f32 v5, v5
    v_exp_f32 v6, v6
    v_exp_f32 v7, v7
    v_max_f32 v72, 0, v72
    v_max_f32 v73, 0, v73
    v_max_f32 v74, 0, v74
    v_max_f32 v75, 0, v75
    v_add_f32 v4, 0x358637bd, v4
    v_add_f32 v5, 0x358637bd, v5
    v_add_f32 v6, 0x358637bd, v6
    v_add_f32 v7, 0x358637bd, v7
    v_fma_f32 v72, v72, v12, v4
    v_fma_f32 v73, v73, v12, v5
    v_fma_f32 v74, v74, v12, v6
    v_fma_f32 v75, v75, v12, v7
    v_mul_f32 v4, v15, v76
    v_mul_f32 v5, v15, v77
    v_mul_f32 v6, v15, v78
    v_mul_f32 v7, v15, v79
    v_min_f32 v4, 0, v4
    v_min_f32 v5, 0, v5
    v_min_f32 v6, 0, v6
    v_min_f32 v7, 0, v7
    v_exp_f32 v4, v4
    v_exp_f32 v5, v5
    v_exp_f32 v6, v6
    v_exp_f32 v7, v7
    v_max_f32 v76, 0, v76
    v_max_f32 v77, 0, v77
    v_max_f32 v78, 0, v78
    v_max_f32 v79, 0, v79
    v_add_f32 v4, 0x358637bd, v4
    v_add_f32 v5, 0x358637bd, v5
    v_add_f32 v6, 0x358637bd, v6
    v_add_f32 v7, 0x358637bd, v7
    v_fma_f32 v76, v76, v12, v4
    v_fma_f32 v77, v77, v12, v5
    v_fma_f32 v78, v78, v12, v6
    v_fma_f32 v79, v79, v12, v7
    v_cvt_pk_bf16_f32 v160, v64, v65
    v_cvt_pk_bf16_f32 v161, v66, v67
    v_cvt_pk_bf16_f32 v162, v68, v69
    v_cvt_pk_bf16_f32 v163, v70, v71
    v_cvt_pk_bf16_f32 v164, v72, v73
    v_cvt_pk_bf16_f32 v165, v74, v75
    v_cvt_pk_bf16_f32 v166, v76, v77
    v_cvt_pk_bf16_f32 v167, v78, v79
    buffer_store_dwordx4 v[160:163], v3, s[8:11], s56 offen sc0 sc1
    buffer_store_dwordx4 v[164:167], v3, s[8:11], s56 offen offset:1024 sc0 sc1
    v_mul_f32 v4, v15, v80
    v_mul_f32 v5, v15, v81
    v_mul_f32 v6, v15, v82
    v_mul_f32 v7, v15, v83
    v_min_f32 v4, 0, v4
    v_min_f32 v5, 0, v5
    v_min_f32 v6, 0, v6
    v_min_f32 v7, 0, v7
    v_exp_f32 v4, v4
    v_exp_f32 v5, v5
    v_exp_f32 v6, v6
    v_exp_f32 v7, v7
    v_max_f32 v80, 0, v80
    v_max_f32 v81, 0, v81
    v_max_f32 v82, 0, v82
    v_max_f32 v83, 0, v83
    v_add_f32 v4, 0x358637bd, v4
    v_add_f32 v5, 0x358637bd, v5
    v_add_f32 v6, 0x358637bd, v6
    v_add_f32 v7, 0x358637bd, v7
    v_fma_f32 v80, v80, v12, v4
    v_fma_f32 v81, v81, v12, v5
    v_fma_f32 v82, v82, v12, v6
    v_fma_f32 v83, v83, v12, v7
    v_mul_f32 v4, v15, v84
    v_mul_f32 v5, v15, v85
    v_mul_f32 v6, v15, v86
    v_mul_f32 v7, v15, v87
    v_min_f32 v4, 0, v4
    v_min_f32 v5, 0, v5
    v_min_f32 v6, 0, v6
    v_min_f32 v7, 0, v7
    v_exp_f32 v4, v4
    v_exp_f32 v5, v5
    v_exp_f32 v6, v6
    v_exp_f32 v7, v7
    v_max_f32 v84, 0, v84
    v_max_f32 v85, 0, v85
    v_max_f32 v86, 0, v86
    v_max_f32 v87, 0, v87
    v_add_f32 v4, 0x358637bd, v4
    v_add_f32 v5, 0x358637bd, v5
    v_add_f32 v6, 0x358637bd, v6
    v_add_f32 v7, 0x358637bd, v7
    v_fma_f32 v84, v84, v12, v4
    v_fma_f32 v85, v85, v12, v5
    v_fma_f32 v86, v86, v12, v6
    v_fma_f32 v87, v87, v12, v7
    v_mul_f32 v4, v15, v88
    v_mul_f32 v5, v15, v89
    v_mul_f32 v6, v15, v90
    v_mul_f32 v7, v15, v91
    v_min_f32 v4, 0, v4
    v_min_f32 v5, 0, v5
    v_min_f32 v6, 0, v6
    v_min_f32 v7, 0, v7
    v_exp_f32 v4, v4
    v_exp_f32 v5, v5
    v_exp_f32 v6, v6
    v_exp_f32 v7, v7
    v_max_f32 v88, 0, v88
    v_max_f32 v89, 0, v89
    v_max_f32 v90, 0, v90
    v_max_f32 v91, 0, v91
    v_add_f32 v4, 0x358637bd, v4
    v_add_f32 v5, 0x358637bd, v5
    v_add_f32 v6, 0x358637bd, v6
    v_add_f32 v7, 0x358637bd, v7
    v_fma_f32 v88, v88, v12, v4
    v_fma_f32 v89, v89, v12, v5
    v_fma_f32 v90, v90, v12, v6
    v_fma_f32 v91, v91, v12, v7
    v_mul_f32 v4, v15, v92
    v_mul_f32 v5, v15, v93
    v_mul_f32 v6, v15, v94
    v_mul_f32 v7, v15, v95
    v_min_f32 v4, 0, v4
    v_min_f32 v5, 0, v5
    v_min_f32 v6, 0, v6
    v_min_f32 v7, 0, v7
    v_exp_f32 v4, v4
    v_exp_f32 v5, v5
    v_exp_f32 v6, v6
    v_exp_f32 v7, v7
    v_max_f32 v92, 0, v92
    v_max_f32 v93, 0, v93
    v_max_f32 v94, 0, v94
    v_max_f32 v95, 0, v95
    v_add_f32 v4, 0x358637bd, v4
    v_add_f32 v5, 0x358637bd, v5
    v_add_f32 v6, 0x358637bd, v6
    v_add_f32 v7, 0x358637bd, v7
    v_fma_f32 v92, v92, v12, v4
    v_fma_f32 v93, v93, v12, v5
    v_fma_f32 v94, v94, v12, v6
    v_fma_f32 v95, v95, v12, v7
    v_cvt_pk_bf16_f32 v168, v80, v81
    v_cvt_pk_bf16_f32 v169, v82, v83
    v_cvt_pk_bf16_f32 v170, v84, v85
    v_cvt_pk_bf16_f32 v171, v86, v87
    v_cvt_pk_bf16_f32 v172, v88, v89
    v_cvt_pk_bf16_f32 v173, v90, v91
    v_cvt_pk_bf16_f32 v174, v92, v93
    v_cvt_pk_bf16_f32 v175, v94, v95
    buffer_store_dwordx4 v[168:171], v3, s[8:11], s57 offen sc0 sc1
    buffer_store_dwordx4 v[172:175], v3, s[8:11], s57 offen offset:1024 sc0 sc1
    v_mul_f32 v4, v15, v96
    v_mul_f32 v5, v15, v97
    v_mul_f32 v6, v15, v98
    v_mul_f32 v7, v15, v99
    v_min_f32 v4, 0, v4
    v_min_f32 v5, 0, v5
    v_min_f32 v6, 0, v6
    v_min_f32 v7, 0, v7
    v_exp_f32 v4, v4
    v_exp_f32 v5, v5
    v_exp_f32 v6, v6
    v_exp_f32 v7, v7
    v_max_f32 v96, 0, v96
    v_max_f32 v97, 0, v97
    v_max_f32 v98, 0, v98
    v_max_f32 v99, 0, v99
    v_add_f32 v4, 0x358637bd, v4
    v_add_f32 v5, 0x358637bd, v5
    v_add_f32 v6, 0x358637bd, v6
    v_add_f32 v7, 0x358637bd, v7
    v_fma_f32 v96, v96, v12, v4
    v_fma_f32 v97, v97, v12, v5
    v_fma_f32 v98, v98, v12, v6
    v_fma_f32 v99, v99, v12, v7
    v_mul_f32 v4, v15, v100
    v_mul_f32 v5, v15, v101
    v_mul_f32 v6, v15, v102
    v_mul_f32 v7, v15, v103
    v_min_f32 v4, 0, v4
    v_min_f32 v5, 0, v5
    v_min_f32 v6, 0, v6
    v_min_f32 v7, 0, v7
    v_exp_f32 v4, v4
    v_exp_f32 v5, v5
    v_exp_f32 v6, v6
    v_exp_f32 v7, v7
    v_max_f32 v100, 0, v100
    v_max_f32 v101, 0, v101
    v_max_f32 v102, 0, v102
    v_max_f32 v103, 0, v103
    v_add_f32 v4, 0x358637bd, v4
    v_add_f32 v5, 0x358637bd, v5
    v_add_f32 v6, 0x358637bd, v6
    v_add_f32 v7, 0x358637bd, v7
    v_fma_f32 v100, v100, v12, v4
    v_fma_f32 v101, v101, v12, v5
    v_fma_f32 v102, v102, v12, v6
    v_fma_f32 v103, v103, v12, v7
    v_mul_f32 v4, v15, v104
    v_mul_f32 v5, v15, v105
    v_mul_f32 v6, v15, v106
    v_mul_f32 v7, v15, v107
    v_min_f32 v4, 0, v4
    v_min_f32 v5, 0, v5
    v_min_f32 v6, 0, v6
    v_min_f32 v7, 0, v7
    v_exp_f32 v4, v4
    v_exp_f32 v5, v5
    v_exp_f32 v6, v6
    v_exp_f32 v7, v7
    v_max_f32 v104, 0, v104
    v_max_f32 v105, 0, v105
    v_max_f32 v106, 0, v106
    v_max_f32 v107, 0, v107
    v_add_f32 v4, 0x358637bd, v4
    v_add_f32 v5, 0x358637bd, v5
    v_add_f32 v6, 0x358637bd, v6
    v_add_f32 v7, 0x358637bd, v7
    v_fma_f32 v104, v104, v12, v4
    v_fma_f32 v105, v105, v12, v5
    v_fma_f32 v106, v106, v12, v6
    v_fma_f32 v107, v107, v12, v7
    v_mul_f32 v4, v15, v108
    v_mul_f32 v5, v15, v109
    v_mul_f32 v6, v15, v110
    v_mul_f32 v7, v15, v111
    v_min_f32 v4, 0, v4
    v_min_f32 v5, 0, v5
    v_min_f32 v6, 0, v6
    v_min_f32 v7, 0, v7
    v_exp_f32 v4, v4
    v_exp_f32 v5, v5
    v_exp_f32 v6, v6
    v_exp_f32 v7, v7
    v_max_f32 v108, 0, v108
    v_max_f32 v109, 0, v109
    v_max_f32 v110, 0, v110
    v_max_f32 v111, 0, v111
    v_add_f32 v4, 0x358637bd, v4
    v_add_f32 v5, 0x358637bd, v5
    v_add_f32 v6, 0x358637bd, v6
    v_add_f32 v7, 0x358637bd, v7
    v_fma_f32 v108, v108, v12, v4
    v_fma_f32 v109, v109, v12, v5
    v_fma_f32 v110, v110, v12, v6
    v_fma_f32 v111, v111, v12, v7
    v_cvt_pk_bf16_f32 v176, v96, v97
    v_cvt_pk_bf16_f32 v177, v98, v99
    v_cvt_pk_bf16_f32 v178, v100, v101
    v_cvt_pk_bf16_f32 v179, v102, v103
    v_cvt_pk_bf16_f32 v180, v104, v105
    v_cvt_pk_bf16_f32 v181, v106, v107
    v_cvt_pk_bf16_f32 v182, v108, v109
    v_cvt_pk_bf16_f32 v183, v110, v111
    buffer_store_dwordx4 v[176:179], v3, s[8:11], s58 offen sc0 sc1
    buffer_store_dwordx4 v[180:183], v3, s[8:11], s58 offen offset:1024 sc0 sc1
    v_mul_f32 v4, v15, v112
    v_mul_f32 v5, v15, v113
    v_mul_f32 v6, v15, v114
    v_mul_f32 v7, v15, v115
    v_min_f32 v4, 0, v4
    v_min_f32 v5, 0, v5
    v_min_f32 v6, 0, v6
    v_min_f32 v7, 0, v7
    v_exp_f32 v4, v4
    v_exp_f32 v5, v5
    v_exp_f32 v6, v6
    v_exp_f32 v7, v7
    v_max_f32 v112, 0, v112
    v_max_f32 v113, 0, v113
    v_max_f32 v114, 0, v114
    v_max_f32 v115, 0, v115
    v_add_f32 v4, 0x358637bd, v4
    v_add_f32 v5, 0x358637bd, v5
    v_add_f32 v6, 0x358637bd, v6
    v_add_f32 v7, 0x358637bd, v7
    v_fma_f32 v112, v112, v12, v4
    v_fma_f32 v113, v113, v12, v5
    v_fma_f32 v114, v114, v12, v6
    v_fma_f32 v115, v115, v12, v7
    v_mul_f32 v4, v15, v116
    v_mul_f32 v5, v15, v117
    v_mul_f32 v6, v15, v118
    v_mul_f32 v7, v15, v119
    v_min_f32 v4, 0, v4
    v_min_f32 v5, 0, v5
    v_min_f32 v6, 0, v6
    v_min_f32 v7, 0, v7
    v_exp_f32 v4, v4
    v_exp_f32 v5, v5
    v_exp_f32 v6, v6
    v_exp_f32 v7, v7
    v_max_f32 v116, 0, v116
    v_max_f32 v117, 0, v117
    v_max_f32 v118, 0, v118
    v_max_f32 v119, 0, v119
    v_add_f32 v4, 0x358637bd, v4
    v_add_f32 v5, 0x358637bd, v5
    v_add_f32 v6, 0x358637bd, v6
    v_add_f32 v7, 0x358637bd, v7
    v_fma_f32 v116, v116, v12, v4
    v_fma_f32 v117, v117, v12, v5
    v_fma_f32 v118, v118, v12, v6
    v_fma_f32 v119, v119, v12, v7
    v_mul_f32 v4, v15, v120
    v_mul_f32 v5, v15, v121
    v_mul_f32 v6, v15, v122
    v_mul_f32 v7, v15, v123
    v_min_f32 v4, 0, v4
    v_min_f32 v5, 0, v5
    v_min_f32 v6, 0, v6
    v_min_f32 v7, 0, v7
    v_exp_f32 v4, v4
    v_exp_f32 v5, v5
    v_exp_f32 v6, v6
    v_exp_f32 v7, v7
    v_max_f32 v120, 0, v120
    v_max_f32 v121, 0, v121
    v_max_f32 v122, 0, v122
    v_max_f32 v123, 0, v123
    v_add_f32 v4, 0x358637bd, v4
    v_add_f32 v5, 0x358637bd, v5
    v_add_f32 v6, 0x358637bd, v6
    v_add_f32 v7, 0x358637bd, v7
    v_fma_f32 v120, v120, v12, v4
    v_fma_f32 v121, v121, v12, v5
    v_fma_f32 v122, v122, v12, v6
    v_fma_f32 v123, v123, v12, v7
    v_mul_f32 v4, v15, v124
    v_mul_f32 v5, v15, v125
    v_mul_f32 v6, v15, v126
    v_mul_f32 v7, v15, v127
    v_min_f32 v4, 0, v4
    v_min_f32 v5, 0, v5
    v_min_f32 v6, 0, v6
    v_min_f32 v7, 0, v7
    v_exp_f32 v4, v4
    v_exp_f32 v5, v5
    v_exp_f32 v6, v6
    v_exp_f32 v7, v7
    v_max_f32 v124, 0, v124
    v_max_f32 v125, 0, v125
    v_max_f32 v126, 0, v126
    v_max_f32 v127, 0, v127
    v_add_f32 v4, 0x358637bd, v4
    v_add_f32 v5, 0x358637bd, v5
    v_add_f32 v6, 0x358637bd, v6
    v_add_f32 v7, 0x358637bd, v7
    v_fma_f32 v124, v124, v12, v4
    v_fma_f32 v125, v125, v12, v5
    v_fma_f32 v126, v126, v12, v6
    v_fma_f32 v127, v127, v12, v7
    v_cvt_pk_bf16_f32 v184, v112, v113
    v_cvt_pk_bf16_f32 v185, v114, v115
    v_cvt_pk_bf16_f32 v186, v116, v117
    v_cvt_pk_bf16_f32 v187, v118, v119
    v_cvt_pk_bf16_f32 v188, v120, v121
    v_cvt_pk_bf16_f32 v189, v122, v123
    v_cvt_pk_bf16_f32 v190, v124, v125
    v_cvt_pk_bf16_f32 v191, v126, v127
    buffer_store_dwordx4 v[184:187], v3, s[8:11], s59 offen sc0 sc1
    buffer_store_dwordx4 v[188:191], v3, s[8:11], s59 offen offset:1024 sc0 sc1
    s_endpgm
F1_pack:
    s_mov_b32 s44, 0
    s_sub_u32 s5, s2, 192
    s_lshl_b32 s6, s3, 14
    s_mov_b32 s12, s18
    s_mov_b32 s13, s19
    s_mov_b32 s14, 1572864
    s_lshl_b32 s40, s5, 3
    s_add_u32 s40, s40, s3
    s_mul_i32 s40, s40, 3072
    v_lshrrev_b32 v115, 3, v2
    v_lshlrev_b32 v115, 10, v115
    v_and_b32 v5, 7, v2
    v_lshlrev_b32 v5, 4, v5
    v_add_u32 v115, v115, v5
    v_lshrrev_b32 v5, 5, v2
    v_lshlrev_b32 v5, 2, v5
    v_bfe_u32 v6, v2, 2, 2
    v_add_u32 v5, v5, v6
    v_lshlrev_b32 v5, 7, v5
    v_bfe_u32 v6, v2, 4, 1
    v_lshlrev_b32 v6, 5, v6
    v_add_u32 v5, v5, v6
    v_and_b32 v6, 3, v2
    v_lshlrev_b32 v6, 3, v6
    v_add_u32 v5, v5, v6
    v_add_u32 v116, s6, v5
    s_mov_b32 s19, 0x20000
    s_lshl_b32 s35, s5, 2
    s_add_u32 s35, s35, s3
    s_cmp_ge_u32 s5, 56
    s_cbranch_scc1 F1_zero
    s_waitcnt vmcnt(0)
    s_and_b32 s7, s5, 1
    s_lshr_b32 s5, s5, 1
    s_lshl_b32 s48, s7, 3
    s_add_u32 s48, s48, s3
F1_gu:
    s_mov_b32 s12, s24
    s_mov_b32 s13, s25
    s_mov_b32 s14, 1835008
    s_mov_b32 s36, s26
    s_mov_b32 s37, s27
    s_mov_b32 s38, 1835008
    s_mul_i32 s47, s48, 114688
    s_lshl_b32 s43, s5, 7
    s_add_u32 s47, s47, s43
    v_lshrrev_b32 v4, 3, v2
    v_mul_u32_u24 v4, 3584, v4
    v_and_b32 v5, 7, v2
    v_lshlrev_b32 v5, 4, v5
    v_add_u32 v4, v4, v5
    s_add_u32 s49, s6, 0
    s_mov_b32 m0, s49
    s_add_u32 s50, s49, 4096
    buffer_load_dwordx4 v4, s[12:15], s47 offen lds
    s_mov_b32 m0, s50
    s_nop 0
    buffer_load_dwordx4 v4, s[36:39], s47 offen lds
    s_add_u32 s47, s47, 28672
    s_add_u32 s49, s6, 1024
    s_mov_b32 m0, s49
    s_add_u32 s50, s49, 4096
    buffer_load_dwordx4 v4, s[12:15], s47 offen lds
    s_mov_b32 m0, s50
    s_nop 0
    buffer_load_dwordx4 v4, s[36:39], s47 offen lds
    s_add_u32 s47, s47, 28672
    s_add_u32 s49, s6, 2048
    s_mov_b32 m0, s49
    s_add_u32 s50, s49, 4096
    buffer_load_dwordx4 v4, s[12:15], s47 offen lds
    s_mov_b32 m0, s50
    s_nop 0
    buffer_load_dwordx4 v4, s[36:39], s47 offen lds
    s_add_u32 s47, s47, 28672
    s_add_u32 s49, s6, 3072
    s_mov_b32 m0, s49
    s_add_u32 s50, s49, 4096
    buffer_load_dwordx4 v4, s[12:15], s47 offen lds
    s_mov_b32 m0, s50
    s_nop 0
    buffer_load_dwordx4 v4, s[36:39], s47 offen lds
    s_add_u32 s47, s47, 28672
    s_mov_b32 s16, s28
    s_mov_b32 s17, s29
    s_mov_b32 s18, 1835008
    s_cmp_ge_u32 s3, 4
    s_cbranch_scc1 F1_nw
    s_and_b32 s32, s35, 7
    s_lshr_b32 s35, s35, 3
    s_lshl_b32 s30, s35, 16
    s_lshl_b32 s31, s32, 7
    s_add_u32 s30, s30, s31
    s_mul_i32 s33, s32, 112
    s_lshl_b32 s35, s35, 2
    s_add_u32 s33, s33, s35
    s_lshl_b32 s33, s33, 11
    s_add_u32 s33, s33, 5963776
    s_add_u32 s31, s6, 8192
    s_mov_b32 m0, s31
    s_add_u32 s31, s31, 1024
    buffer_load_dwordx4 v115, s[16:19], s30 offen lds
    s_add_u32 s30, s30, 8192
    s_mov_b32 m0, s31
    s_add_u32 s31, s31, 1024
    buffer_load_dwordx4 v115, s[16:19], s30 offen lds
    s_add_u32 s30, s30, 8192
    s_mov_b32 m0, s31
    s_add_u32 s31, s31, 1024
    buffer_load_dwordx4 v115, s[16:19], s30 offen lds
    s_add_u32 s30, s30, 8192
    s_mov_b32 m0, s31
    s_add_u32 s31, s31, 1024
    buffer_load_dwordx4 v115, s[16:19], s30 offen lds
    s_add_u32 s30, s30, 8192
    s_mov_b32 m0, s31
    s_add_u32 s31, s31, 1024
    buffer_load_dwordx4 v115, s[16:19], s30 offen lds
    s_add_u32 s30, s30, 8192
    s_mov_b32 m0, s31
    s_add_u32 s31, s31, 1024
    buffer_load_dwordx4 v115, s[16:19], s30 offen lds
    s_add_u32 s30, s30, 8192
    s_mov_b32 m0, s31
    s_add_u32 s31, s31, 1024
    buffer_load_dwordx4 v115, s[16:19], s30 offen lds
    s_add_u32 s30, s30, 8192
    s_mov_b32 m0, s31
    s_add_u32 s31, s31, 1024
    buffer_load_dwordx4 v115, s[16:19], s30 offen lds
    s_add_u32 s30, s30, 8192
    s_waitcnt vmcnt(8)
    s_branch F1_nw2
F1_nw:
    s_waitcnt vmcnt(0)
F1_nw2:
    v_lshrrev_b32 v5, 5, v2
    v_lshlrev_b32 v5, 2, v5
    v_bfe_u32 v6, v2, 2, 2
    v_add_u32 v5, v5, v6
    v_bfe_u32 v6, v2, 4, 1
    v_lshlrev_b32 v6, 5, v6
    v_add_u32 v5, v5, v6
    v_lshlrev_b32 v5, 7, v5
    v_and_b32 v6, 3, v2
    v_lshlrev_b32 v6, 3, v6
    v_add_u32 v5, v5, v6
    v_add_u32 v5, s6, v5
    s_lshl_b32 s42, s48, 1
    v_mov_b32 v7, 0x3f803f80
    v_mov_b32 v8, 0
    v_mov_b32 v9, 0
    v_mov_b32 v10, 0
    v_mov_b32 v11, 0
    s_lshl_b32 s43, s5, 2
    s_add_u32 s43, s43, 0
    s_mul_i32 s40, s43, 9363
    s_lshr_b32 s40, s40, 16
    s_mul_i32 s45, s40, 7
    s_sub_u32 s45, s43, s45
    s_mul_i32 s41, s45, 33
    s_cmp_lt_u32 s45, 4
    s_cselect_b32 s41, s45, s41
    s_cselect_b32 s46, 4, 1
    s_lshl_b32 s41, s41, 10
    s_lshl_b32 s60, s46, 10
    s_mul_i32 s40, s40, 237568
    s_add_u32 s41, s41, s40
    s_add_u32 s41, s41, 2162688
    s_mul_i32 s46, s60, s42
    s_add_u32 s56, s41, s46
    s_lshl_b32 s46, s60, 5
    s_add_u32 s41, s41, s46
    s_cmp_eq_u32 s4, 0
    s_cselect_b32 s51, s41, s51
    s_lshl_b32 s43, s5, 2
    s_add_u32 s43, s43, 1
    s_mul_i32 s40, s43, 9363
    s_lshr_b32 s40, s40, 16
    s_mul_i32 s45, s40, 7
    s_sub_u32 s45, s43, s45
    s_mul_i32 s41, s45, 33
    s_cmp_lt_u32 s45, 4
    s_cselect_b32 s41, s45, s41
    s_cselect_b32 s46, 4, 1
    s_lshl_b32 s41, s41, 10
    s_lshl_b32 s61, s46, 10
    s_mul_i32 s40, s40, 237568
    s_add_u32 s41, s41, s40
    s_add_u32 s41, s41, 2162688
    s_mul_i32 s46, s61, s42
    s_add_u32 s57, s41, s46
    s_lshl_b32 s46, s61, 5
    s_add_u32 s41, s41, s46
    s_cmp_eq_u32 s4, 1
    s_cselect_b32 s51, s41, s51
    s_lshl_b32 s43, s5, 2
    s_add_u32 s43, s43, 2
    s_mul_i32 s40, s43, 9363
    s_lshr_b32 s40, s40, 16
    s_mul_i32 s45, s40, 7
    s_sub_u32 s45, s43, s45
    s_mul_i32 s41, s45, 33
    s_cmp_lt_u32 s45, 4
    s_cselect_b32 s41, s45, s41
    s_cselect_b32 s46, 4, 1
    s_lshl_b32 s41, s41, 10
    s_lshl_b32 s62, s46, 10
    s_mul_i32 s40, s40, 237568
    s_add_u32 s41, s41, s40
    s_add_u32 s41, s41, 2162688
    s_mul_i32 s46, s62, s42
    s_add_u32 s58, s41, s46
    s_lshl_b32 s46, s62, 5
    s_add_u32 s41, s41, s46
    s_cmp_eq_u32 s4, 2
    s_cselect_b32 s51, s41, s51
    s_lshl_b32 s43, s5, 2
    s_add_u32 s43, s43, 3
    s_mul_i32 s40, s43, 9363
    s_lshr_b32 s40, s40, 16
    s_mul_i32 s45, s40, 7
    s_sub_u32 s45, s43, s45
    s_mul_i32 s41, s45, 33
    s_cmp_lt_u32 s45, 4
    s_cselect_b32 s41, s45, s41
    s_cselect_b32 s46, 4, 1
    s_lshl_b32 s41, s41, 10
    s_lshl_b32 s63, s46, 10
    s_mul_i32 s40, s40, 237568
    s_add_u32 s41, s41, s40
    s_add_u32 s41, s41, 2162688
    s_mul_i32 s46, s63, s42
    s_add_u32 s59, s41, s46
    s_lshl_b32 s46, s63, 5
    s_add_u32 s41, s41, s46
    s_cmp_eq_u32 s4, 3
    s_cselect_b32 s51, s41, s51
    ds_read_b64_tr_b16 v[16:17], v5 offset:0
    ds_read_b64_tr_b16 v[18:19], v5 offset:1024
    ds_read_b64_tr_b16 v[20:21], v5 offset:2048
    ds_read_b64_tr_b16 v[22:23], v5 offset:3072
    ds_read_b64_tr_b16 v[24:25], v5 offset:32
    ds_read_b64_tr_b16 v[26:27], v5 offset:1056
    ds_read_b64_tr_b16 v[28:29], v5 offset:2080
    ds_read_b64_tr_b16 v[30:31], v5 offset:3104
    ds_read_b64_tr_b16 v[32:33], v5 offset:64
    ds_read_b64_tr_b16 v[34:35], v5 offset:1088
    ds_read_b64_tr_b16 v[36:37], v5 offset:2112
    ds_read_b64_tr_b16 v[38:39], v5 offset:3136
    ds_read_b64_tr_b16 v[40:41], v5 offset:96
    ds_read_b64_tr_b16 v[42:43], v5 offset:1120
    ds_read_b64_tr_b16 v[44:45], v5 offset:2144
    ds_read_b64_tr_b16 v[46:47], v5 offset:3168
    s_waitcnt lgkmcnt(0)
    buffer_store_dwordx4 v[16:19], v3, s[8:11], s56 offen sc0 sc1
    s_add_u32 s56, s56, s60
    buffer_store_dwordx4 v[20:23], v3, s[8:11], s56 offen sc0 sc1
    s_add_u32 s56, s56, s60
    buffer_store_dwordx4 v[24:27], v3, s[8:11], s57 offen sc0 sc1
    s_add_u32 s57, s57, s61
    buffer_store_dwordx4 v[28:31], v3, s[8:11], s57 offen sc0 sc1
    s_add_u32 s57, s57, s61
    buffer_store_dwordx4 v[32:35], v3, s[8:11], s58 offen sc0 sc1
    s_add_u32 s58, s58, s62
    buffer_store_dwordx4 v[36:39], v3, s[8:11], s58 offen sc0 sc1
    s_add_u32 s58, s58, s62
    buffer_store_dwordx4 v[40:43], v3, s[8:11], s59 offen sc0 sc1
    s_add_u32 s59, s59, s63
    buffer_store_dwordx4 v[44:47], v3, s[8:11], s59 offen sc0 sc1
    s_add_u32 s59, s59, s63
    v_dot2_f32_bf16 v8, v16, v7, v8
    v_dot2_f32_bf16 v8, v17, v7, v8
    v_dot2_f32_bf16 v8, v18, v7, v8
    v_dot2_f32_bf16 v8, v19, v7, v8
    v_dot2_f32_bf16 v8, v20, v7, v8
    v_dot2_f32_bf16 v8, v21, v7, v8
    v_dot2_f32_bf16 v8, v22, v7, v8
    v_dot2_f32_bf16 v8, v23, v7, v8
    v_dot2_f32_bf16 v9, v24, v7, v9
    v_dot2_f32_bf16 v9, v25, v7, v9
    v_dot2_f32_bf16 v9, v26, v7, v9
    v_dot2_f32_bf16 v9, v27, v7, v9
    v_dot2_f32_bf16 v9, v28, v7, v9
    v_dot2_f32_bf16 v9, v29, v7, v9
    v_dot2_f32_bf16 v9, v30, v7, v9
    v_dot2_f32_bf16 v9, v31, v7, v9
    v_dot2_f32_bf16 v10, v32, v7, v10
    v_dot2_f32_bf16 v10, v33, v7, v10
    v_dot2_f32_bf16 v10, v34, v7, v10
    v_dot2_f32_bf16 v10, v35, v7, v10
    v_dot2_f32_bf16 v10, v36, v7, v10
    v_dot2_f32_bf16 v10, v37, v7, v10
    v_dot2_f32_bf16 v10, v38, v7, v10
    v_dot2_f32_bf16 v10, v39, v7, v10
    v_dot2_f32_bf16 v11, v40, v7, v11
    v_dot2_f32_bf16 v11, v41, v7, v11
    v_dot2_f32_bf16 v11, v42, v7, v11
    v_dot2_f32_bf16 v11, v43, v7, v11
    v_dot2_f32_bf16 v11, v44, v7, v11
    v_dot2_f32_bf16 v11, v45, v7, v11
    v_dot2_f32_bf16 v11, v46, v7, v11
    v_dot2_f32_bf16 v11, v47, v7, v11
F1_cs:
    s_lshl_b32 s40, s3, 10
    s_add_u32 s40, s40, 131072
    v_lshlrev_b32 v5, 2, v2
    v_add_u32 v6, s40, v5
    ds_write_b32 v6, v8
    ds_write_b32 v6, v9 offset:256
    ds_write_b32 v6, v10 offset:512
    ds_write_b32 v6, v11 offset:768
    s_waitcnt lgkmcnt(0)
    s_barrier
    s_cmp_ge_u32 s3, 4
    s_cbranch_scc1 F1_pend
    s_waitcnt vmcnt(8)
    ds_read_b64_tr_b16 v[128:129], v116 offset:8192
    ds_read_b64_tr_b16 v[130:131], v116 offset:9216
    ds_read_b64_tr_b16 v[132:133], v116 offset:8256
    ds_read_b64_tr_b16 v[134:135], v116 offset:9280
    ds_read_b64_tr_b16 v[136:137], v116 offset:10240
    ds_read_b64_tr_b16 v[138:139], v116 offset:11264
    ds_read_b64_tr_b16 v[140:141], v116 offset:10304
    ds_read_b64_tr_b16 v[142:143], v116 offset:11328
    ds_read_b64_tr_b16 v[144:145], v116 offset:12288
    ds_read_b64_tr_b16 v[146:147], v116 offset:13312
    ds_read_b64_tr_b16 v[148:149], v116 offset:12352
    ds_read_b64_tr_b16 v[150:151], v116 offset:13376
    ds_read_b64_tr_b16 v[152:153], v116 offset:14336
    ds_read_b64_tr_b16 v[154:155], v116 offset:15360
    ds_read_b64_tr_b16 v[156:157], v116 offset:14400
    ds_read_b64_tr_b16 v[158:159], v116 offset:15424
    s_waitcnt lgkmcnt(0)
    s_add_u32 s32, s33, 4096
    buffer_store_dwordx4 v[128:131], v3, s[8:11], s33 offen offset:0 sc0 sc1
    buffer_store_dwordx4 v[132:135], v3, s[8:11], s33 offen offset:1024 sc0 sc1
    buffer_store_dwordx4 v[136:139], v3, s[8:11], s33 offen offset:2048 sc0 sc1
    buffer_store_dwordx4 v[140:143], v3, s[8:11], s33 offen offset:3072 sc0 sc1
    buffer_store_dwordx4 v[144:147], v3, s[8:11], s32 offen offset:0 sc0 sc1
    buffer_store_dwordx4 v[148:151], v3, s[8:11], s32 offen offset:1024 sc0 sc1
    buffer_store_dwordx4 v[152:155], v3, s[8:11], s32 offen offset:2048 sc0 sc1
    buffer_store_dwordx4 v[156:159], v3, s[8:11], s32 offen offset:3072 sc0 sc1
    s_lshl_b32 s40, s3, 8
    s_add_u32 s40, s40, 131072
    v_add_u32 v6, s40, v5
    ds_read_b32 v80, v6 offset:0
    ds_read_b32 v81, v6 offset:1024
    ds_read_b32 v82, v6 offset:2048
    ds_read_b32 v83, v6 offset:3072
    ds_read_b32 v84, v6 offset:4096
    ds_read_b32 v85, v6 offset:5120
    ds_read_b32 v86, v6 offset:6144
    ds_read_b32 v87, v6 offset:7168
    s_waitcnt lgkmcnt(0)
    v_add_f32 v80, v80, v84
    v_add_f32 v81, v81, v85
    v_add_f32 v82, v82, v86
    v_add_f32 v83, v83, v87
    v_add_f32 v80, v80, v82
    v_add_f32 v81, v81, v83
    v_add_f32 v80, v80, v81
    v_cmp_gt_u32 vcc, 32, v2
    v_mov_b32 v4, v80
    s_nop 1
    v_permlane32_swap_b32 v80, v4
    v_add_f32 v80, v80, v4
    s_lshl_b32 s40, s7, 9
    s_add_u32 s51, s51, s40
    v_cvt_pk_bf16_f32 v4, v80, v80
    v_and_b32 v4, 0xffff0000, v4
    v_sub_f32 v5, v80, v4
    v_cvt_pk_bf16_f32 v4, v5, v5
    v_and_b32 v4, 0xffff0000, v4
    v_sub_f32 v6, v5, v4
    v_cvt_pk_bf16_f32 v84, v80, v5
    v_cvt_pk_bf16_f32 v85, v6, v80
    v_cvt_pk_bf16_f32 v86, v5, v80
    v_mov_b32 v87, 0
    s_mov_b64 exec, 0xffffffff
    buffer_store_dwordx4 v[84:87], v3, s[8:11], s51 offen sc0 sc1
    s_mov_b64 exec, -1
F1_pend:
    s_endpgm
F1_zero:
    s_sub_u32 s40, s5, 56
    s_lshl_b32 s35, s40, 3
    s_add_u32 s35, s35, s3
    s_mov_b32 s16, s20
    s_mov_b32 s17, s21
    s_mov_b32 s18, 524288
    s_cmp_ge_u32 s5, 61
    s_cbranch_scc1 F1_nz
    s_lshl_b32 s43, s40, 15
    s_add_u32 s43, s43, 27262976
    v_lshlrev_b32 v4, 4, v0
    v_mov_b32 v20, 0
    v_mov_b32 v21, 0
    v_mov_b32 v22, 0
    v_mov_b32 v23, 0
    buffer_store_dwordx4 v[20:23], v4, s[8:11], s43 offen sc0 sc1
    s_add_u32 s43, s43, 8192
    buffer_store_dwordx4 v[20:23], v4, s[8:11], s43 offen sc0 sc1
    s_add_u32 s43, s43, 8192
    buffer_store_dwordx4 v[20:23], v4, s[8:11], s43 offen sc0 sc1
    s_add_u32 s43, s43, 8192
    buffer_store_dwordx4 v[20:23], v4, s[8:11], s43 offen sc0 sc1
    s_add_u32 s43, s43, 8192
    s_waitcnt vmcnt(0)
    s_barrier
    s_cmp_ge_u32 s40, 2
    s_cbranch_scc1 F1_nz
    s_cmp_lg_u32 s3, 0
    s_cbranch_scc1 F1_nz
    v_mov_b32 v21, 1
    s_mov_b64 exec, 1
    buffer_atomic_add v21, v20, s[52:55], 0 offen sc1
    s_mov_b64 exec, -1
F1_nz:
    s_and_b32 s32, s35, 7
    s_lshr_b32 s35, s35, 3
    s_lshl_b32 s30, s35, 16
    s_lshl_b32 s31, s32, 7
    s_add_u32 s30, s30, s31
    s_mul_i32 s33, s32, 32
    s_lshl_b32 s35, s35, 2
    s_add_u32 s33, s33, s35
    s_lshl_b32 s33, s33, 11
    s_add_u32 s33, s33, 1638400
    s_add_u32 s31, s6, 8192
    s_mov_b32 m0, s31
    s_add_u32 s31, s31, 1024
    buffer_load_dwordx4 v115, s[16:19], s30 offen lds
    s_add_u32 s30, s30, 8192
    s_mov_b32 m0, s31
    s_add_u32 s31, s31, 1024
    buffer_load_dwordx4 v115, s[16:19], s30 offen lds
    s_add_u32 s30, s30, 8192
    s_mov_b32 m0, s31
    s_add_u32 s31, s31, 1024
    buffer_load_dwordx4 v115, s[16:19], s30 offen lds
    s_add_u32 s30, s30, 8192
    s_mov_b32 m0, s31
    s_add_u32 s31, s31, 1024
    buffer_load_dwordx4 v115, s[16:19], s30 offen lds
    s_add_u32 s30, s30, 8192
    s_mov_b32 m0, s31
    s_add_u32 s31, s31, 1024
    buffer_load_dwordx4 v115, s[16:19], s30 offen lds
    s_add_u32 s30, s30, 8192
    s_mov_b32 m0, s31
    s_add_u32 s31, s31, 1024
    buffer_load_dwordx4 v115, s[16:19], s30 offen lds
    s_add_u32 s30, s30, 8192
    s_mov_b32 m0, s31
    s_add_u32 s31, s31, 1024
    buffer_load_dwordx4 v115, s[16:19], s30 offen lds
    s_add_u32 s30, s30, 8192
    s_mov_b32 m0, s31
    s_add_u32 s31, s31, 1024
    buffer_load_dwordx4 v115, s[16:19], s30 offen lds
    s_add_u32 s30, s30, 8192
    s_waitcnt vmcnt(0)
    ds_read_b64_tr_b16 v[128:129], v116 offset:8192
    ds_read_b64_tr_b16 v[130:131], v116 offset:9216
    ds_read_b64_tr_b16 v[132:133], v116 offset:8256
    ds_read_b64_tr_b16 v[134:135], v116 offset:9280
    ds_read_b64_tr_b16 v[136:137], v116 offset:10240
    ds_read_b64_tr_b16 v[138:139], v116 offset:11264
    ds_read_b64_tr_b16 v[140:141], v116 offset:10304
    ds_read_b64_tr_b16 v[142:143], v116 offset:11328
    ds_read_b64_tr_b16 v[144:145], v116 offset:12288
    ds_read_b64_tr_b16 v[146:147], v116 offset:13312
    ds_read_b64_tr_b16 v[148:149], v116 offset:12352
    ds_read_b64_tr_b16 v[150:151], v116 offset:13376
    ds_read_b64_tr_b16 v[152:153], v116 offset:14336
    ds_read_b64_tr_b16 v[154:155], v116 offset:15360
    ds_read_b64_tr_b16 v[156:157], v116 offset:14400
    ds_read_b64_tr_b16 v[158:159], v116 offset:15424
    s_waitcnt lgkmcnt(0)
    s_add_u32 s32, s33, 4096
    buffer_store_dwordx4 v[128:131], v3, s[8:11], s33 offen offset:0 sc0 sc1
    buffer_store_dwordx4 v[132:135], v3, s[8:11], s33 offen offset:1024 sc0 sc1
    buffer_store_dwordx4 v[136:139], v3, s[8:11], s33 offen offset:2048 sc0 sc1
    buffer_store_dwordx4 v[140:143], v3, s[8:11], s33 offen offset:3072 sc0 sc1
    buffer_store_dwordx4 v[144:147], v3, s[8:11], s32 offen offset:0 sc0 sc1
    buffer_store_dwordx4 v[148:151], v3, s[8:11], s32 offen offset:1024 sc0 sc1
    buffer_store_dwordx4 v[152:155], v3, s[8:11], s32 offen offset:2048 sc0 sc1
    buffer_store_dwordx4 v[156:159], v3, s[8:11], s32 offen offset:3072 sc0 sc1
F1_done:
    s_endpgm
.globl fk_kernel
.p2align 8
.type fk_kernel,@function
fk_kernel:
    s_mov_b32 s40, 18874368
    s_mov_b32 s41, 27262976
    s_mov_b32 s42, 10485760
    s_mov_b32 s43, 0
    s_mov_b32 s44, 2
    s_mov_b32 s45, 12582912
    s_mov_b32 s48, 27394048
    s_mov_b32 s49, 16777216
    s_cmp_ge_u32 s2, 256
    s_cbranch_scc1 FK_done
    s_load_dwordx2 s[32:33], s[0:1], 72
    s_load_dwordx2 s[34:35], s[0:1], 56
    v_lshrrev_b32 v1, 6, v0
    v_and_b32 v2, 63, v0
    v_readfirstlane_b32 s3, v1
    v_lshlrev_b32 v3, 4, v2
    s_and_b32 s4, s3, 3
    s_load_dwordx2 s[46:47], s[0:1], 0
    s_and_b32 s5, s2, 7
    s_lshr_b32 s6, s2, 3
    s_lshl_b32 s52, s5, 1
    s_lshr_b32 s7, s6, 4
    s_add_u32 s52, s52, s7
    s_and_b32 s53, s6, 15
    s_lshr_b32 s54, s53, 3
    s_and_b32 s55, s53, 7
    s_lshl_b32 s5, s52, 7
    s_add_u32 s48, s48, s5
    s_lshl_b32 s12, s52, 2
    s_add_u32 s12, s12, s4
    s_lshl_b32 s13, s12, 15
    s_waitcnt lgkmcnt(0)
    s_mov_b32 s8, s32
    s_mov_b32 s9, s33
    s_mov_b32 s10, 0x2200000
    s_mov_b32 s11, 0x20000
    s_cmp_ge_u32 s3, 4
    s_cbranch_scc1 FK_Y
    s_cmp_lg_u32 s3, 0
    s_cbranch_scc1 FK_X1
    s_getreg_b32 s57, hwreg(HW_REG_XCC_ID, 0, 4)
    s_add_u32 s57, s57, 1
    s_lshl_b32 s58, s53, 2
    s_add_u32 s58, s58, s48
    s_add_u32 s58, s58, 0x3000
    v_mov_b32 v8, 0
    v_mov_b32 v9, s57
    s_mov_b64 exec, 1
    buffer_store_dword v9, v8, s[8:11], s58 offen sc0 sc1
    s_mov_b64 exec, -1
FK_X1:
    s_mul_i32 s15, s53, 237568
    s_add_u32 s15, s15, 2162688
    s_lshl_b32 s16, s4, 12
    s_add_u32 s17, s15, s16
    s_barrier
    s_add_u32 s60, s48, 0x3000
    v_and_b32 v6, 15, v2
    v_lshlrev_b32 v6, 2, v6
    buffer_load_dword v7, v6, s[8:11], s60 offen sc0 sc1
    s_mov_b32 m0, s16
    s_nop 0
    buffer_load_dwordx4 v3, s[8:11], s17 offen offset:0  lds
    buffer_load_dwordx4 v3, s[8:11], s17 offen offset:1024  lds
    buffer_load_dwordx4 v3, s[8:11], s17 offen offset:2048  lds
    buffer_load_dwordx4 v3, s[8:11], s17 offen offset:3072  lds
    s_add_u32 s16, s16, 16384
    s_add_u32 s17, s17, 16384
    s_mov_b32 m0, s16
    s_nop 0
    buffer_load_dwordx4 v3, s[8:11], s17 offen offset:0  lds
    buffer_load_dwordx4 v3, s[8:11], s17 offen offset:1024  lds
    buffer_load_dwordx4 v3, s[8:11], s17 offen offset:2048  lds
    buffer_load_dwordx4 v3, s[8:11], s17 offen offset:3072  lds
    s_add_u32 s16, s16, 16384
    s_add_u32 s17, s17, 16384
    s_mov_b32 m0, s16
    s_nop 0
    buffer_load_dwordx4 v3, s[8:11], s17 offen offset:0  lds
    buffer_load_dwordx4 v3, s[8:11], s17 offen offset:1024  lds
    buffer_load_dwordx4 v3, s[8:11], s17 offen offset:2048  lds
    buffer_load_dwordx4 v3, s[8:11], s17 offen offset:3072  lds
    s_add_u32 s16, s16, 16384
    s_add_u32 s17, s17, 16384
    s_mov_b32 m0, s16
    s_nop 0
    buffer_load_dwordx4 v3, s[8:11], s17 offen offset:0  lds
    buffer_load_dwordx4 v3, s[8:11], s17 offen offset:1024  lds
    buffer_load_dwordx4 v3, s[8:11], s17 offen offset:2048  lds
    buffer_load_dwordx4 v3, s[8:11], s17 offen offset:3072  lds
    s_add_u32 s16, s16, 16384
    s_add_u32 s17, s17, 16384
    s_barrier
    s_mov_b32 m0, s16
    s_nop 0
    buffer_load_dwordx4 v3, s[8:11], s17 offen offset:0  lds
    buffer_load_dwordx4 v3, s[8:11], s17 offen offset:1024  lds
    buffer_load_dwordx4 v3, s[8:11], s17 offen offset:2048  lds
    buffer_load_dwordx4 v3, s[8:11], s17 offen offset:3072  lds
    s_add_u32 s16, s16, 16384
    s_add_u32 s17, s17, 16384
    s_mov_b32 m0, s16
    s_nop 0
    buffer_load_dwordx4 v3, s[8:11], s17 offen offset:0  lds
    buffer_load_dwordx4 v3, s[8:11], s17 offen offset:1024  lds
    buffer_load_dwordx4 v3, s[8:11], s17 offen offset:2048  lds
    buffer_load_dwordx4 v3, s[8:11], s17 offen offset:3072  lds
    s_add_u32 s16, s16, 16384
    s_add_u32 s17, s17, 16384
    s_mov_b32 m0, s16
    s_nop 0
    buffer_load_dwordx4 v3, s[8:11], s17 offen offset:0  lds
    buffer_load_dwordx4 v3, s[8:11], s17 offen offset:1024  lds
    buffer_load_dwordx4 v3, s[8:11], s17 offen offset:2048  lds
    buffer_load_dwordx4 v3, s[8:11], s17 offen offset:3072  lds
    s_add_u32 s16, s16, 16384
    s_add_u32 s17, s17, 16384
    s_waitcnt vmcnt(28)
    s_getreg_b32 s57, hwreg(HW_REG_XCC_ID, 0, 4)
    s_add_u32 s57, s57, 1
    s_mov_b32 s59, 0
FK_mc1:
    v_cmp_eq_u32 vcc, 0, v7
    s_cbranch_vccz FK_mc1_out
    s_add_u32 s59, s59, 1
    s_cmp_gt_u32 s59, 0x40000
    s_cbranch_scc1 FK_mc1_out
    buffer_load_dword v7, v6, s[8:11], s60 offen sc0 sc1
    s_waitcnt vmcnt(0)
    s_branch FK_mc1
FK_mc1_out:
    v_cmp_ne_u32 vcc, s57, v7
    s_nop 1
    s_cmp_lg_u32 vcc_lo, 0
    s_cselect_b32 s56, 1, 0
    s_waitcnt lgkmcnt(0)
FK_Xc:
    s_mul_i32 s19, s12, 114688
    s_mul_i32 s20, s53, 7168
    s_add_u32 s19, s19, s20
    s_add_u32 s19, s19, s40
    s_lshl_b32 s21, s12, 12
    s_add_u32 s21, s21, s45
    v_and_b32 v4, 31, v2
    v_lshlrev_b32 v4, 4, v4
    v_lshrrev_b32 v5, 5, v2
    v_lshlrev_b32 v5, 11, v5
    v_add_u32 v4, v4, v5
    v_add_u32 v14, 0x10000, v3
    v_add_u32 v15, 0x20000, v3
    s_add_u32 s14, s13, s42
    s_lshl_b32 s31, s4, 4
    s_add_u32 s31, s31, s48
    s_lshr_b32 s22, s4, 1
    s_lshl_b32 s22, s22, 5
    s_lshl_b32 s23, s53, 1
    s_add_u32 s22, s22, s23
    s_and_b32 s23, s4, 1
    s_add_u32 s22, s22, s23
    s_add_u32 s22, s22, s48
    s_add_u32 s22, s22, 0x1000
    s_andn2_b32 s63, s43, s56
    v_mov_b32 v12, 0
    s_mov_b32 s59, 0
    s_mov_b64 exec, 1
FK_pl2:
    buffer_load_dwordx4 v[8:11], v12, s[8:11], s31 offen sc1
    s_waitcnt vmcnt(0)
    v_and_b32 v8, v8, v9
    v_and_b32 v10, v10, v11
    v_and_b32 v8, v8, v10
    s_nop 0
    v_readfirstlane_b32 s58, v8
    s_add_u32 s59, s59, 1
    s_cmp_gt_u32 s59, 0x40000
    s_cbranch_scc1 FK_pl2_out
    s_cmp_lg_u32 s58, 0x01010101
    s_cbranch_scc1 FK_pl2
FK_pl2_out:
    s_mov_b64 exec, -1
    buffer_load_dwordx4 a[0:3], v3, s[8:11], s14 offen offset:0 sc1
    buffer_load_dwordx4 a[4:7], v3, s[8:11], s14 offen offset:1024 sc1
    buffer_load_dwordx4 a[8:11], v3, s[8:11], s14 offen offset:2048 sc1
    buffer_load_dwordx4 a[12:15], v3, s[8:11], s14 offen offset:3072 sc1
    s_add_u32 s14, s14, 4096
    buffer_load_dwordx4 a[16:19], v3, s[8:11], s14 offen offset:0 sc1
    buffer_load_dwordx4 a[20:23], v3, s[8:11], s14 offen offset:1024 sc1
    buffer_load_dwordx4 a[24:27], v3, s[8:11], s14 offen offset:2048 sc1
    buffer_load_dwordx4 a[28:31], v3, s[8:11], s14 offen offset:3072 sc1
    s_add_u32 s14, s14, 4096
    buffer_load_dwordx4 a[32:35], v3, s[8:11], s14 offen offset:0 sc1
    buffer_load_dwordx4 a[36:39], v3, s[8:11], s14 offen offset:1024 sc1
    s_barrier
    buffer_load_dwordx4 v[112:115], v4, s[8:11], s21 offen offset:0 sc1
    buffer_load_dwordx4 v[116:119], v4, s[8:11], s21 offen offset:512 sc1
    buffer_load_dwordx4 v[120:123], v4, s[8:11], s21 offen offset:1024 sc1
    buffer_load_dwordx4 v[124:127], v4, s[8:11], s21 offen offset:1536 sc1
    ds_read_b128 v[16:19], v3 offset:0
    ds_read_b128 v[20:23], v3 offset:1024
    ds_read_b128 v[24:27], v3 offset:2048
    ds_read_b128 v[28:31], v3 offset:3072
    s_waitcnt vmcnt(13)
    s_waitcnt lgkmcnt(3)
    v_mfma_f32_32x32x16_bf16 v[48:63], v[16:19], a[0:3], 0
    ds_read_b128 v[32:35], v3 offset:4096
    buffer_load_dwordx4 a[40:43], v3, s[8:11], s14 offen offset:2048 sc1
    s_waitcnt lgkmcnt(3)
    v_mfma_f32_32x32x16_bf16 v[64:79], v[20:23], a[0:3], 0
    ds_read_b128 v[36:39], v3 offset:5120
    s_waitcnt lgkmcnt(3)
    v_mfma_f32_32x32x16_bf16 v[80:95], v[24:27], a[0:3], 0
    ds_read_b128 v[40:43], v3 offset:6144
    buffer_load_dwordx4 a[44:47], v3, s[8:11], s14 offen offset:3072 sc1
    s_add_u32 s14, s14, 4096
    s_waitcnt lgkmcnt(3)
    v_mfma_f32_32x32x16_bf16 v[96:111], v[28:31], a[0:3], 0
    ds_read_b128 v[16:19], v3 offset:7168
    s_waitcnt vmcnt(14)
    s_waitcnt lgkmcnt(3)
    v_mfma_f32_32x32x16_bf16 v[48:63], v[32:35], a[4:7], v[48:63]
    ds_read_b128 v[20:23], v3 offset:8192
    buffer_load_dwordx4 a[48:51], v3, s[8:11], s14 offen offset:0 sc1
    s_waitcnt lgkmcnt(3)
    v_mfma_f32_32x32x16_bf16 v[64:79], v[36:39], a[4:7], v[64:79]
    ds_read_b128 v[24:27], v3 offset:9216
    s_waitcnt lgkmcnt(3)
    v_mfma_f32_32x32x16_bf16 v[80:95], v[40:43], a[4:7], v[80:95]
    ds_read_b128 v[28:31], v3 offset:10240
    buffer_load_dwordx4 a[52:55], v3, s[8:11], s14 offen offset:1024 sc1
    s_waitcnt lgkmcnt(3)
    v_mfma_f32_32x32x16_bf16 v[96:111], v[16:19], a[4:7], v[96:111]
    ds_read_b128 v[32:35], v3 offset:11264
    s_waitcnt vmcnt(15)
    s_waitcnt lgkmcnt(3)
    v_mfma_f32_32x32x16_bf16 v[48:63], v[20:23], a[8:11], v[48:63]
    ds_read_b128 v[36:39], v3 offset:12288
    buffer_load_dwordx4 a[56:59], v3, s[8:11], s14 offen offset:2048 sc1
    s_waitcnt lgkmcnt(3)
    v_mfma_f32_32x32x16_bf16 v[64:79], v[24:27], a[8:11], v[64:79]
    ds_read_b128 v[40:43], v3 offset:13312
    s_waitcnt lgkmcnt(3)
    v_mfma_f32_32x32x16_bf16 v[80:95], v[28:31], a[8:11], v[80:95]
    ds_read_b128 v[16:19], v3 offset:14336
    buffer_load_dwordx4 a[60:63], v3, s[8:11], s14 offen offset:3072 sc1
    s_add_u32 s14, s14, 4096
    s_waitcnt lgkmcnt(3)
    v_mfma_f32_32x32x16_bf16 v[96:111], v[32:35], a[8:11], v[96:111]
    ds_read_b128 v[20:23], v3 offset:15360
    s_waitcnt vmcnt(16)
    s_waitcnt lgkmcnt(3)
    v_mfma_f32_32x32x16_bf16 v[48:63], v[36:39], a[12:15], v[48:63]
    ds_read_b128 v[24:27], v3 offset:16384
    buffer_load_dwordx4 a[64:67], v3, s[8:11], s14 offen offset:0 sc1
    s_waitcnt lgkmcnt(3)
    v_mfma_f32_32x32x16_bf16 v[64:79], v[40:43], a[12:15], v[64:79]
    ds_read_b128 v[28:31], v3 offset:17408
    s_waitcnt lgkmcnt(3)
    v_mfma_f32_32x32x16_bf16 v[80:95], v[16:19], a[12:15], v[80:95]
    ds_read_b128 v[32:35], v3 offset:18432
    buffer_load_dwordx4 a[68:71], v3, s[8:11], s14 offen offset:1024 sc1
    s_waitcnt lgkmcnt(3)
    v_mfma_f32_32x32x16_bf16 v[96:111], v[20:23], a[12:15], v[96:111]
    ds_read_b128 v[36:39], v3 offset:19456
    s_waitcnt vmcnt(17)
    s_waitcnt lgkmcnt(3)
    v_mfma_f32_32x32x16_bf16 v[48:63], v[24:27], a[16:19], v[48:63]
    ds_read_b128 v[40:43], v3 offset:20480
    buffer_load_dwordx4 a[72:75], v3, s[8:11], s14 offen offset:2048 sc1
    s_waitcnt lgkmcnt(3)
    v_mfma_f32_32x32x16_bf16 v[64:79], v[28:31], a[16:19], v[64:79]
    ds_read_b128 v[16:19], v3 offset:21504
    s_waitcnt lgkmcnt(3)
    v_mfma_f32_32x32x16_bf16 v[80:95], v[32:35], a[16:19], v[80:95]
    ds_read_b128 v[20:23], v3 offset:22528
    buffer_load_dwordx4 a[76:79], v3, s[8:11], s14 offen offset:3072 sc1
    s_add_u32 s14, s14, 4096
    s_waitcnt lgkmcnt(3)
    v_mfma_f32_32x32x16_bf16 v[96:111], v[36:39], a[16:19], v[96:111]
    ds_read_b128 v[24:27], v3 offset:23552
    s_waitcnt vmcnt(18)
    s_waitcnt lgkmcnt(3)
    v_mfma_f32_32x32x16_bf16 v[48:63], v[40:43], a[20:23], v[48:63]
    ds_read_b128 v[28:31], v3 offset:24576
    buffer_load_dwordx4 a[80:83], v3, s[8:11], s14 offen offset:0 sc1
    s_waitcnt lgkmcnt(3)
    v_mfma_f32_32x32x16_bf16 v[64:79], v[16:19], a[20:23], v[64:79]
    ds_read_b128 v[32:35], v3 offset:25600
    s_waitcnt lgkmcnt(3)
    v_mfma_f32_32x32x16_bf16 v[80:95], v[20:23], a[20:23], v[80:95]
    ds_read_b128 v[36:39], v3 offset:26624
    buffer_load_dwordx4 a[84:87], v3, s[8:11], s14 offen offset:1024 sc1
    s_waitcnt lgkmcnt(3)
    v_mfma_f32_32x32x16_bf16 v[96:111], v[24:27], a[20:23], v[96:111]
    ds_read_b128 v[40:43], v3 offset:27648
    s_waitcnt vmcnt(19)
    s_waitcnt lgkmcnt(3)
    v_mfma_f32_32x32x16_bf16 v[48:63], v[28:31], a[24:27], v[48:63]
    ds_read_b128 v[16:19], v3 offset:28672
    buffer_load_dwordx4 a[88:91], v3, s[8:11], s14 offen offset:2048 sc1
    s_waitcnt lgkmcnt(3)
    v_mfma_f32_32x32x16_bf16 v[64:79], v[32:35], a[24:27], v[64:79]
    ds_read_b128 v[20:23], v3 offset:29696
    s_waitcnt lgkmcnt(3)
    v_mfma_f32_32x32x16_bf16 v[80:95], v[36:39], a[24:27], v[80:95]
    ds_read_b128 v[24:27], v3 offset:30720
    buffer_load_dwordx4 a[92:95], v3, s[8:11], s14 offen offset:3072 sc1
    s_add_u32 s14, s14, 4096
    s_waitcnt lgkmcnt(3)
    v_mfma_f32_32x32x16_bf16 v[96:111], v[40:43], a[24:27], v[96:111]
    ds_read_b128 v[28:31], v3 offset:31744
    s_waitcnt vmcnt(20)
    s_waitcnt lgkmcnt(3)
    v_mfma_f32_32x32x16_bf16 v[48:63], v[16:19], a[28:31], v[48:63]
    ds_read_b128 v[32:35], v3 offset:32768
    buffer_load_dwordx4 a[96:99], v3, s[8:11], s14 offen offset:0 sc1
    s_waitcnt lgkmcnt(3)
    v_mfma_f32_32x32x16_bf16 v[64:79], v[20:23], a[28:31], v[64:79]
    ds_read_b128 v[36:39], v3 offset:33792
    s_barrier
    s_waitcnt lgkmcnt(3)
    v_mfma_f32_32x32x16_bf16 v[80:95], v[24:27], a[28:31], v[80:95]
    ds_read_b128 v[40:43], v3 offset:34816
    buffer_load_dwordx4 a[100:103], v3, s[8:11], s14 offen offset:1024 sc1
    s_waitcnt lgkmcnt(3)
    v_mfma_f32_32x32x16_bf16 v[96:111], v[28:31], a[28:31], v[96:111]
    ds_read_b128 v[16:19], v3 offset:35840
    s_waitcnt vmcnt(21)
    s_waitcnt lgkmcnt(3)
    v_mfma_f32_32x32x16_bf16 v[48:63], v[32:35], a[32:35], v[48:63]
    ds_read_b128 v[20:23], v3 offset:36864
    buffer_load_dwordx4 a[104:107], v3, s[8:11], s14 offen offset:2048 sc1
    s_waitcnt lgkmcnt(3)
    v_mfma_f32_32x32x16_bf16 v[64:79], v[36:39], a[32:35], v[64:79]
    ds_read_b128 v[24:27], v3 offset:37888
    s_waitcnt lgkmcnt(3)
    v_mfma_f32_32x32x16_bf16 v[80:95], v[40:43], a[32:35], v[80:95]
    ds_read_b128 v[28:31], v3 offset:38912
    buffer_load_dwordx4 a[108:111], v3, s[8:11], s14 offen offset:3072 sc1
    s_add_u32 s14, s14, 4096
    s_waitcnt lgkmcnt(3)
    v_mfma_f32_32x32x16_bf16 v[96:111], v[16:19], a[32:35], v[96:111]
    ds_read_b128 v[32:35], v3 offset:39936
    s_waitcnt vmcnt(22)
    s_waitcnt lgkmcnt(3)
    v_mfma_f32_32x32x16_bf16 v[48:63], v[20:23], a[36:39], v[48:63]
    ds_read_b128 v[36:39], v3 offset:40960
    buffer_load_dwordx4 a[112:115], v3, s[8:11], s14 offen offset:0 sc1
    s_waitcnt lgkmcnt(3)
    v_mfma_f32_32x32x16_bf16 v[64:79], v[24:27], a[36:39], v[64:79]
    ds_read_b128 v[40:43], v3 offset:41984
    s_waitcnt lgkmcnt(3)
    v_mfma_f32_32x32x16_bf16 v[80:95], v[28:31], a[36:39], v[80:95]
    ds_read_b128 v[16:19], v3 offset:43008
    buffer_load_dwordx4 a[116:119], v3, s[8:11], s14 offen offset:1024 sc1
    s_waitcnt lgkmcnt(3)
    v_mfma_f32_32x32x16_bf16 v[96:111], v[32:35], a[36:39], v[96:111]
    ds_read_b128 v[20:23], v3 offset:44032
    s_waitcnt vmcnt(19)
    s_waitcnt lgkmcnt(3)
    v_mfma_f32_32x32x16_bf16 v[48:63], v[36:39], a[40:43], v[48:63]
    ds_read_b128 v[24:27], v3 offset:45056
    buffer_load_dwordx4 a[120:123], v3, s[8:11], s14 offen offset:2048 sc1
    s_waitcnt lgkmcnt(3)
    v_mfma_f32_32x32x16_bf16 v[64:79], v[40:43], a[40:43], v[64:79]
    ds_read_b128 v[28:31], v3 offset:46080
    s_waitcnt lgkmcnt(3)
    v_mfma_f32_32x32x16_bf16 v[80:95], v[16:19], a[40:43], v[80:95]
    ds_read_b128 v[32:35], v3 offset:47104
    buffer_load_dwordx4 a[124:127], v3, s[8:11], s14 offen offset:3072 sc1
    s_add_u32 s14, s14, 4096
    s_waitcnt lgkmcnt(3)
    v_mfma_f32_32x32x16_bf16 v[96:111], v[20:23], a[40:43], v[96:111]
    ds_read_b128 v[36:39], v3 offset:48128
    s_waitcnt vmcnt(20)
    s_waitcnt lgkmcnt(3)
    v_mfma_f32_32x32x16_bf16 v[48:63], v[24:27], a[44:47], v[48:63]
    ds_read_b128 v[40:43], v3 offset:49152
    s_waitcnt lgkmcnt(3)
    v_mfma_f32_32x32x16_bf16 v[64:79], v[28:31], a[44:47], v[64:79]
    ds_read_b128 v[16:19], v3 offset:50176
    s_waitcnt lgkmcnt(3)
    v_mfma_f32_32x32x16_bf16 v[80:95], v[32:35], a[44:47], v[80:95]
    ds_read_b128 v[20:23], v3 offset:51200
    s_waitcnt lgkmcnt(3)
    v_mfma_f32_32x32x16_bf16 v[96:111], v[36:39], a[44:47], v[96:111]
    ds_read_b128 v[24:27], v3 offset:52224
    s_waitcnt vmcnt(19)
    s_waitcnt lgkmcnt(3)
    v_mfma_f32_32x32x16_bf16 v[48:63], v[40:43], a[48:51], v[48:63]
    ds_read_b128 v[28:31], v3 offset:53248
    s_waitcnt lgkmcnt(3)
    v_mfma_f32_32x32x16_bf16 v[64:79], v[16:19], a[48:51], v[64:79]
    ds_read_b128 v[32:35], v3 offset:54272
    s_waitcnt lgkmcnt(3)
    v_mfma_f32_32x32x16_bf16 v[80:95], v[20:23], a[48:51], v[80:95]
    ds_read_b128 v[36:39], v3 offset:55296
    s_waitcnt lgkmcnt(3)
    v_mfma_f32_32x32x16_bf16 v[96:111], v[24:27], a[48:51], v[96:111]
    ds_read_b128 v[40:43], v3 offset:56320
    s_waitcnt vmcnt(18)
    s_waitcnt lgkmcnt(3)
    v_mfma_f32_32x32x16_bf16 v[48:63], v[28:31], a[52:55], v[48:63]
    ds_read_b128 v[16:19], v3 offset:57344
    s_waitcnt lgkmcnt(3)
    v_mfma_f32_32x32x16_bf16 v[64:79], v[32:35], a[52:55], v[64:79]
    ds_read_b128 v[20:23], v3 offset:58368
    s_waitcnt lgkmcnt(3)
    v_mfma_f32_32x32x16_bf16 v[80:95], v[36:39], a[52:55], v[80:95]
    ds_read_b128 v[24:27], v3 offset:59392
    s_waitcnt lgkmcnt(3)
    v_mfma_f32_32x32x16_bf16 v[96:111], v[40:43], a[52:55], v[96:111]
    ds_read_b128 v[28:31], v3 offset:60416
    s_waitcnt vmcnt(17)
    s_waitcnt lgkmcnt(3)
    v_mfma_f32_32x32x16_bf16 v[48:63], v[16:19], a[56:59], v[48:63]
    ds_read_b128 v[32:35], v3 offset:61440
    v_add_f32 v112, v112, v120
    v_add_f32 v113, v113, v121
    v_add_f32 v114, v114, v122
    v_add_f32 v115, v115, v123
    v_add_f32 v116, v116, v124
    v_add_f32 v117, v117, v125
    v_add_f32 v118, v118, v126
    s_waitcnt lgkmcnt(3)
    v_mfma_f32_32x32x16_bf16 v[64:79], v[20:23], a[56:59], v[64:79]
    ds_read_b128 v[36:39], v3 offset:62464
    v_add_f32 v119, v119, v127
    v_add_f32 v112, v112, v116
    s_waitcnt lgkmcnt(3)
    v_mfma_f32_32x32x16_bf16 v[80:95], v[24:27], a[56:59], v[80:95]
    ds_read_b128 v[40:43], v3 offset:63488
    v_add_f32 v113, v113, v117
    v_add_f32 v114, v114, v118
    s_waitcnt lgkmcnt(3)
    v_mfma_f32_32x32x16_bf16 v[96:111], v[28:31], a[56:59], v[96:111]
    ds_read_b128 v[16:19], v3 offset:64512
    v_add_f32 v115, v115, v119
    v_add_f32 v112, v112, v114
    s_barrier
    s_waitcnt vmcnt(16)
    s_waitcnt lgkmcnt(3)
    v_mfma_f32_32x32x16_bf16 v[48:63], v[32:35], a[60:63], v[48:63]
    ds_read_b128 v[20:23], v14 offset:0
    v_add_f32 v113, v113, v115
    v_mov_b32 v114, v112
    s_waitcnt lgkmcnt(3)
    v_mfma_f32_32x32x16_bf16 v[64:79], v[36:39], a[60:63], v[64:79]
    ds_read_b128 v[24:27], v14 offset:1024
    v_mov_b32 v115, v113
    v_permlane32_swap_b32 v112, v114
    s_waitcnt lgkmcnt(3)
    v_mfma_f32_32x32x16_bf16 v[80:95], v[40:43], a[60:63], v[80:95]
    ds_read_b128 v[28:31], v14 offset:2048
    v_permlane32_swap_b32 v113, v115
    v_add_f32 v112, v112, v114
    s_waitcnt lgkmcnt(3)
    v_mfma_f32_32x32x16_bf16 v[96:111], v[16:19], a[60:63], v[96:111]
    ds_read_b128 v[32:35], v14 offset:3072
    v_add_f32 v113, v113, v115
    v_mul_f32 v112, 0xbb000000, v112
    s_waitcnt vmcnt(15)
    s_waitcnt lgkmcnt(3)
    v_mfma_f32_32x32x16_bf16 v[48:63], v[20:23], a[64:67], v[48:63]
    ds_read_b128 v[36:39], v14 offset:4096
    v_mul_f32 v113, 0x3b000000, v113
    v_fma_f32 v113, -v112, v112, v113
    s_waitcnt lgkmcnt(3)
    v_mfma_f32_32x32x16_bf16 v[64:79], v[24:27], a[64:67], v[64:79]
    ds_read_b128 v[40:43], v14 offset:5120
    v_max_f32 v113, 0, v113
    v_add_f32 v13, 0x3727c5ac, v113
    s_waitcnt lgkmcnt(3)
    v_mfma_f32_32x32x16_bf16 v[80:95], v[28:31], a[64:67], v[80:95]
    ds_read_b128 v[16:19], v14 offset:6144
    v_rsq_f32 v12, v13
    v_cvt_pk_bf16_f32 v8, v112, v112
    s_waitcnt lgkmcnt(3)
    v_mfma_f32_32x32x16_bf16 v[96:111], v[32:35], a[64:67], v[96:111]
    ds_read_b128 v[20:23], v14 offset:7168
    v_and_b32 v114, 0xffff0000, v8
    v_sub_f32 v114, v112, v114
    s_waitcnt vmcnt(14)
    s_waitcnt lgkmcnt(3)
    v_mfma_f32_32x32x16_bf16 v[48:63], v[36:39], a[68:71], v[48:63]
    ds_read_b128 v[24:27], v14 offset:8192
    v_cvt_pk_bf16_f32 v9, v112, v114
    v_and_b32 v115, 0xffff0000, v9
    s_waitcnt lgkmcnt(3)
    v_mfma_f32_32x32x16_bf16 v[64:79], v[40:43], a[68:71], v[64:79]
    ds_read_b128 v[28:31], v14 offset:9216
    v_sub_f32 v115, v114, v115
    v_cvt_pk_bf16_f32 v10, v114, v115
    s_waitcnt lgkmcnt(3)
    v_mfma_f32_32x32x16_bf16 v[80:95], v[16:19], a[68:71], v[80:95]
    ds_read_b128 v[32:35], v14 offset:10240
    v_mov_b32 v11, 0
    v_mul_f32 v5, 0xc0135761, v12
    s_waitcnt lgkmcnt(3)
    v_mfma_f32_32x32x16_bf16 v[96:111], v[20:23], a[68:71], v[96:111]
    ds_read_b128 v[36:39], v14 offset:11264
    v_mul_f32 v4, v12, v12
    v_mul_f32 v4, 0x3d372713, v4
    s_waitcnt vmcnt(13)
    s_waitcnt lgkmcnt(3)
    v_mfma_f32_32x32x16_bf16 v[48:63], v[24:27], a[72:75], v[48:63]
    ds_read_b128 v[40:43], v14 offset:12288
    v_mul_f32 v4, v4, v5
    s_waitcnt lgkmcnt(3)
    v_mfma_f32_32x32x16_bf16 v[64:79], v[28:31], a[72:75], v[64:79]
    ds_read_b128 v[16:19], v14 offset:13312
    s_waitcnt lgkmcnt(3)
    v_mfma_f32_32x32x16_bf16 v[80:95], v[32:35], a[72:75], v[80:95]
    ds_read_b128 v[20:23], v14 offset:14336
    s_waitcnt lgkmcnt(3)
    v_mfma_f32_32x32x16_bf16 v[96:111], v[36:39], a[72:75], v[96:111]
    ds_read_b128 v[24:27], v14 offset:15360
    s_waitcnt vmcnt(12)
    s_waitcnt lgkmcnt(3)
    v_mfma_f32_32x32x16_bf16 v[48:63], v[40:43], a[76:79], v[48:63]
    ds_read_b128 v[28:31], v14 offset:16384
    s_waitcnt lgkmcnt(3)
    v_mfma_f32_32x32x16_bf16 v[64:79], v[16:19], a[76:79], v[64:79]
    ds_read_b128 v[32:35], v14 offset:17408
    s_waitcnt lgkmcnt(3)
    v_mfma_f32_32x32x16_bf16 v[80:95], v[20:23], a[76:79], v[80:95]
    ds_read_b128 v[36:39], v14 offset:18432
    s_waitcnt lgkmcnt(3)
    v_mfma_f32_32x32x16_bf16 v[96:111], v[24:27], a[76:79], v[96:111]
    ds_read_b128 v[40:43], v14 offset:19456
    s_waitcnt vmcnt(11)
    s_waitcnt lgkmcnt(3)
    v_mfma_f32_32x32x16_bf16 v[48:63], v[28:31], a[80:83], v[48:63]
    ds_read_b128 v[16:19], v14 offset:20480
    s_waitcnt lgkmcnt(3)
    v_mfma_f32_32x32x16_bf16 v[64:79], v[32:35], a[80:83], v[64:79]
    ds_read_b128 v[20:23], v14 offset:21504
    s_waitcnt lgkmcnt(3)
    v_mfma_f32_32x32x16_bf16 v[80:95], v[36:39], a[80:83], v[80:95]
    ds_read_b128 v[24:27], v14 offset:22528
    s_waitcnt lgkmcnt(3)
    v_mfma_f32_32x32x16_bf16 v[96:111], v[40:43], a[80:83], v[96:111]
    ds_read_b128 v[28:31], v14 offset:23552
    s_waitcnt vmcnt(10)
    s_waitcnt lgkmcnt(3)
    v_mfma_f32_32x32x16_bf16 v[48:63], v[16:19], a[84:87], v[48:63]
    ds_read_b128 v[32:35], v14 offset:24576
    s_waitcnt lgkmcnt(3)
    v_mfma_f32_32x32x16_bf16 v[64:79], v[20:23], a[84:87], v[64:79]
    ds_read_b128 v[36:39], v14 offset:25600
    s_waitcnt lgkmcnt(3)
    v_mfma_f32_32x32x16_bf16 v[80:95], v[24:27], a[84:87], v[80:95]
    ds_read_b128 v[40:43], v14 offset:26624
    s_waitcnt lgkmcnt(3)
    v_mfma_f32_32x32x16_bf16 v[96:111], v[28:31], a[84:87], v[96:111]
    ds_read_b128 v[16:19], v14 offset:27648
    s_waitcnt vmcnt(9)
    s_waitcnt lgkmcnt(3)
    v_mfma_f32_32x32x16_bf16 v[48:63], v[32:35], a[88:91], v[48:63]
    ds_read_b128 v[20:23], v14 offset:28672
    s_waitcnt lgkmcnt(3)
    v_mfma_f32_32x32x16_bf16 v[64:79], v[36:39], a[88:91], v[64:79]
    ds_read_b128 v[24:27], v14 offset:29696
    s_waitcnt lgkmcnt(3)
    v_mfma_f32_32x32x16_bf16 v[80:95], v[40:43], a[88:91], v[80:95]
    ds_read_b128 v[28:31], v14 offset:30720
    s_waitcnt lgkmcnt(3)
    v_mfma_f32_32x32x16_bf16 v[96:111], v[16:19], a[88:91], v[96:111]
    ds_read_b128 v[32:35], v14 offset:31744
    s_barrier
    s_waitcnt vmcnt(8)
    s_waitcnt lgkmcnt(3)
    v_mfma_f32_32x32x16_bf16 v[48:63], v[20:23], a[92:95], v[48:63]
    ds_read_b128 v[36:39], v14 offset:32768
    s_waitcnt lgkmcnt(3)
    v_mfma_f32_32x32x16_bf16 v[64:79], v[24:27], a[92:95], v[64:79]
    ds_read_b128 v[40:43], v14 offset:33792
    s_waitcnt lgkmcnt(3)
    v_mfma_f32_32x32x16_bf16 v[80:95], v[28:31], a[92:95], v[80:95]
    ds_read_b128 v[16:19], v14 offset:34816
    s_waitcnt lgkmcnt(3)
    v_mfma_f32_32x32x16_bf16 v[96:111], v[32:35], a[92:95], v[96:111]
    ds_read_b128 v[20:23], v14 offset:35840
    s_waitcnt vmcnt(7)
    s_waitcnt lgkmcnt(3)
    v_mfma_f32_32x32x16_bf16 v[48:63], v[36:39], a[96:99], v[48:63]
    ds_read_b128 v[24:27], v14 offset:36864
    s_waitcnt lgkmcnt(3)
    v_mfma_f32_32x32x16_bf16 v[64:79], v[40:43], a[96:99], v[64:79]
    ds_read_b128 v[28:31], v14 offset:37888
    s_waitcnt lgkmcnt(3)
    v_mfma_f32_32x32x16_bf16 v[80:95], v[16:19], a[96:99], v[80:95]
    ds_read_b128 v[32:35], v14 offset:38912
    s_waitcnt lgkmcnt(3)
    v_mfma_f32_32x32x16_bf16 v[96:111], v[20:23], a[96:99], v[96:111]
    ds_read_b128 v[36:39], v14 offset:39936
    s_waitcnt vmcnt(6)
    s_waitcnt lgkmcnt(3)
    v_mfma_f32_32x32x16_bf16 v[48:63], v[24:27], a[100:103], v[48:63]
    ds_read_b128 v[40:43], v14 offset:40960
    s_waitcnt lgkmcnt(3)
    v_mfma_f32_32x32x16_bf16 v[64:79], v[28:31], a[100:103], v[64:79]
    ds_read_b128 v[16:19], v14 offset:41984
    s_waitcnt lgkmcnt(3)
    v_mfma_f32_32x32x16_bf16 v[80:95], v[32:35], a[100:103], v[80:95]
    ds_read_b128 v[20:23], v14 offset:43008
    s_waitcnt lgkmcnt(3)
    v_mfma_f32_32x32x16_bf16 v[96:111], v[36:39], a[100:103], v[96:111]
    ds_read_b128 v[24:27], v14 offset:44032
    s_waitcnt vmcnt(5)
    s_waitcnt lgkmcnt(3)
    v_mfma_f32_32x32x16_bf16 v[48:63], v[40:43], a[104:107], v[48:63]
    ds_read_b128 v[28:31], v14 offset:45056
    s_waitcnt lgkmcnt(3)
    v_mfma_f32_32x32x16_bf16 v[64:79], v[16:19], a[104:107], v[64:79]
    ds_read_b128 v[32:35], v14 offset:46080
    s_waitcnt lgkmcnt(3)
    v_mfma_f32_32x32x16_bf16 v[80:95], v[20:23], a[104:107], v[80:95]
    ds_read_b128 v[36:39], v14 offset:47104
    s_waitcnt lgkmcnt(3)
    v_mfma_f32_32x32x16_bf16 v[96:111], v[24:27], a[104:107], v[96:111]
    ds_read_b128 v[40:43], v14 offset:48128
    s_waitcnt vmcnt(4)
    s_waitcnt lgkmcnt(3)
    v_mfma_f32_32x32x16_bf16 v[48:63], v[28:31], a[108:111], v[48:63]
    ds_read_b128 v[16:19], v14 offset:49152
    s_waitcnt lgkmcnt(3)
    v_mfma_f32_32x32x16_bf16 v[64:79], v[32:35], a[108:111], v[64:79]
    ds_read_b128 v[20:23], v14 offset:50176
    s_waitcnt lgkmcnt(3)
    v_mfma_f32_32x32x16_bf16 v[80:95], v[36:39], a[108:111], v[80:95]
    ds_read_b128 v[24:27], v14 offset:51200
    s_waitcnt lgkmcnt(3)
    v_mfma_f32_32x32x16_bf16 v[96:111], v[40:43], a[108:111], v[96:111]
    ds_read_b128 v[28:31], v14 offset:52224
    s_waitcnt vmcnt(3)
    s_waitcnt lgkmcnt(3)
    v_mfma_f32_32x32x16_bf16 v[48:63], v[16:19], a[112:115], v[48:63]
    ds_read_b128 v[32:35], v14 offset:53248
    s_waitcnt lgkmcnt(3)
    v_mfma_f32_32x32x16_bf16 v[64:79], v[20:23], a[112:115], v[64:79]
    ds_read_b128 v[36:39], v14 offset:54272
    s_waitcnt lgkmcnt(3)
    v_mfma_f32_32x32x16_bf16 v[80:95], v[24:27], a[112:115], v[80:95]
    ds_read_b128 v[40:43], v14 offset:55296
    s_waitcnt lgkmcnt(3)
    v_mfma_f32_32x32x16_bf16 v[96:111], v[28:31], a[112:115], v[96:111]
    ds_read_b128 v[16:19], v14 offset:56320
    s_waitcnt vmcnt(2)
    s_waitcnt lgkmcnt(3)
    v_mfma_f32_32x32x16_bf16 v[48:63], v[32:35], a[116:119], v[48:63]
    ds_read_b128 v[20:23], v14 offset:57344
    s_waitcnt lgkmcnt(3)
    v_mfma_f32_32x32x16_bf16 v[64:79], v[36:39], a[116:119], v[64:79]
    ds_read_b128 v[24:27], v14 offset:58368
    s_waitcnt lgkmcnt(3)
    v_mfma_f32_32x32x16_bf16 v[80:95], v[40:43], a[116:119], v[80:95]
    ds_read_b128 v[28:31], v14 offset:59392
    s_waitcnt lgkmcnt(3)
    v_mfma_f32_32x32x16_bf16 v[96:111], v[16:19], a[116:119], v[96:111]
    ds_read_b128 v[32:35], v14 offset:60416
    s_waitcnt vmcnt(1)
    s_waitcnt lgkmcnt(3)
    v_mfma_f32_32x32x16_bf16 v[48:63], v[20:23], a[120:123], v[48:63]
    ds_read_b128 v[36:39], v14 offset:61440
    s_waitcnt lgkmcnt(3)
    v_mfma_f32_32x32x16_bf16 v[64:79], v[24:27], a[120:123], v[64:79]
    ds_read_b128 v[40:43], v14 offset:62464
    s_waitcnt lgkmcnt(3)
    v_mfma_f32_32x32x16_bf16 v[80:95], v[28:31], a[120:123], v[80:95]
    ds_read_b128 v[16:19], v14 offset:63488
    s_waitcnt lgkmcnt(3)
    v_mfma_f32_32x32x16_bf16 v[96:111], v[32:35], a[120:123], v[96:111]
    ds_read_b128 v[20:23], v14 offset:64512
    s_barrier
    s_waitcnt vmcnt(0)
    s_waitcnt lgkmcnt(3)
    v_mfma_f32_32x32x16_bf16 v[48:63], v[36:39], a[124:127], v[48:63]
    ds_read_b128 v[24:27], v15 offset:0
    s_waitcnt lgkmcnt(3)
    v_mfma_f32_32x32x16_bf16 v[64:79], v[40:43], a[124:127], v[64:79]
    ds_read_b128 v[28:31], v15 offset:1024
    s_waitcnt lgkmcnt(3)
    v_mfma_f32_32x32x16_bf16 v[80:95], v[16:19], a[124:127], v[80:95]
    ds_read_b128 v[32:35], v15 offset:2048
    s_waitcnt lgkmcnt(3)
    v_mfma_f32_32x32x16_bf16 v[96:111], v[20:23], a[124:127], v[96:111]
    ds_read_b128 v[36:39], v15 offset:3072
    s_waitcnt lgkmcnt(3)
    v_mfma_f32_32x32x16_bf16 v[48:63], v[24:27], v[8:11], v[48:63]
    ds_read_b128 v[40:43], v15 offset:4096
    s_waitcnt lgkmcnt(3)
    v_mfma_f32_32x32x16_bf16 v[64:79], v[28:31], v[8:11], v[64:79]
    ds_read_b128 v[16:19], v15 offset:5120
    s_waitcnt lgkmcnt(3)
    v_mfma_f32_32x32x16_bf16 v[80:95], v[32:35], v[8:11], v[80:95]
    ds_read_b128 v[20:23], v15 offset:6144
    s_waitcnt lgkmcnt(3)
    v_mfma_f32_32x32x16_bf16 v[96:111], v[36:39], v[8:11], v[96:111]
    ds_read_b128 v[24:27], v15 offset:7168
    s_nop 1
    v_mul_f32 v44, v48, v48
    v_mul_f32 v45, v49, v49
    v_mul_f32 v46, v50, v50
    v_mul_f32 v47, v51, v51
    v_mul_f32 v56, v48, v56
    v_mul_f32 v57, v49, v57
    v_mul_f32 v58, v50, v58
    s_waitcnt lgkmcnt(3)
    v_mfma_f32_32x32x16_bf16 v[112:127], v[40:43], a[0:3], 0
    ds_read_b128 v[28:31], v15 offset:8192
    v_mul_f32 v59, v51, v59
    v_fma_f32 v44, v44, v4, v5
    v_fma_f32 v45, v45, v4, v5
    v_fma_f32 v46, v46, v4, v5
    s_waitcnt lgkmcnt(3)
    v_mfma_f32_32x32x16_bf16 v[112:127], v[16:19], a[4:7], v[112:127]
    ds_read_b128 v[32:35], v15 offset:9216
    v_fma_f32 v47, v47, v4, v5
    v_mul_f32 v48, v44, v48
    v_mul_f32 v49, v45, v49
    v_mul_f32 v50, v46, v50
    s_waitcnt lgkmcnt(3)
    v_mfma_f32_32x32x16_bf16 v[112:127], v[20:23], a[8:11], v[112:127]
    ds_read_b128 v[36:39], v15 offset:10240
    v_mul_f32 v51, v47, v51
    v_exp_f32 v48, v48
    v_exp_f32 v49, v49
    v_exp_f32 v50, v50
    s_waitcnt lgkmcnt(3)
    v_mfma_f32_32x32x16_bf16 v[112:127], v[24:27], a[12:15], v[112:127]
    ds_read_b128 v[40:43], v15 offset:11264
    v_exp_f32 v51, v51
    v_fma_f32 v48, v48, v13, v13
    v_fma_f32 v49, v49, v13, v13
    v_fma_f32 v50, v50, v13, v13
    v_fma_f32 v51, v51, v13, v13
    s_waitcnt lgkmcnt(3)
    v_mfma_f32_32x32x16_bf16 v[112:127], v[28:31], a[16:19], v[112:127]
    ds_read_b128 v[16:19], v15 offset:12288
    v_rcp_f32 v48, v48
    v_rcp_f32 v49, v49
    v_rcp_f32 v50, v50
    v_rcp_f32 v51, v51
    s_waitcnt lgkmcnt(3)
    v_mfma_f32_32x32x16_bf16 v[112:127], v[32:35], a[20:23], v[112:127]
    ds_read_b128 v[20:23], v15 offset:13312
    v_mul_f32 v48, v48, v56
    v_mul_f32 v49, v49, v57
    v_mul_f32 v50, v50, v58
    v_mul_f32 v51, v51, v59
    s_waitcnt lgkmcnt(3)
    v_mfma_f32_32x32x16_bf16 v[112:127], v[36:39], a[24:27], v[112:127]
    ds_read_b128 v[24:27], v15 offset:14336
    v_cvt_pk_bf16_f32 v56, v48, v49
    v_cvt_pk_bf16_f32 v57, v50, v51
    v_mul_f32 v44, v52, v52
    v_mul_f32 v45, v53, v53
    v_mul_f32 v46, v54, v54
    s_waitcnt lgkmcnt(3)
    v_mfma_f32_32x32x16_bf16 v[112:127], v[40:43], a[28:31], v[112:127]
    ds_read_b128 v[28:31], v15 offset:15360
    v_mul_f32 v47, v55, v55
    v_mul_f32 v60, v52, v60
    v_mul_f32 v61, v53, v61
    v_mul_f32 v62, v54, v62
    s_waitcnt lgkmcnt(3)
    v_mfma_f32_32x32x16_bf16 v[112:127], v[16:19], a[32:35], v[112:127]
    ds_read_b128 v[32:35], v15 offset:16384
    v_mul_f32 v63, v55, v63
    v_fma_f32 v44, v44, v4, v5
    v_fma_f32 v45, v45, v4, v5
    v_fma_f32 v46, v46, v4, v5
    s_waitcnt lgkmcnt(3)
    v_mfma_f32_32x32x16_bf16 v[112:127], v[20:23], a[36:39], v[112:127]
    ds_read_b128 v[36:39], v15 offset:17408
    v_fma_f32 v47, v47, v4, v5
    v_mul_f32 v52, v44, v52
    v_mul_f32 v53, v45, v53
    v_mul_f32 v54, v46, v54
    s_waitcnt lgkmcnt(3)
    v_mfma_f32_32x32x16_bf16 v[112:127], v[24:27], a[40:43], v[112:127]
    ds_read_b128 v[40:43], v15 offset:18432
    v_mul_f32 v55, v47, v55
    v_exp_f32 v52, v52
    v_exp_f32 v53, v53
    v_exp_f32 v54, v54
    v_exp_f32 v55, v55
    s_waitcnt lgkmcnt(3)
    v_mfma_f32_32x32x16_bf16 v[112:127], v[28:31], a[44:47], v[112:127]
    ds_read_b128 v[16:19], v15 offset:19456
    v_fma_f32 v52, v52, v13, v13
    v_fma_f32 v53, v53, v13, v13
    v_fma_f32 v54, v54, v13, v13
    v_fma_f32 v55, v55, v13, v13
    s_waitcnt lgkmcnt(3)
    v_mfma_f32_32x32x16_bf16 v[112:127], v[32:35], a[48:51], v[112:127]
    ds_read_b128 v[20:23], v15 offset:20480
    v_rcp_f32 v52, v52
    v_rcp_f32 v53, v53
    v_rcp_f32 v54, v54
    v_rcp_f32 v55, v55
    s_waitcnt lgkmcnt(3)
    v_mfma_f32_32x32x16_bf16 v[112:127], v[36:39], a[52:55], v[112:127]
    ds_read_b128 v[24:27], v15 offset:21504
    v_mul_f32 v52, v52, v60
    v_mul_f32 v53, v53, v61
    v_mul_f32 v54, v54, v62
    v_mul_f32 v55, v55, v63
    v_cvt_pk_bf16_f32 v58, v52, v53
    s_waitcnt lgkmcnt(3)
    v_mfma_f32_32x32x16_bf16 v[112:127], v[40:43], a[56:59], v[112:127]
    ds_read_b128 v[28:31], v15 offset:22528
    v_cvt_pk_bf16_f32 v59, v54, v55
    buffer_store_dwordx4 v[56:59], v3, s[8:11], s19 offen offset:0 sc1
    v_mul_f32 v44, v64, v64
    v_mul_f32 v45, v65, v65
    s_waitcnt lgkmcnt(3)
    v_mfma_f32_32x32x16_bf16 v[112:127], v[16:19], a[60:63], v[112:127]
    ds_read_b128 v[32:35], v15 offset:23552
    v_mul_f32 v46, v66, v66
    v_mul_f32 v47, v67, v67
    v_mul_f32 v72, v64, v72
    v_mul_f32 v73, v65, v73
    s_waitcnt lgkmcnt(3)
    v_mfma_f32_32x32x16_bf16 v[112:127], v[20:23], a[64:67], v[112:127]
    ds_read_b128 v[36:39], v15 offset:24576
    v_mul_f32 v74, v66, v74
    v_mul_f32 v75, v67, v75
    v_fma_f32 v44, v44, v4, v5
    v_fma_f32 v45, v45, v4, v5
    v_fma_f32 v46, v46, v4, v5
    s_waitcnt lgkmcnt(3)
    v_mfma_f32_32x32x16_bf16 v[112:127], v[24:27], a[68:71], v[112:127]
    ds_read_b128 v[40:43], v15 offset:25600
    v_fma_f32 v47, v47, v4, v5
    v_mul_f32 v64, v44, v64
    v_mul_f32 v65, v45, v65
    v_mul_f32 v66, v46, v66
    s_waitcnt lgkmcnt(3)
    v_mfma_f32_32x32x16_bf16 v[112:127], v[28:31], a[72:75], v[112:127]
    ds_read_b128 v[16:19], v15 offset:26624
    v_mul_f32 v67, v47, v67
    v_exp_f32 v64, v64
    v_exp_f32 v65, v65
    v_exp_f32 v66, v66
    s_waitcnt lgkmcnt(3)
    v_mfma_f32_32x32x16_bf16 v[112:127], v[32:35], a[76:79], v[112:127]
    ds_read_b128 v[20:23], v15 offset:27648
    v_exp_f32 v67, v67
    v_fma_f32 v64, v64, v13, v13
    v_fma_f32 v65, v65, v13, v13
    v_fma_f32 v66, v66, v13, v13
    s_waitcnt lgkmcnt(3)
    v_mfma_f32_32x32x16_bf16 v[112:127], v[36:39], a[80:83], v[112:127]
    ds_read_b128 v[24:27], v15 offset:28672
    v_fma_f32 v67, v67, v13, v13
    v_rcp_f32 v64, v64
    v_rcp_f32 v65, v65
    v_rcp_f32 v66, v66
    v_rcp_f32 v67, v67
    s_waitcnt lgkmcnt(3)
    v_mfma_f32_32x32x16_bf16 v[112:127], v[40:43], a[84:87], v[112:127]
    ds_read_b128 v[28:31], v15 offset:29696
    v_mul_f32 v64, v64, v72
    v_mul_f32 v65, v65, v73
    v_mul_f32 v66, v66, v74
    v_mul_f32 v67, v67, v75
    s_waitcnt lgkmcnt(3)
    v_mfma_f32_32x32x16_bf16 v[112:127], v[16:19], a[88:91], v[112:127]
    ds_read_b128 v[32:35], v15 offset:30720
    v_cvt_pk_bf16_f32 v72, v64, v65
    v_cvt_pk_bf16_f32 v73, v66, v67
    v_mul_f32 v44, v68, v68
    v_mul_f32 v45, v69, v69
    s_waitcnt lgkmcnt(3)
    v_mfma_f32_32x32x16_bf16 v[112:127], v[20:23], a[92:95], v[112:127]
    ds_read_b128 v[36:39], v15 offset:31744
    v_mul_f32 v46, v70, v70
    v_mul_f32 v47, v71, v71
    v_mul_f32 v76, v68, v76
    v_mul_f32 v77, v69, v77
    v_mul_f32 v78, v70, v78
    s_barrier
    s_waitcnt lgkmcnt(3)
    v_mfma_f32_32x32x16_bf16 v[112:127], v[24:27], a[96:99], v[112:127]
    ds_read_b128 v[40:43], v3 offset:0
    v_mul_f32 v79, v71, v79
    v_fma_f32 v44, v44, v4, v5
    v_fma_f32 v45, v45, v4, v5
    v_fma_f32 v46, v46, v4, v5
    s_waitcnt lgkmcnt(3)
    v_mfma_f32_32x32x16_bf16 v[112:127], v[28:31], a[100:103], v[112:127]
    ds_read_b128 v[16:19], v3 offset:1024
    v_fma_f32 v47, v47, v4, v5
    v_mul_f32 v68, v44, v68
    v_mul_f32 v69, v45, v69
    v_mul_f32 v70, v46, v70
    s_waitcnt lgkmcnt(3)
    v_mfma_f32_32x32x16_bf16 v[112:127], v[32:35], a[104:107], v[112:127]
    ds_read_b128 v[20:23], v3 offset:2048
    v_mul_f32 v71, v47, v71
    v_exp_f32 v68, v68
    v_exp_f32 v69, v69
    v_exp_f32 v70, v70
    v_exp_f32 v71, v71
    s_waitcnt lgkmcnt(3)
    v_mfma_f32_32x32x16_bf16 v[112:127], v[36:39], a[108:111], v[112:127]
    ds_read_b128 v[24:27], v3 offset:3072
    v_fma_f32 v68, v68, v13, v13
    v_fma_f32 v69, v69, v13, v13
    v_fma_f32 v70, v70, v13, v13
    v_fma_f32 v71, v71, v13, v13
    s_waitcnt lgkmcnt(3)
    v_mfma_f32_32x32x16_bf16 v[112:127], v[40:43], a[112:115], v[112:127]
    ds_read_b128 v[28:31], v3 offset:4096
    v_rcp_f32 v68, v68
    v_rcp_f32 v69, v69
    v_rcp_f32 v70, v70
    v_rcp_f32 v71, v71
    s_waitcnt lgkmcnt(3)
    v_mfma_f32_32x32x16_bf16 v[112:127], v[16:19], a[116:119], v[112:127]
    ds_read_b128 v[32:35], v3 offset:5120
    v_mul_f32 v68, v68, v76
    v_mul_f32 v69, v69, v77
    v_mul_f32 v70, v70, v78
    v_mul_f32 v71, v71, v79
    s_waitcnt lgkmcnt(3)
    v_mfma_f32_32x32x16_bf16 v[112:127], v[20:23], a[120:123], v[112:127]
    ds_read_b128 v[36:39], v3 offset:6144
    v_cvt_pk_bf16_f32 v74, v68, v69
    v_cvt_pk_bf16_f32 v75, v70, v71
    buffer_store_dwordx4 v[72:75], v3, s[8:11], s19 offen offset:1024 sc1
    v_mul_f32 v44, v80, v80
    v_mul_f32 v45, v81, v81
    s_waitcnt lgkmcnt(3)
    v_mfma_f32_32x32x16_bf16 v[112:127], v[24:27], a[124:127], v[112:127]
    ds_read_b128 v[40:43], v3 offset:7168
    v_mul_f32 v46, v82, v82
    v_mul_f32 v47, v83, v83
    v_mul_f32 v88, v80, v88
    v_mul_f32 v89, v81, v89
    s_waitcnt lgkmcnt(3)
    v_mfma_f32_32x32x16_bf16 v[112:127], v[28:31], v[8:11], v[112:127]
    ds_read_b128 v[16:19], v3 offset:8192
    v_mul_f32 v90, v82, v90
    v_mul_f32 v91, v83, v91
    v_fma_f32 v44, v44, v4, v5
    v_fma_f32 v45, v45, v4, v5
    s_waitcnt lgkmcnt(3)
    v_mfma_f32_32x32x16_bf16 v[48:63], v[32:35], a[0:3], 0
    ds_read_b128 v[20:23], v3 offset:9216
    v_fma_f32 v46, v46, v4, v5
    v_fma_f32 v47, v47, v4, v5
    v_mul_f32 v80, v44, v80
    v_mul_f32 v81, v45, v81
    v_mul_f32 v82, v46, v82
    s_waitcnt lgkmcnt(3)
    v_mfma_f32_32x32x16_bf16 v[48:63], v[36:39], a[4:7], v[48:63]
    ds_read_b128 v[24:27], v3 offset:10240
    v_mul_f32 v83, v47, v83
    v_exp_f32 v80, v80
    v_exp_f32 v81, v81
    v_exp_f32 v82, v82
    s_waitcnt lgkmcnt(3)
    v_mfma_f32_32x32x16_bf16 v[48:63], v[40:43], a[8:11], v[48:63]
    ds_read_b128 v[28:31], v3 offset:11264
    v_exp_f32 v83, v83
    v_fma_f32 v80, v80, v13, v13
    v_fma_f32 v81, v81, v13, v13
    v_fma_f32 v82, v82, v13, v13
    s_waitcnt lgkmcnt(3)
    v_mfma_f32_32x32x16_bf16 v[48:63], v[16:19], a[12:15], v[48:63]
    ds_read_b128 v[32:35], v3 offset:12288
    v_fma_f32 v83, v83, v13, v13
    v_rcp_f32 v80, v80
    v_rcp_f32 v81, v81
    v_rcp_f32 v82, v82
    v_rcp_f32 v83, v83
    s_waitcnt lgkmcnt(3)
    v_mfma_f32_32x32x16_bf16 v[48:63], v[20:23], a[16:19], v[48:63]
    ds_read_b128 v[36:39], v3 offset:13312
    v_mul_f32 v80, v80, v88
    v_mul_f32 v81, v81, v89
    v_mul_f32 v82, v82, v90
    v_mul_f32 v83, v83, v91
    s_waitcnt lgkmcnt(3)
    v_mfma_f32_32x32x16_bf16 v[48:63], v[24:27], a[20:23], v[48:63]
    ds_read_b128 v[40:43], v3 offset:14336
    v_cvt_pk_bf16_f32 v88, v80, v81
    v_cvt_pk_bf16_f32 v89, v82, v83
    v_mul_f32 v44, v84, v84
    v_mul_f32 v45, v85, v85
    s_waitcnt lgkmcnt(3)
    v_mfma_f32_32x32x16_bf16 v[48:63], v[28:31], a[24:27], v[48:63]
    ds_read_b128 v[16:19], v3 offset:15360
    v_mul_f32 v46, v86, v86
    v_mul_f32 v47, v87, v87
    v_mul_f32 v92, v84, v92
    v_mul_f32 v93, v85, v93
    s_waitcnt lgkmcnt(3)
    v_mfma_f32_32x32x16_bf16 v[48:63], v[32:35], a[28:31], v[48:63]
    ds_read_b128 v[20:23], v3 offset:16384
    v_mul_f32 v94, v86, v94
    v_mul_f32 v95, v87, v95
    v_fma_f32 v44, v44, v4, v5
    v_fma_f32 v45, v45, v4, v5
    v_fma_f32 v46, v46, v4, v5
    s_waitcnt lgkmcnt(3)
    v_mfma_f32_32x32x16_bf16 v[48:63], v[36:39], a[32:35], v[48:63]
    ds_read_b128 v[24:27], v3 offset:17408
    v_fma_f32 v47, v47, v4, v5
    v_mul_f32 v84, v44, v84
    v_mul_f32 v85, v45, v85
    v_mul_f32 v86, v46, v86
    s_waitcnt lgkmcnt(3)
    v_mfma_f32_32x32x16_bf16 v[48:63], v[40:43], a[36:39], v[48:63]
    ds_read_b128 v[28:31], v3 offset:18432
    v_mul_f32 v87, v47, v87
    v_exp_f32 v84, v84
    v_exp_f32 v85, v85
    v_exp_f32 v86, v86
    s_waitcnt lgkmcnt(3)
    v_mfma_f32_32x32x16_bf16 v[48:63], v[16:19], a[40:43], v[48:63]
    ds_read_b128 v[32:35], v3 offset:19456
    v_exp_f32 v87, v87
    v_fma_f32 v84, v84, v13, v13
    v_fma_f32 v85, v85, v13, v13
    v_fma_f32 v86, v86, v13, v13
    v_fma_f32 v87, v87, v13, v13
    s_waitcnt lgkmcnt(3)
    v_mfma_f32_32x32x16_bf16 v[48:63], v[20:23], a[44:47], v[48:63]
    ds_read_b128 v[36:39], v3 offset:20480
    v_rcp_f32 v84, v84
    v_rcp_f32 v85, v85
    v_rcp_f32 v86, v86
    v_rcp_f32 v87, v87
    s_waitcnt lgkmcnt(3)
    v_mfma_f32_32x32x16_bf16 v[48:63], v[24:27], a[48:51], v[48:63]
    ds_read_b128 v[40:43], v3 offset:21504
    v_mul_f32 v84, v84, v92
    v_mul_f32 v85, v85, v93
    v_mul_f32 v86, v86, v94
    v_mul_f32 v87, v87, v95
    s_waitcnt lgkmcnt(3)
    v_mfma_f32_32x32x16_bf16 v[48:63], v[28:31], a[52:55], v[48:63]
    ds_read_b128 v[16:19], v3 offset:22528
    v_cvt_pk_bf16_f32 v90, v84, v85
    v_cvt_pk_bf16_f32 v91, v86, v87
    buffer_store_dwordx4 v[88:91], v3, s[8:11], s19 offen offset:2048 sc1
    v_mul_f32 v44, v96, v96
    v_mul_f32 v45, v97, v97
    s_waitcnt lgkmcnt(3)
    v_mfma_f32_32x32x16_bf16 v[48:63], v[32:35], a[56:59], v[48:63]
    ds_read_b128 v[20:23], v3 offset:23552
    v_mul_f32 v46, v98, v98
    v_mul_f32 v47, v99, v99
    v_mul_f32 v104, v96, v104
    v_mul_f32 v105, v97, v105
    s_waitcnt lgkmcnt(3)
    v_mfma_f32_32x32x16_bf16 v[48:63], v[36:39], a[60:63], v[48:63]
    ds_read_b128 v[24:27], v3 offset:24576
    v_mul_f32 v106, v98, v106
    v_mul_f32 v107, v99, v107
    v_fma_f32 v44, v44, v4, v5
    v_fma_f32 v45, v45, v4, v5
    s_waitcnt lgkmcnt(3)
    v_mfma_f32_32x32x16_bf16 v[48:63], v[40:43], a[64:67], v[48:63]
    ds_read_b128 v[28:31], v3 offset:25600
    v_fma_f32 v46, v46, v4, v5
    v_fma_f32 v47, v47, v4, v5
    v_mul_f32 v96, v44, v96
    v_mul_f32 v97, v45, v97
    s_waitcnt lgkmcnt(3)
    v_mfma_f32_32x32x16_bf16 v[48:63], v[16:19], a[68:71], v[48:63]
    ds_read_b128 v[32:35], v3 offset:26624
    v_mul_f32 v98, v46, v98
    v_mul_f32 v99, v47, v99
    v_exp_f32 v96, v96
    v_exp_f32 v97, v97
    v_exp_f32 v98, v98
    s_waitcnt lgkmcnt(3)
    v_mfma_f32_32x32x16_bf16 v[48:63], v[20:23], a[72:75], v[48:63]
    ds_read_b128 v[36:39], v3 offset:27648
    v_exp_f32 v99, v99
    v_fma_f32 v96, v96, v13, v13
    v_fma_f32 v97, v97, v13, v13
    v_fma_f32 v98, v98, v13, v13
    s_waitcnt lgkmcnt(3)
    v_mfma_f32_32x32x16_bf16 v[48:63], v[24:27], a[76:79], v[48:63]
    ds_read_b128 v[40:43], v3 offset:28672
    v_fma_f32 v99, v99, v13, v13
    v_rcp_f32 v96, v96
    v_rcp_f32 v97, v97
    v_rcp_f32 v98, v98
    s_waitcnt lgkmcnt(3)
    v_mfma_f32_32x32x16_bf16 v[48:63], v[28:31], a[80:83], v[48:63]
    ds_read_b128 v[16:19], v3 offset:29696
    v_rcp_f32 v99, v99
    v_mul_f32 v96, v96, v104
    v_mul_f32 v97, v97, v105
    v_mul_f32 v98, v98, v106
    v_mul_f32 v99, v99, v107
    s_waitcnt lgkmcnt(3)
    v_mfma_f32_32x32x16_bf16 v[48:63], v[32:35], a[84:87], v[48:63]
    ds_read_b128 v[20:23], v3 offset:30720
    v_cvt_pk_bf16_f32 v104, v96, v97
    v_cvt_pk_bf16_f32 v105, v98, v99
    v_mul_f32 v44, v100, v100
    v_mul_f32 v45, v101, v101
    s_waitcnt lgkmcnt(3)
    v_mfma_f32_32x32x16_bf16 v[48:63], v[36:39], a[88:91], v[48:63]
    ds_read_b128 v[24:27], v3 offset:31744
    v_mul_f32 v46, v102, v102
    v_mul_f32 v47, v103, v103
    v_mul_f32 v108, v100, v108
    v_mul_f32 v109, v101, v109
    s_barrier
    s_waitcnt lgkmcnt(3)
    v_mfma_f32_32x32x16_bf16 v[48:63], v[40:43], a[92:95], v[48:63]
    ds_read_b128 v[28:31], v3 offset:32768
    v_mul_f32 v110, v102, v110
    v_mul_f32 v111, v103, v111
    v_fma_f32 v44, v44, v4, v5
    v_fma_f32 v45, v45, v4, v5
    v_fma_f32 v46, v46, v4, v5
    s_waitcnt lgkmcnt(3)
    v_mfma_f32_32x32x16_bf16 v[48:63], v[16:19], a[96:99], v[48:63]
    ds_read_b128 v[32:35], v3 offset:33792
    v_fma_f32 v47, v47, v4, v5
    v_mul_f32 v100, v44, v100
    v_mul_f32 v101, v45, v101
    v_mul_f32 v102, v46, v102
    s_waitcnt lgkmcnt(3)
    v_mfma_f32_32x32x16_bf16 v[48:63], v[20:23], a[100:103], v[48:63]
    ds_read_b128 v[36:39], v3 offset:34816
    v_mul_f32 v103, v47, v103
    v_exp_f32 v100, v100
    v_exp_f32 v101, v101
    v_exp_f32 v102, v102
    s_waitcnt lgkmcnt(3)
    v_mfma_f32_32x32x16_bf16 v[48:63], v[24:27], a[104:107], v[48:63]
    ds_read_b128 v[40:43], v3 offset:35840
    v_exp_f32 v103, v103
    v_fma_f32 v100, v100, v13, v13
    v_fma_f32 v101, v101, v13, v13
    v_fma_f32 v102, v102, v13, v13
    s_waitcnt lgkmcnt(3)
    v_mfma_f32_32x32x16_bf16 v[48:63], v[28:31], a[108:111], v[48:63]
    ds_read_b128 v[16:19], v3 offset:36864
    v_fma_f32 v103, v103, v13, v13
    v_rcp_f32 v100, v100
    v_rcp_f32 v101, v101
    v_rcp_f32 v102, v102
    v_rcp_f32 v103, v103
    s_waitcnt lgkmcnt(3)
    v_mfma_f32_32x32x16_bf16 v[48:63], v[32:35], a[112:115], v[48:63]
    ds_read_b128 v[20:23], v3 offset:37888
    v_mul_f32 v100, v100, v108
    v_mul_f32 v101, v101, v109
    v_mul_f32 v102, v102, v110
    v_mul_f32 v103, v103, v111
    s_waitcnt lgkmcnt(3)
    v_mfma_f32_32x32x16_bf16 v[48:63], v[36:39], a[116:119], v[48:63]
    ds_read_b128 v[24:27], v3 offset:38912
    v_cvt_pk_bf16_f32 v106, v100, v101
    v_cvt_pk_bf16_f32 v107, v102, v103
    buffer_store_dwordx4 v[104:107], v3, s[8:11], s19 offen offset:3072 sc1
    v_mul_f32 v44, v112, v112
    s_waitcnt lgkmcnt(3)
    v_mfma_f32_32x32x16_bf16 v[48:63], v[40:43], a[120:123], v[48:63]
    ds_read_b128 v[28:31], v3 offset:39936
    v_mul_f32 v45, v113, v113
    v_mul_f32 v46, v114, v114
    v_mul_f32 v47, v115, v115
    v_mul_f32 v120, v112, v120
    v_mul_f32 v121, v113, v121
    s_waitcnt lgkmcnt(3)
    v_mfma_f32_32x32x16_bf16 v[48:63], v[16:19], a[124:127], v[48:63]
    ds_read_b128 v[32:35], v3 offset:40960
    v_mul_f32 v122, v114, v122
    v_mul_f32 v123, v115, v123
    v_fma_f32 v44, v44, v4, v5
    v_fma_f32 v45, v45, v4, v5
    s_waitcnt lgkmcnt(3)
    v_mfma_f32_32x32x16_bf16 v[48:63], v[20:23], v[8:11], v[48:63]
    ds_read_b128 v[36:39], v3 offset:41984
    v_fma_f32 v46, v46, v4, v5
    v_fma_f32 v47, v47, v4, v5
    v_mul_f32 v112, v44, v112
    v_mul_f32 v113, v45, v113
    s_waitcnt lgkmcnt(3)
    v_mfma_f32_32x32x16_bf16 v[64:79], v[24:27], a[0:3], 0
    ds_read_b128 v[40:43], v3 offset:43008
    v_mul_f32 v114, v46, v114
    v_mul_f32 v115, v47, v115
    v_exp_f32 v112, v112
    v_exp_f32 v113, v113
    v_exp_f32 v114, v114
    s_waitcnt lgkmcnt(3)
    v_mfma_f32_32x32x16_bf16 v[64:79], v[28:31], a[4:7], v[64:79]
    ds_read_b128 v[16:19], v3 offset:44032
    v_exp_f32 v115, v115
    v_fma_f32 v112, v112, v13, v13
    v_fma_f32 v113, v113, v13, v13
    v_fma_f32 v114, v114, v13, v13
    s_waitcnt lgkmcnt(3)
    v_mfma_f32_32x32x16_bf16 v[64:79], v[32:35], a[8:11], v[64:79]
    ds_read_b128 v[20:23], v3 offset:45056
    v_fma_f32 v115, v115, v13, v13
    v_rcp_f32 v112, v112
    v_rcp_f32 v113, v113
    v_rcp_f32 v114, v114
    s_waitcnt lgkmcnt(3)
    v_mfma_f32_32x32x16_bf16 v[64:79], v[36:39], a[12:15], v[64:79]
    ds_read_b128 v[24:27], v3 offset:46080
    v_rcp_f32 v115, v115
    v_mul_f32 v112, v112, v120
    v_mul_f32 v113, v113, v121
    v_mul_f32 v114, v114, v122
    s_waitcnt lgkmcnt(3)
    v_mfma_f32_32x32x16_bf16 v[64:79], v[40:43], a[16:19], v[64:79]
    ds_read_b128 v[28:31], v3 offset:47104
    v_mul_f32 v115, v115, v123
    v_cvt_pk_bf16_f32 v120, v112, v113
    v_cvt_pk_bf16_f32 v121, v114, v115
    v_mul_f32 v44, v116, v116
    v_mul_f32 v45, v117, v117
    s_waitcnt lgkmcnt(3)
    v_mfma_f32_32x32x16_bf16 v[64:79], v[16:19], a[20:23], v[64:79]
    ds_read_b128 v[32:35], v3 offset:48128
    v_mul_f32 v46, v118, v118
    v_mul_f32 v47, v119, v119
    v_mul_f32 v124, v116, v124
    v_mul_f32 v125, v117, v125
    s_waitcnt lgkmcnt(3)
    v_mfma_f32_32x32x16_bf16 v[64:79], v[20:23], a[24:27], v[64:79]
    ds_read_b128 v[36:39], v3 offset:49152
    v_mul_f32 v126, v118, v126
    v_mul_f32 v127, v119, v127
    v_fma_f32 v44, v44, v4, v5
    v_fma_f32 v45, v45, v4, v5
    s_waitcnt lgkmcnt(3)
    v_mfma_f32_32x32x16_bf16 v[64:79], v[24:27], a[28:31], v[64:79]
    ds_read_b128 v[40:43], v3 offset:50176
    v_fma_f32 v46, v46, v4, v5
    v_fma_f32 v47, v47, v4, v5
    v_mul_f32 v116, v44, v116
    v_mul_f32 v117, v45, v117
    v_mul_f32 v118, v46, v118
    s_waitcnt lgkmcnt(3)
    v_mfma_f32_32x32x16_bf16 v[64:79], v[28:31], a[32:35], v[64:79]
    ds_read_b128 v[16:19], v3 offset:51200
    v_mul_f32 v119, v47, v119
    v_exp_f32 v116, v116
    v_exp_f32 v117, v117
    v_exp_f32 v118, v118
    s_waitcnt lgkmcnt(3)
    v_mfma_f32_32x32x16_bf16 v[64:79], v[32:35], a[36:39], v[64:79]
    ds_read_b128 v[20:23], v3 offset:52224
    v_exp_f32 v119, v119
    v_fma_f32 v116, v116, v13, v13
    v_fma_f32 v117, v117, v13, v13
    v_fma_f32 v118, v118, v13, v13
    s_waitcnt lgkmcnt(3)
    v_mfma_f32_32x32x16_bf16 v[64:79], v[36:39], a[40:43], v[64:79]
    ds_read_b128 v[24:27], v3 offset:53248
    v_fma_f32 v119, v119, v13, v13
    v_rcp_f32 v116, v116
    v_rcp_f32 v117, v117
    v_rcp_f32 v118, v118
    v_rcp_f32 v119, v119
    s_waitcnt lgkmcnt(3)
    v_mfma_f32_32x32x16_bf16 v[64:79], v[40:43], a[44:47], v[64:79]
    ds_read_b128 v[28:31], v3 offset:54272
    v_mul_f32 v116, v116, v124
    v_mul_f32 v117, v117, v125
    v_mul_f32 v118, v118, v126
    v_mul_f32 v119, v119, v127
    s_waitcnt lgkmcnt(3)
    v_mfma_f32_32x32x16_bf16 v[64:79], v[16:19], a[48:51], v[64:79]
    ds_read_b128 v[32:35], v3 offset:55296
    v_cvt_pk_bf16_f32 v122, v116, v117
    v_cvt_pk_bf16_f32 v123, v118, v119
    s_add_u32 s19, s19, 4096
    buffer_store_dwordx4 v[120:123], v3, s[8:11], s19 offen offset:0 sc1
    v_mul_f32 v44, v48, v48
    s_waitcnt lgkmcnt(3)
    v_mfma_f32_32x32x16_bf16 v[64:79], v[20:23], a[52:55], v[64:79]
    ds_read_b128 v[36:39], v3 offset:56320
    v_mul_f32 v45, v49, v49
    v_mul_f32 v46, v50, v50
    v_mul_f32 v47, v51, v51
    v_mul_f32 v56, v48, v56
    s_waitcnt lgkmcnt(3)
    v_mfma_f32_32x32x16_bf16 v[64:79], v[24:27], a[56:59], v[64:79]
    ds_read_b128 v[40:43], v3 offset:57344
    v_mul_f32 v57, v49, v57
    v_mul_f32 v58, v50, v58
    v_mul_f32 v59, v51, v59
    v_fma_f32 v44, v44, v4, v5
    v_fma_f32 v45, v45, v4, v5
    s_waitcnt lgkmcnt(3)
    v_mfma_f32_32x32x16_bf16 v[64:79], v[28:31], a[60:63], v[64:79]
    ds_read_b128 v[16:19], v3 offset:58368
    v_fma_f32 v46, v46, v4, v5
    v_fma_f32 v47, v47, v4, v5
    v_mul_f32 v48, v44, v48
    v_mul_f32 v49, v45, v49
    s_waitcnt lgkmcnt(3)
    v_mfma_f32_32x32x16_bf16 v[64:79], v[32:35], a[64:67], v[64:79]
    ds_read_b128 v[20:23], v3 offset:59392
    v_mul_f32 v50, v46, v50
    v_mul_f32 v51, v47, v51
    v_exp_f32 v48, v48
    v_exp_f32 v49, v49
    s_waitcnt lgkmcnt(3)
    v_mfma_f32_32x32x16_bf16 v[64:79], v[36:39], a[68:71], v[64:79]
    ds_read_b128 v[24:27], v3 offset:60416
    v_exp_f32 v50, v50
    v_exp_f32 v51, v51
    v_fma_f32 v48, v48, v13, v13
    v_fma_f32 v49, v49, v13, v13
    v_fma_f32 v50, v50, v13, v13
    s_waitcnt lgkmcnt(3)
    v_mfma_f32_32x32x16_bf16 v[64:79], v[40:43], a[72:75], v[64:79]
    ds_read_b128 v[28:31], v3 offset:61440
    v_fma_f32 v51, v51, v13, v13
    v_rcp_f32 v48, v48
    v_rcp_f32 v49, v49
    v_rcp_f32 v50, v50
    s_waitcnt lgkmcnt(3)
    v_mfma_f32_32x32x16_bf16 v[64:79], v[16:19], a[76:79], v[64:79]
    ds_read_b128 v[32:35], v3 offset:62464
    v_rcp_f32 v51, v51
    v_mul_f32 v48, v48, v56
    v_mul_f32 v49, v49, v57
    v_mul_f32 v50, v50, v58
    s_waitcnt lgkmcnt(3)
    v_mfma_f32_32x32x16_bf16 v[64:79], v[20:23], a[80:83], v[64:79]
    ds_read_b128 v[36:39], v3 offset:63488
    v_mul_f32 v51, v51, v59
    v_cvt_pk_bf16_f32 v56, v48, v49
    v_cvt_pk_bf16_f32 v57, v50, v51
    v_mul_f32 v44, v52, v52
    v_mul_f32 v45, v53, v53
    s_waitcnt lgkmcnt(3)
    v_mfma_f32_32x32x16_bf16 v[64:79], v[24:27], a[84:87], v[64:79]
    ds_read_b128 v[40:43], v3 offset:64512
    v_mul_f32 v46, v54, v54
    v_mul_f32 v47, v55, v55
    v_mul_f32 v60, v52, v60
    v_mul_f32 v61, v53, v61
    s_barrier
    s_waitcnt lgkmcnt(3)
    v_mfma_f32_32x32x16_bf16 v[64:79], v[28:31], a[88:91], v[64:79]
    ds_read_b128 v[16:19], v14 offset:0
    v_mul_f32 v62, v54, v62
    v_mul_f32 v63, v55, v63
    v_fma_f32 v44, v44, v4, v5
    v_fma_f32 v45, v45, v4, v5
    s_waitcnt lgkmcnt(3)
    v_mfma_f32_32x32x16_bf16 v[64:79], v[32:35], a[92:95], v[64:79]
    ds_read_b128 v[20:23], v14 offset:1024
    v_fma_f32 v46, v46, v4, v5
    v_fma_f32 v47, v47, v4, v5
    v_mul_f32 v52, v44, v52
    v_mul_f32 v53, v45, v53
    s_waitcnt lgkmcnt(3)
    v_mfma_f32_32x32x16_bf16 v[64:79], v[36:39], a[96:99], v[64:79]
    ds_read_b128 v[24:27], v14 offset:2048
    v_mul_f32 v54, v46, v54
    v_mul_f32 v55, v47, v55
    v_exp_f32 v52, v52
    v_exp_f32 v53, v53
    v_exp_f32 v54, v54
    s_waitcnt lgkmcnt(3)
    v_mfma_f32_32x32x16_bf16 v[64:79], v[40:43], a[100:103], v[64:79]
    ds_read_b128 v[28:31], v14 offset:3072
    v_exp_f32 v55, v55
    v_fma_f32 v52, v52, v13, v13
    v_fma_f32 v53, v53, v13, v13
    v_fma_f32 v54, v54, v13, v13
    s_waitcnt lgkmcnt(3)
    v_mfma_f32_32x32x16_bf16 v[64:79], v[16:19], a[104:107], v[64:79]
    ds_read_b128 v[32:35], v14 offset:4096
    v_fma_f32 v55, v55, v13, v13
    v_rcp_f32 v52, v52
    v_rcp_f32 v53, v53
    v_rcp_f32 v54, v54
    s_waitcnt lgkmcnt(3)
    v_mfma_f32_32x32x16_bf16 v[64:79], v[20:23], a[108:111], v[64:79]
    ds_read_b128 v[36:39], v14 offset:5120
    v_rcp_f32 v55, v55
    v_mul_f32 v52, v52, v60
    v_mul_f32 v53, v53, v61
    v_mul_f32 v54, v54, v62
    v_mul_f32 v55, v55, v63
    s_waitcnt lgkmcnt(3)
    v_mfma_f32_32x32x16_bf16 v[64:79], v[24:27], a[112:115], v[64:79]
    ds_read_b128 v[40:43], v14 offset:6144
    v_cvt_pk_bf16_f32 v58, v52, v53
    v_cvt_pk_bf16_f32 v59, v54, v55
    buffer_store_dwordx4 v[56:59], v3, s[8:11], s19 offen offset:1024 sc1
    s_waitcnt lgkmcnt(3)
    v_mfma_f32_32x32x16_bf16 v[64:79], v[28:31], a[116:119], v[64:79]
    s_waitcnt lgkmcnt(2)
    v_mfma_f32_32x32x16_bf16 v[64:79], v[32:35], a[120:123], v[64:79]
    s_waitcnt lgkmcnt(1)
    v_mfma_f32_32x32x16_bf16 v[64:79], v[36:39], a[124:127], v[64:79]
    s_waitcnt lgkmcnt(0)
    v_mfma_f32_32x32x16_bf16 v[64:79], v[40:43], v[8:11], v[64:79]
    s_nop 11
    v_mul_f32 v44, v64, v64
    v_mul_f32 v45, v65, v65
    v_mul_f32 v46, v66, v66
    v_mul_f32 v47, v67, v67
    v_mul_f32 v72, v64, v72
    v_mul_f32 v73, v65, v73
    v_mul_f32 v74, v66, v74
    v_mul_f32 v75, v67, v75
    v_fma_f32 v44, v44, v4, v5
    v_fma_f32 v45, v45, v4, v5
    v_fma_f32 v46, v46, v4, v5
    v_fma_f32 v47, v47, v4, v5
    v_mul_f32 v64, v44, v64
    v_mul_f32 v65, v45, v65
    v_mul_f32 v66, v46, v66
    v_mul_f32 v67, v47, v67
    v_exp_f32 v64, v64
    v_exp_f32 v65, v65
    v_exp_f32 v66, v66
    v_exp_f32 v67, v67
    v_fma_f32 v64, v64, v13, v13
    v_fma_f32 v65, v65, v13, v13
    v_fma_f32 v66, v66, v13, v13
    v_fma_f32 v67, v67, v13, v13
    v_rcp_f32 v64, v64
    v_rcp_f32 v65, v65
    v_rcp_f32 v66, v66
    v_rcp_f32 v67, v67
    v_mul_f32 v64, v64, v72
    v_mul_f32 v65, v65, v73
    v_mul_f32 v66, v66, v74
    v_mul_f32 v67, v67, v75
    v_cvt_pk_bf16_f32 v72, v64, v65
    v_cvt_pk_bf16_f32 v73, v66, v67
    v_mul_f32 v44, v68, v68
    v_mul_f32 v45, v69, v69
    v_mul_f32 v46, v70, v70
    v_mul_f32 v47, v71, v71
    v_mul_f32 v76, v68, v76
    v_mul_f32 v77, v69, v77
    v_mul_f32 v78, v70, v78
    v_mul_f32 v79, v71, v79
    v_fma_f32 v44, v44, v4, v5
    v_fma_f32 v45, v45, v4, v5
    v_fma_f32 v46, v46, v4, v5
    v_fma_f32 v47, v47, v4, v5
    v_mul_f32 v68, v44, v68
    v_mul_f32 v69, v45, v69
    v_mul_f32 v70, v46, v70
    v_mul_f32 v71, v47, v71
    v_exp_f32 v68, v68
    v_exp_f32 v69, v69
    v_exp_f32 v70, v70
    v_exp_f32 v71, v71
    v_fma_f32 v68, v68, v13, v13
    v_fma_f32 v69, v69, v13, v13
    v_fma_f32 v70, v70, v13, v13
    v_fma_f32 v71, v71, v13, v13
    v_rcp_f32 v68, v68
    v_rcp_f32 v69, v69
    v_rcp_f32 v70, v70
    v_rcp_f32 v71, v71
    v_mul_f32 v68, v68, v76
    v_mul_f32 v69, v69, v77
    v_mul_f32 v70, v70, v78
    v_mul_f32 v71, v71, v79
    v_cvt_pk_bf16_f32 v74, v68, v69
    v_cvt_pk_bf16_f32 v75, v70, v71
    buffer_store_dwordx4 v[72:75], v3, s[8:11], s19 offen offset:2048 sc1
    v_mov_b32 v8, 0
    v_mov_b32 v9, 1
    s_waitcnt vmcnt(0)
    s_mov_b64 exec, 1
    s_cmp_eq_u32 s56, 0
    s_cbranch_scc1 FK_pb3_f
    buffer_store_byte v9, v8, s[8:11], s22 offen sc0 sc1
    s_branch FK_pb3_d
FK_pb3_f:
    buffer_store_byte v9, v8, s[8:11], s22 offen
FK_pb3_d:
    s_mov_b64 exec, -1
    s_cmp_eq_u32 s43, 1
    s_cbranch_scc0 FK_X2
    s_endpgm
FK_X2:
    s_mul_i32 s15, s53, 102400
    s_mul_i32 s16, s4, 25600
    s_add_u32 s17, s15, s16
    v_add_u32 v4, s16, v3
    s_waitcnt vmcnt(0)
    s_barrier
    s_mov_b32 m0, s16
    s_nop 0
    buffer_load_dwordx4 v3, s[8:11], s17 offen offset:0 lds
    buffer_load_dwordx4 v3, s[8:11], s17 offen offset:1024 lds
    buffer_load_dwordx4 v3, s[8:11], s17 offen offset:2048 lds
    buffer_load_dwordx4 v3, s[8:11], s17 offen offset:3072 lds
    s_add_u32 s16, s16, 4096
    s_add_u32 s17, s17, 4096
    s_mov_b32 m0, s16
    s_nop 0
    buffer_load_dwordx4 v3, s[8:11], s17 offen offset:0 lds
    buffer_load_dwordx4 v3, s[8:11], s17 offen offset:1024 lds
    buffer_load_dwordx4 v3, s[8:11], s17 offen offset:2048 lds
    buffer_load_dwordx4 v3, s[8:11], s17 offen offset:3072 lds
    s_add_u32 s16, s16, 4096
    s_add_u32 s17, s17, 4096
    s_mov_b32 m0, s16
    s_nop 0
    buffer_load_dwordx4 v3, s[8:11], s17 offen offset:0 lds
    buffer_load_dwordx4 v3, s[8:11], s17 offen offset:1024 lds
    buffer_load_dwordx4 v3, s[8:11], s17 offen offset:2048 lds
    buffer_load_dwordx4 v3, s[8:11], s17 offen offset:3072 lds
    s_add_u32 s16, s16, 4096
    s_add_u32 s17, s17, 4096
    s_mov_b32 m0, s16
    s_nop 0
    buffer_load_dwordx4 v3, s[8:11], s17 offen offset:0 lds
    buffer_load_dwordx4 v3, s[8:11], s17 offen offset:1024 lds
    buffer_load_dwordx4 v3, s[8:11], s17 offen offset:2048 lds
    buffer_load_dwordx4 v3, s[8:11], s17 offen offset:3072 lds
    s_add_u32 s16, s16, 4096
    s_add_u32 s17, s17, 4096
    s_barrier
    s_mov_b32 m0, s16
    s_nop 0
    buffer_load_dwordx4 v3, s[8:11], s17 offen offset:0 lds
    buffer_load_dwordx4 v3, s[8:11], s17 offen offset:1024 lds
    buffer_load_dwordx4 v3, s[8:11], s17 offen offset:2048 lds
    buffer_load_dwordx4 v3, s[8:11], s17 offen offset:3072 lds
    s_add_u32 s16, s16, 4096
    s_add_u32 s17, s17, 4096
    s_mov_b32 m0, s16
    s_nop 0
    buffer_load_dwordx4 v3, s[8:11], s17 offen offset:0 lds
    buffer_load_dwordx4 v3, s[8:11], s17 offen offset:1024 lds
    buffer_load_dwordx4 v3, s[8:11], s17 offen offset:2048 lds
    buffer_load_dwordx4 v3, s[8:11], s17 offen offset:3072 lds
    s_add_u32 s16, s16, 4096
    s_add_u32 s17, s17, 4096
    s_mov_b32 m0, s16
    s_nop 0
    buffer_load_dwordx4 v3, s[8:11], s17 offen offset:0 lds
    s_add_u32 s16, s16, 4096
    s_add_u32 s17, s17, 4096
    s_waitcnt lgkmcnt(0)
    s_mov_b32 s6, s53
    s_mov_b32 s42, 12582912
    s_mov_b32 s41, 27328512
    s_add_u32 s14, s13, 10485760
    s_add_u32 s31, s31, 0x2000
    s_add_u32 s22, s22, 0x1800
    s_waitcnt vmcnt(0)
    s_lshl_b32 s19, s12, 12
    s_add_u32 s19, s19, s42
    v_and_b32 v4, 31, v2
    v_lshlrev_b32 v4, 4, v4
    v_lshrrev_b32 v5, 5, v2
    v_lshlrev_b32 v5, 11, v5
    v_add_u32 v4, v4, v5
    v_add_u32 v14, 0x10000, v3
    s_lshl_b32 s18, s4, 11
    s_add_u32 s18, s18, 114688
    v_add_u32 v1, s18, v3
    s_lshl_b32 s18, s4, 7
    s_add_u32 s18, s18, 102400
    v_and_b32 v5, 31, v2
    v_lshlrev_b32 v5, 2, v5
    v_add_u32 v5, s18, v5
    v_lshrrev_b32 v6, 5, v2
    v_lshlrev_b32 v6, 4, v6
    v_add_u32 v6, s18, v6
    s_barrier
    v_mov_b32 v12, 0
    s_mov_b32 s59, 0
    s_mov_b64 exec, 1
FK_pl4:
    buffer_load_dwordx4 v[8:11], v12, s[8:11], s31 offen sc1
    s_waitcnt vmcnt(0)
    v_and_b32 v8, v8, v9
    v_and_b32 v10, v10, v11
    v_and_b32 v8, v8, v10
    s_nop 0
    v_readfirstlane_b32 s58, v8
    s_add_u32 s59, s59, 1
    s_cmp_gt_u32 s59, 0x40000
    s_cbranch_scc1 FK_pl4_out
    s_cmp_lg_u32 s58, 0x01010101
    s_cbranch_scc1 FK_pl4
FK_pl4_out:
    s_mov_b64 exec, -1
    buffer_load_dwordx4 a[0:3], v3, s[8:11], s14 offen offset:0 sc1
    buffer_load_dwordx4 a[4:7], v3, s[8:11], s14 offen offset:1024 sc1
    buffer_load_dwordx4 a[8:11], v3, s[8:11], s14 offen offset:2048 sc1
    buffer_load_dwordx4 a[12:15], v3, s[8:11], s14 offen offset:3072 sc1
    s_add_u32 s14, s14, 4096
    buffer_load_dwordx4 a[16:19], v3, s[8:11], s14 offen offset:0 sc1
    buffer_load_dwordx4 a[20:23], v3, s[8:11], s14 offen offset:1024 sc1
    buffer_load_dwordx4 a[24:27], v3, s[8:11], s14 offen offset:2048 sc1
    buffer_load_dwordx4 a[28:31], v3, s[8:11], s14 offen offset:3072 sc1
    s_add_u32 s14, s14, 4096
    buffer_load_dwordx4 a[32:35], v3, s[8:11], s14 offen offset:0 sc1
    buffer_load_dwordx4 a[36:39], v3, s[8:11], s14 offen offset:1024 sc1
    buffer_load_dwordx4 a[40:43], v3, s[8:11], s14 offen offset:2048 sc1
    buffer_load_dwordx4 a[44:47], v3, s[8:11], s14 offen offset:3072 sc1
    s_add_u32 s14, s14, 4096
    buffer_load_dwordx4 v[112:115], v4, s[8:11], s19 offen offset:0 sc1
    buffer_load_dwordx4 v[116:119], v4, s[8:11], s19 offen offset:512 sc1
    buffer_load_dwordx4 v[120:123], v4, s[8:11], s19 offen offset:1024 sc1
    buffer_load_dwordx4 v[124:127], v4, s[8:11], s19 offen offset:1536 sc1
    ds_read_b128 v[16:19], v3 offset:0
    ds_read_b128 v[20:23], v3 offset:1024
    ds_read_b128 v[24:27], v3 offset:3072
    s_waitcnt vmcnt(15)
    s_waitcnt lgkmcnt(2)
    v_mfma_f32_32x32x16_bf16 v[64:79], a[0:3], v[16:19], 0
    ds_read_b128 v[28:31], v3 offset:4096
    buffer_load_dwordx4 a[48:51], v3, s[8:11], s14 offen offset:0 sc1
    s_waitcnt lgkmcnt(2)
    v_mfma_f32_32x32x16_bf16 v[80:95], a[0:3], v[20:23], 0
    ds_read_b128 v[32:35], v3 offset:6144
    s_waitcnt vmcnt(15)
    s_waitcnt lgkmcnt(2)
    v_mfma_f32_32x32x16_bf16 v[64:79], a[4:7], v[24:27], v[64:79]
    ds_read_b128 v[36:39], v3 offset:7168
    buffer_load_dwordx4 a[52:55], v3, s[8:11], s14 offen offset:1024 sc1
    s_waitcnt lgkmcnt(2)
    v_mfma_f32_32x32x16_bf16 v[80:95], a[4:7], v[28:31], v[80:95]
    ds_read_b128 v[16:19], v3 offset:9216
    s_waitcnt vmcnt(15)
    s_waitcnt lgkmcnt(2)
    v_mfma_f32_32x32x16_bf16 v[64:79], a[8:11], v[32:35], v[64:79]
    ds_read_b128 v[20:23], v3 offset:10240
    buffer_load_dwordx4 a[56:59], v3, s[8:11], s14 offen offset:2048 sc1
    s_waitcnt lgkmcnt(2)
    v_mfma_f32_32x32x16_bf16 v[80:95], a[8:11], v[36:39], v[80:95]
    ds_read_b128 v[24:27], v3 offset:12288
    s_waitcnt vmcnt(15)
    s_waitcnt lgkmcnt(2)
    v_mfma_f32_32x32x16_bf16 v[64:79], a[12:15], v[16:19], v[64:79]
    ds_read_b128 v[28:31], v3 offset:13312
    buffer_load_dwordx4 a[60:63], v3, s[8:11], s14 offen offset:3072 sc1
    s_add_u32 s14, s14, 4096
    s_waitcnt lgkmcnt(2)
    v_mfma_f32_32x32x16_bf16 v[80:95], a[12:15], v[20:23], v[80:95]
    ds_read_b128 v[32:35], v3 offset:15360
    s_waitcnt vmcnt(15)
    s_waitcnt lgkmcnt(2)
    v_mfma_f32_32x32x16_bf16 v[64:79], a[16:19], v[24:27], v[64:79]
    ds_read_b128 v[36:39], v3 offset:16384
    buffer_load_dwordx4 a[64:67], v3, s[8:11], s14 offen offset:0 sc1
    s_waitcnt lgkmcnt(2)
    v_mfma_f32_32x32x16_bf16 v[80:95], a[16:19], v[28:31], v[80:95]
    ds_read_b128 v[16:19], v3 offset:18432
    s_waitcnt vmcnt(15)
    s_waitcnt lgkmcnt(2)
    v_mfma_f32_32x32x16_bf16 v[64:79], a[20:23], v[32:35], v[64:79]
    ds_read_b128 v[20:23], v3 offset:19456
    buffer_load_dwordx4 a[68:71], v3, s[8:11], s14 offen offset:1024 sc1
    s_waitcnt lgkmcnt(2)
    v_mfma_f32_32x32x16_bf16 v[80:95], a[20:23], v[36:39], v[80:95]
    ds_read_b128 v[24:27], v3 offset:21504
    s_waitcnt vmcnt(15)
    s_waitcnt lgkmcnt(2)
    v_mfma_f32_32x32x16_bf16 v[64:79], a[24:27], v[16:19], v[64:79]
    ds_read_b128 v[28:31], v3 offset:22528
    buffer_load_dwordx4 a[72:75], v3, s[8:11], s14 offen offset:2048 sc1
    s_waitcnt lgkmcnt(2)
    v_mfma_f32_32x32x16_bf16 v[80:95], a[24:27], v[20:23], v[80:95]
    ds_read_b128 v[32:35], v3 offset:24576
    s_waitcnt vmcnt(15)
    s_waitcnt lgkmcnt(2)
    v_mfma_f32_32x32x16_bf16 v[64:79], a[28:31], v[24:27], v[64:79]
    ds_read_b128 v[36:39], v3 offset:25600
    buffer_load_dwordx4 a[76:79], v3, s[8:11], s14 offen offset:3072 sc1
    s_add_u32 s14, s14, 4096
    s_waitcnt lgkmcnt(2)
    v_mfma_f32_32x32x16_bf16 v[80:95], a[28:31], v[28:31], v[80:95]
    ds_read_b128 v[16:19], v3 offset:27648
    s_waitcnt vmcnt(15)
    s_waitcnt lgkmcnt(2)
    v_mfma_f32_32x32x16_bf16 v[64:79], a[32:35], v[32:35], v[64:79]
    ds_read_b128 v[20:23], v3 offset:28672
    buffer_load_dwordx4 a[80:83], v3, s[8:11], s14 offen offset:0 sc1
    s_waitcnt lgkmcnt(2)
    v_mfma_f32_32x32x16_bf16 v[80:95], a[32:35], v[36:39], v[80:95]
    ds_read_b128 v[24:27], v3 offset:30720
    s_waitcnt vmcnt(15)
    s_waitcnt lgkmcnt(2)
    v_mfma_f32_32x32x16_bf16 v[64:79], a[36:39], v[16:19], v[64:79]
    ds_read_b128 v[28:31], v3 offset:31744
    buffer_load_dwordx4 a[84:87], v3, s[8:11], s14 offen offset:1024 sc1
    s_waitcnt lgkmcnt(2)
    v_mfma_f32_32x32x16_bf16 v[80:95], a[36:39], v[20:23], v[80:95]
    ds_read_b128 v[32:35], v3 offset:33792
    s_waitcnt vmcnt(15)
    s_waitcnt lgkmcnt(2)
    v_mfma_f32_32x32x16_bf16 v[64:79], a[40:43], v[24:27], v[64:79]
    ds_read_b128 v[36:39], v3 offset:34816
    buffer_load_dwordx4 a[88:91], v3, s[8:11], s14 offen offset:2048 sc1
    s_waitcnt lgkmcnt(2)
    v_mfma_f32_32x32x16_bf16 v[80:95], a[40:43], v[28:31], v[80:95]
    ds_read_b128 v[16:19], v3 offset:36864
    s_waitcnt vmcnt(15)
    s_waitcnt lgkmcnt(2)
    v_mfma_f32_32x32x16_bf16 v[64:79], a[44:47], v[32:35], v[64:79]
    ds_read_b128 v[20:23], v3 offset:37888
    buffer_load_dwordx4 a[92:95], v3, s[8:11], s14 offen offset:3072 sc1
    s_add_u32 s14, s14, 4096
    s_waitcnt lgkmcnt(2)
    v_mfma_f32_32x32x16_bf16 v[80:95], a[44:47], v[36:39], v[80:95]
    ds_read_b128 v[24:27], v3 offset:39936
    s_waitcnt vmcnt(11)
    s_waitcnt lgkmcnt(2)
    v_mfma_f32_32x32x16_bf16 v[64:79], a[48:51], v[16:19], v[64:79]
    ds_read_b128 v[28:31], v3 offset:40960
    buffer_load_dwordx4 a[96:99], v3, s[8:11], s14 offen offset:0 sc1
    s_waitcnt lgkmcnt(2)
    v_mfma_f32_32x32x16_bf16 v[80:95], a[48:51], v[20:23], v[80:95]
    ds_read_b128 v[32:35], v3 offset:43008
    s_waitcnt vmcnt(11)
    s_waitcnt lgkmcnt(2)
    v_mfma_f32_32x32x16_bf16 v[64:79], a[52:55], v[24:27], v[64:79]
    ds_read_b128 v[36:39], v3 offset:44032
    buffer_load_dwordx4 a[100:103], v3, s[8:11], s14 offen offset:1024 sc1
    s_waitcnt lgkmcnt(2)
    v_mfma_f32_32x32x16_bf16 v[80:95], a[52:55], v[28:31], v[80:95]
    ds_read_b128 v[16:19], v3 offset:46080
    s_waitcnt vmcnt(11)
    s_waitcnt lgkmcnt(2)
    v_mfma_f32_32x32x16_bf16 v[64:79], a[56:59], v[32:35], v[64:79]
    ds_read_b128 v[20:23], v3 offset:47104
    buffer_load_dwordx4 a[104:107], v3, s[8:11], s14 offen offset:2048 sc1
    s_waitcnt lgkmcnt(2)
    v_mfma_f32_32x32x16_bf16 v[80:95], a[56:59], v[36:39], v[80:95]
    ds_read_b128 v[24:27], v3 offset:49152
    s_waitcnt vmcnt(11)
    s_waitcnt lgkmcnt(2)
    v_mfma_f32_32x32x16_bf16 v[64:79], a[60:63], v[16:19], v[64:79]
    ds_read_b128 v[28:31], v3 offset:50176
    buffer_load_dwordx4 a[108:111], v3, s[8:11], s14 offen offset:3072 sc1
    s_add_u32 s14, s14, 4096
    s_waitcnt lgkmcnt(2)
    v_mfma_f32_32x32x16_bf16 v[80:95], a[60:63], v[20:23], v[80:95]
    ds_read_b128 v[32:35], v3 offset:52224
    s_waitcnt vmcnt(11)
    s_waitcnt lgkmcnt(2)
    v_mfma_f32_32x32x16_bf16 v[64:79], a[64:67], v[24:27], v[64:79]
    ds_read_b128 v[36:39], v3 offset:53248
    buffer_load_dwordx4 a[112:115], v3, s[8:11], s14 offen offset:0 sc1
    s_waitcnt lgkmcnt(2)
    v_mfma_f32_32x32x16_bf16 v[80:95], a[64:67], v[28:31], v[80:95]
    ds_read_b128 v[16:19], v3 offset:55296
    s_waitcnt vmcnt(11)
    s_waitcnt lgkmcnt(2)
    v_mfma_f32_32x32x16_bf16 v[64:79], a[68:71], v[32:35], v[64:79]
    ds_read_b128 v[20:23], v3 offset:56320
    buffer_load_dwordx4 a[116:119], v3, s[8:11], s14 offen offset:1024 sc1
    s_waitcnt lgkmcnt(2)
    v_mfma_f32_32x32x16_bf16 v[80:95], a[68:71], v[36:39], v[80:95]
    ds_read_b128 v[24:27], v3 offset:58368
    s_waitcnt vmcnt(11)
    s_waitcnt lgkmcnt(2)
    v_mfma_f32_32x32x16_bf16 v[64:79], a[72:75], v[16:19], v[64:79]
    ds_read_b128 v[28:31], v3 offset:59392
    buffer_load_dwordx4 a[120:123], v3, s[8:11], s14 offen offset:2048 sc1
    v_add_f32 v112, v112, v120
    v_add_f32 v113, v113, v121
    v_add_f32 v114, v114, v122
    v_add_f32 v115, v115, v123
    v_add_f32 v116, v116, v124
    v_add_f32 v117, v117, v125
    v_add_f32 v118, v118, v126
    v_add_f32 v119, v119, v127
    v_add_f32 v112, v112, v116
    v_add_f32 v113, v113, v117
    v_add_f32 v114, v114, v118
    v_add_f32 v115, v115, v119
    v_add_f32 v112, v112, v114
    v_add_f32 v113, v113, v115
    v_mov_b32 v114, v112
    v_mov_b32 v115, v113
    s_nop 0
    v_permlane32_swap_b32 v112, v114
    v_permlane32_swap_b32 v113, v115
    v_add_f32 v112, v112, v114
    v_add_f32 v113, v113, v115
    v_mul_f32 v112, 0xbb000000, v112
    v_mul_f32 v113, 0x3b000000, v113
    v_fma_f32 v113, -v112, v112, v113
    v_max_f32 v113, 0, v113
    v_add_f32 v13, 0x3727c5ac, v113
    v_rsq_f32 v12, v13
    v_cvt_pk_bf16_f32 v8, v112, v112
    v_and_b32 v114, 0xffff0000, v8
    v_sub_f32 v114, v112, v114
    v_cvt_pk_bf16_f32 v9, v112, v114
    v_and_b32 v115, 0xffff0000, v9
    v_sub_f32 v115, v114, v115
    v_cvt_pk_bf16_f32 v10, v114, v115
    v_mov_b32 v11, 0
    ds_write_b32 v5, v12
    s_waitcnt lgkmcnt(0)
    ds_read_b128 v[112:115], v6 offset:0
    ds_read_b128 v[116:119], v6 offset:32
    ds_read_b128 v[120:123], v6 offset:64
    ds_read_b128 v[124:127], v6 offset:96
    v_mul_f32 v15, 0x3fb8aa3b, v12
    v_and_b32 v4, 16, v2
    v_cmp_eq_u32 vcc, 0, v4
    v_mov_b32 v7, 0x3f803f80
    v_mfma_f32_32x32x16_bf16 v[80:95], a[72:75], v[20:23], v[80:95]
    ds_read_b128 v[32:35], v3 offset:61440
    s_waitcnt vmcnt(11)
    v_mfma_f32_32x32x16_bf16 v[64:79], a[76:79], v[24:27], v[64:79]
    ds_read_b128 v[36:39], v3 offset:62464
    buffer_load_dwordx4 a[124:127], v3, s[8:11], s14 offen offset:3072 sc1
    s_add_u32 s14, s14, 4096
    v_mfma_f32_32x32x16_bf16 v[80:95], a[76:79], v[28:31], v[80:95]
    ds_read_b128 v[16:19], v3 offset:64512
    s_waitcnt vmcnt(11)
    s_waitcnt lgkmcnt(2)
    v_mfma_f32_32x32x16_bf16 v[64:79], a[80:83], v[32:35], v[64:79]
    ds_read_b128 v[20:23], v14 offset:0
    s_barrier
    s_waitcnt lgkmcnt(2)
    v_mfma_f32_32x32x16_bf16 v[80:95], a[80:83], v[36:39], v[80:95]
    ds_read_b128 v[24:27], v14 offset:2048
    s_waitcnt vmcnt(10)
    s_waitcnt lgkmcnt(2)
    v_mfma_f32_32x32x16_bf16 v[64:79], a[84:87], v[16:19], v[64:79]
    ds_read_b128 v[28:31], v14 offset:3072
    v_mov_b32 v4, 0x358637bd
    v_mov_b32 v5, 0x358637bd
    v_mul_f32 v48, 0x3fb8aa3b, v112
    v_mul_f32 v49, 0x3fb8aa3b, v113
    s_waitcnt lgkmcnt(2)
    v_mfma_f32_32x32x16_bf16 v[80:95], a[84:87], v[20:23], v[80:95]
    ds_read_b128 v[32:35], v14 offset:5120
    v_mul_f32 v50, 0x3fb8aa3b, v114
    v_mul_f32 v51, 0x3fb8aa3b, v115
    s_waitcnt vmcnt(9)
    s_waitcnt lgkmcnt(2)
    v_mfma_f32_32x32x16_bf16 v[64:79], a[88:91], v[24:27], v[64:79]
    ds_read_b128 v[36:39], v14 offset:6144
    v_mul_f32 v52, 0x3fb8aa3b, v116
    v_mul_f32 v53, 0x3fb8aa3b, v117
    s_waitcnt lgkmcnt(2)
    v_mfma_f32_32x32x16_bf16 v[80:95], a[88:91], v[28:31], v[80:95]
    ds_read_b128 v[16:19], v14 offset:8192
    v_mul_f32 v54, 0x3fb8aa3b, v118
    v_mul_f32 v55, 0x3fb8aa3b, v119
    s_waitcnt vmcnt(8)
    s_waitcnt lgkmcnt(2)
    v_mfma_f32_32x32x16_bf16 v[64:79], a[92:95], v[32:35], v[64:79]
    ds_read_b128 v[20:23], v14 offset:9216
    v_mul_f32 v56, 0x3fb8aa3b, v120
    v_mul_f32 v57, 0x3fb8aa3b, v121
    s_waitcnt lgkmcnt(2)
    v_mfma_f32_32x32x16_bf16 v[80:95], a[92:95], v[36:39], v[80:95]
    ds_read_b128 v[24:27], v14 offset:32768
    v_mul_f32 v58, 0x3fb8aa3b, v122
    v_mul_f32 v59, 0x3fb8aa3b, v123
    s_waitcnt vmcnt(7)
    s_waitcnt lgkmcnt(2)
    v_mfma_f32_32x32x16_bf16 v[64:79], a[96:99], v[16:19], v[64:79]
    ds_read_b128 v[28:31], v14 offset:33792
    v_mul_f32 v60, 0x3fb8aa3b, v124
    v_mul_f32 v61, 0x3fb8aa3b, v125
    s_waitcnt lgkmcnt(2)
    v_mfma_f32_32x32x16_bf16 v[80:95], a[96:99], v[20:23], v[80:95]
    ds_read_b128 v[32:35], v14 offset:11264
    v_mul_f32 v62, 0x3fb8aa3b, v126
    v_mul_f32 v63, 0x3fb8aa3b, v127
    s_waitcnt lgkmcnt(2)
    v_mfma_f32_32x32x16_bf16 v[64:79], v[8:11], v[24:27], v[64:79]
    ds_read_b128 v[36:39], v14 offset:12288
    s_waitcnt lgkmcnt(2)
    v_mfma_f32_32x32x16_bf16 v[80:95], v[8:11], v[28:31], v[80:95]
    ds_read_b128 v[16:19], v14 offset:14336
    s_waitcnt vmcnt(6)
    s_waitcnt lgkmcnt(2)
    v_mfma_f32_32x32x16_bf16 v[64:79], a[100:103], v[32:35], v[64:79]
    ds_read_b128 v[20:23], v14 offset:15360
    s_waitcnt lgkmcnt(2)
    v_mfma_f32_32x32x16_bf16 v[80:95], a[100:103], v[36:39], v[80:95]
    ds_read_b128 v[24:27], v14 offset:17408
    s_waitcnt vmcnt(5)
    s_waitcnt lgkmcnt(2)
    v_mfma_f32_32x32x16_bf16 v[64:79], a[104:107], v[16:19], v[64:79]
    ds_read_b128 v[28:31], v14 offset:18432
    s_waitcnt lgkmcnt(2)
    v_mfma_f32_32x32x16_bf16 v[80:95], a[104:107], v[20:23], v[80:95]
    ds_read_b128 v[32:35], v14 offset:20480
    s_waitcnt vmcnt(4)
    s_waitcnt lgkmcnt(2)
    v_mfma_f32_32x32x16_bf16 v[64:79], a[108:111], v[24:27], v[64:79]
    ds_read_b128 v[36:39], v14 offset:21504
    s_waitcnt lgkmcnt(2)
    v_mfma_f32_32x32x16_bf16 v[80:95], a[108:111], v[28:31], v[80:95]
    ds_read_b128 v[16:19], v14 offset:23552
    s_waitcnt vmcnt(3)
    s_waitcnt lgkmcnt(2)
    v_mfma_f32_32x32x16_bf16 v[64:79], a[112:115], v[32:35], v[64:79]
    ds_read_b128 v[20:23], v14 offset:24576
    s_waitcnt lgkmcnt(2)
    v_mfma_f32_32x32x16_bf16 v[80:95], a[112:115], v[36:39], v[80:95]
    ds_read_b128 v[24:27], v14 offset:26624
    s_waitcnt vmcnt(2)
    s_waitcnt lgkmcnt(2)
    v_mfma_f32_32x32x16_bf16 v[64:79], a[116:119], v[16:19], v[64:79]
    ds_read_b128 v[28:31], v14 offset:27648
    s_waitcnt lgkmcnt(2)
    v_mfma_f32_32x32x16_bf16 v[80:95], a[116:119], v[20:23], v[80:95]
    ds_read_b128 v[32:35], v14 offset:29696
    s_waitcnt vmcnt(1)
    s_waitcnt lgkmcnt(2)
    v_mfma_f32_32x32x16_bf16 v[64:79], a[120:123], v[24:27], v[64:79]
    ds_read_b128 v[36:39], v14 offset:30720
    s_waitcnt lgkmcnt(2)
    v_mfma_f32_32x32x16_bf16 v[80:95], a[120:123], v[28:31], v[80:95]
    ds_read_b128 v[16:19], v3 offset:2048
    s_waitcnt vmcnt(0)
    s_waitcnt lgkmcnt(2)
    v_mfma_f32_32x32x16_bf16 v[64:79], a[124:127], v[32:35], v[64:79]
    ds_read_b128 v[20:23], v14 offset:34816
    s_waitcnt lgkmcnt(2)
    v_mfma_f32_32x32x16_bf16 v[80:95], a[124:127], v[36:39], v[80:95]
    ds_read_b128 v[24:27], v3 offset:5120
    s_waitcnt lgkmcnt(2)
    v_mfma_f32_32x32x16_bf16 v[96:111], v[16:19], a[0:3], 0
    ds_read_b128 v[28:31], v3 offset:8192
    s_waitcnt lgkmcnt(2)
    v_mfma_f32_32x32x16_bf16 v[96:111], v[20:23], v[8:11], v[96:111]
    ds_read_b128 v[32:35], v3 offset:11264
    s_waitcnt lgkmcnt(2)
    v_mfma_f32_32x32x16_bf16 v[96:111], v[24:27], a[4:7], v[96:111]
    ds_read_b128 v[36:39], v3 offset:14336
    v_pk_mul_f32 v[40:41], v[64:65], v[48:49]
    v_pk_mul_f32 v[42:43], v[66:67], v[50:51]
    v_pk_mul_f32 v[44:45], v[68:69], v[52:53]
    v_pk_mul_f32 v[46:47], v[70:71], v[54:55]
    v_max_f32 v64, 0, v64
    v_max_f32 v65, 0, v65
    v_max_f32 v66, 0, v66
    v_max_f32 v67, 0, v67
    s_waitcnt lgkmcnt(2)
    v_mfma_f32_32x32x16_bf16 v[96:111], v[28:31], a[8:11], v[96:111]
    ds_read_b128 v[16:19], v3 offset:17408
    v_max_f32 v68, 0, v68
    v_max_f32 v69, 0, v69
    v_max_f32 v70, 0, v70
    v_max_f32 v71, 0, v71
    v_min_f32 v40, 0, v40
    v_min_f32 v41, 0, v41
    v_min_f32 v42, 0, v42
    v_min_f32 v43, 0, v43
    s_waitcnt lgkmcnt(2)
    v_mfma_f32_32x32x16_bf16 v[96:111], v[32:35], a[12:15], v[96:111]
    ds_read_b128 v[20:23], v3 offset:20480
    v_min_f32 v44, 0, v44
    v_min_f32 v45, 0, v45
    v_min_f32 v46, 0, v46
    v_min_f32 v47, 0, v47
    v_exp_f32 v40, v40
    v_exp_f32 v41, v41
    v_exp_f32 v42, v42
    v_exp_f32 v43, v43
    s_waitcnt lgkmcnt(2)
    v_mfma_f32_32x32x16_bf16 v[96:111], v[36:39], a[16:19], v[96:111]
    ds_read_b128 v[24:27], v3 offset:23552
    v_exp_f32 v44, v44
    v_exp_f32 v45, v45
    v_exp_f32 v46, v46
    v_exp_f32 v47, v47
    v_pk_fma_f32 v[64:65], v[64:65], v[112:113], v[4:5]
    v_pk_fma_f32 v[66:67], v[66:67], v[114:115], v[4:5]
    v_pk_fma_f32 v[68:69], v[68:69], v[116:117], v[4:5]
    v_pk_fma_f32 v[70:71], v[70:71], v[118:119], v[4:5]
    s_waitcnt lgkmcnt(2)
    v_mfma_f32_32x32x16_bf16 v[96:111], v[16:19], a[20:23], v[96:111]
    ds_read_b128 v[28:31], v3 offset:26624
    v_pk_mul_f32 v[80:81], v[80:81], v[112:113]
    v_pk_mul_f32 v[82:83], v[82:83], v[114:115]
    v_pk_mul_f32 v[84:85], v[84:85], v[116:117]
    v_pk_mul_f32 v[86:87], v[86:87], v[118:119]
    v_pk_add_f32 v[64:65], v[64:65], v[40:41]
    v_pk_add_f32 v[66:67], v[66:67], v[42:43]
    v_pk_add_f32 v[68:69], v[68:69], v[44:45]
    v_pk_add_f32 v[70:71], v[70:71], v[46:47]
    s_waitcnt lgkmcnt(2)
    v_mfma_f32_32x32x16_bf16 v[96:111], v[20:23], a[24:27], v[96:111]
    ds_read_b128 v[32:35], v3 offset:29696
    v_pk_mul_f32 v[40:41], v[72:73], v[56:57]
    v_pk_mul_f32 v[42:43], v[74:75], v[58:59]
    v_pk_mul_f32 v[44:45], v[76:77], v[60:61]
    v_pk_mul_f32 v[46:47], v[78:79], v[62:63]
    v_max_f32 v72, 0, v72
    v_max_f32 v73, 0, v73
    v_max_f32 v74, 0, v74
    v_max_f32 v75, 0, v75
    s_waitcnt lgkmcnt(2)
    v_mfma_f32_32x32x16_bf16 v[96:111], v[24:27], a[28:31], v[96:111]
    ds_read_b128 v[36:39], v3 offset:32768
    v_max_f32 v76, 0, v76
    v_max_f32 v77, 0, v77
    v_max_f32 v78, 0, v78
    v_max_f32 v79, 0, v79
    v_min_f32 v40, 0, v40
    v_min_f32 v41, 0, v41
    v_min_f32 v42, 0, v42
    v_min_f32 v43, 0, v43
    s_waitcnt lgkmcnt(2)
    v_mfma_f32_32x32x16_bf16 v[96:111], v[28:31], a[32:35], v[96:111]
    ds_read_b128 v[16:19], v3 offset:35840
    v_min_f32 v44, 0, v44
    v_min_f32 v45, 0, v45
    v_min_f32 v46, 0, v46
    v_min_f32 v47, 0, v47
    v_exp_f32 v40, v40
    v_exp_f32 v41, v41
    v_exp_f32 v42, v42
    v_exp_f32 v43, v43
    s_waitcnt lgkmcnt(2)
    v_mfma_f32_32x32x16_bf16 v[96:111], v[32:35], a[36:39], v[96:111]
    ds_read_b128 v[20:23], v3 offset:38912
    v_exp_f32 v44, v44
    v_exp_f32 v45, v45
    v_exp_f32 v46, v46
    v_exp_f32 v47, v47
    v_pk_fma_f32 v[72:73], v[72:73], v[120:121], v[4:5]
    v_pk_fma_f32 v[74:75], v[74:75], v[122:123], v[4:5]
    v_pk_fma_f32 v[76:77], v[76:77], v[124:125], v[4:5]
    v_pk_fma_f32 v[78:79], v[78:79], v[126:127], v[4:5]
    s_waitcnt lgkmcnt(2)
    v_mfma_f32_32x32x16_bf16 v[96:111], v[36:39], a[40:43], v[96:111]
    ds_read_b128 v[24:27], v3 offset:41984
    v_pk_mul_f32 v[88:89], v[88:89], v[120:121]
    v_pk_mul_f32 v[90:91], v[90:91], v[122:123]
    v_pk_mul_f32 v[92:93], v[92:93], v[124:125]
    v_pk_mul_f32 v[94:95], v[94:95], v[126:127]
    v_pk_add_f32 v[72:73], v[72:73], v[40:41]
    v_pk_add_f32 v[74:75], v[74:75], v[42:43]
    v_pk_add_f32 v[76:77], v[76:77], v[44:45]
    v_pk_add_f32 v[78:79], v[78:79], v[46:47]
    s_waitcnt lgkmcnt(2)
    v_mfma_f32_32x32x16_bf16 v[96:111], v[16:19], a[44:47], v[96:111]
    ds_read_b128 v[28:31], v3 offset:45056
    v_cvt_pk_bf16_f32 v64, v64, v65
    v_cvt_pk_bf16_f32 v80, v80, v81
    v_cvt_pk_bf16_f32 v65, v66, v67
    v_cvt_pk_bf16_f32 v81, v82, v83
    v_cvt_pk_bf16_f32 v66, v68, v69
    v_cvt_pk_bf16_f32 v82, v84, v85
    v_cvt_pk_bf16_f32 v67, v70, v71
    v_cvt_pk_bf16_f32 v83, v86, v87
    s_waitcnt lgkmcnt(2)
    v_mfma_f32_32x32x16_bf16 v[96:111], v[20:23], a[48:51], v[96:111]
    ds_read_b128 v[32:35], v3 offset:48128
    v_cvt_pk_bf16_f32 v68, v72, v73
    v_cvt_pk_bf16_f32 v84, v88, v89
    v_cvt_pk_bf16_f32 v69, v74, v75
    v_cvt_pk_bf16_f32 v85, v90, v91
    v_cvt_pk_bf16_f32 v70, v76, v77
    v_cvt_pk_bf16_f32 v86, v92, v93
    v_cvt_pk_bf16_f32 v71, v78, v79
    v_cvt_pk_bf16_f32 v87, v94, v95
    s_waitcnt lgkmcnt(2)
    v_mfma_f32_32x32x16_bf16 v[96:111], v[24:27], a[52:55], v[96:111]
    ds_read_b128 v[36:39], v3 offset:51200
    v_cndmask_b32 v72, v7, v80, vcc
    v_cndmask_b32 v88, v80, v7, vcc
    v_cndmask_b32 v73, v7, v81, vcc
    v_cndmask_b32 v89, v81, v7, vcc
    v_cndmask_b32 v74, v7, v82, vcc
    v_cndmask_b32 v90, v82, v7, vcc
    v_cndmask_b32 v75, v7, v83, vcc
    v_cndmask_b32 v91, v83, v7, vcc
    s_waitcnt lgkmcnt(2)
    v_mfma_f32_32x32x16_bf16 v[96:111], v[28:31], a[56:59], v[96:111]
    ds_read_b128 v[16:19], v3 offset:54272
    v_cndmask_b32 v76, v7, v84, vcc
    v_cndmask_b32 v92, v84, v7, vcc
    v_cndmask_b32 v77, v7, v85, vcc
    v_cndmask_b32 v93, v85, v7, vcc
    v_cndmask_b32 v78, v7, v86, vcc
    v_cndmask_b32 v94, v86, v7, vcc
    v_cndmask_b32 v79, v7, v87, vcc
    v_cndmask_b32 v95, v87, v7, vcc
    v_mfma_f32_32x32x16_bf16 v[112:127], v[64:67], v[72:75], 0
    v_mfma_f32_32x32x16_bf16 v[48:63], v[64:67], v[88:91], 0
    v_mfma_f32_32x32x16_bf16 v[112:127], v[68:71], v[76:79], v[112:127]
    v_mfma_f32_32x32x16_bf16 v[48:63], v[68:71], v[92:95], v[48:63]
    s_mul_i32 s18, s4, 2176
    s_add_u32 s18, s18, 103424
    v_add_u32 v44, s18, v3
    v_and_b32 v45, 16, v2
    v_lshlrev_b32 v45, 1, v45
    v_lshrrev_b32 v47, 5, v2
    v_lshlrev_b32 v47, 4, v47
    v_add_u32 v47, v47, v45
    v_add_u32 v47, s18, v47
    s_lshl_b32 s18, s4, 9
    s_add_u32 s18, s18, 103424
    v_lshlrev_b32 v46, 2, v2
    v_add_u32 v45, s18, v46
    v_add_u32 v1, 105472, v46
    s_waitcnt lgkmcnt(2)
    v_mfma_f32_32x32x16_bf16 v[96:111], v[32:35], a[60:63], v[96:111]
    ds_read_b128 v[20:23], v3 offset:57344
    s_waitcnt lgkmcnt(2)
    v_mfma_f32_32x32x16_bf16 v[96:111], v[36:39], a[64:67], v[96:111]
    ds_read_b128 v[24:27], v3 offset:60416
    v_cndmask_b32 v48, v112, v56, vcc
    v_cndmask_b32 v49, v113, v57, vcc
    v_cndmask_b32 v50, v114, v58, vcc
    v_cndmask_b32 v51, v115, v59, vcc
    v_cndmask_b32 v52, v116, v60, vcc
    v_cndmask_b32 v53, v117, v61, vcc
    v_cndmask_b32 v54, v118, v62, vcc
    v_cndmask_b32 v55, v119, v63, vcc
    v_cndmask_b32 v112, v56, v112, vcc
    v_cndmask_b32 v113, v57, v113, vcc
    v_cndmask_b32 v114, v58, v114, vcc
    v_cndmask_b32 v115, v59, v115, vcc
    v_cndmask_b32 v116, v60, v116, vcc
    v_cndmask_b32 v117, v61, v117, vcc
    v_cndmask_b32 v118, v62, v118, vcc
    v_cndmask_b32 v119, v63, v119, vcc
    ds_write_b128 v44, v[112:115]
    ds_write_b128 v44, v[116:119] offset:1024
    s_mov_b32 exec_lo, 0x00010001
    s_mov_b32 exec_hi, 0x00010001
    ds_write_b128 v47, v[48:51] offset:2048
    ds_write_b128 v47, v[52:55] offset:2112
    s_mov_b64 exec, -1
    s_waitcnt lgkmcnt(6)
    v_mfma_f32_32x32x16_bf16 v[96:111], v[16:19], a[68:71], v[96:111]
    ds_read_b128 v[28:31], v3 offset:63488
    s_waitcnt lgkmcnt(6)
    v_mfma_f32_32x32x16_bf16 v[96:111], v[20:23], a[72:75], v[96:111]
    ds_read_b128 v[32:35], v14 offset:1024
    s_waitcnt lgkmcnt(6)
    v_mfma_f32_32x32x16_bf16 v[96:111], v[24:27], a[76:79], v[96:111]
    ds_read_b128 v[36:39], v14 offset:4096
    s_waitcnt lgkmcnt(0)
    s_barrier
    ds_read_b32 v64, v45 offset:0
    ds_read_b32 v65, v45 offset:2176
    ds_read_b32 v66, v45 offset:4352
    ds_read_b32 v67, v45 offset:6528
    ds_read_b32 v68, v45 offset:256
    ds_read_b32 v69, v45 offset:2432
    ds_read_b32 v70, v45 offset:4608
    ds_read_b32 v71, v45 offset:6784
    ds_read_b32 v72, v1 offset:0
    ds_read_b32 v73, v1 offset:2176
    ds_read_b32 v74, v1 offset:4352
    ds_read_b32 v75, v1 offset:6528
    s_lshl_b32 s18, s6, 11
    s_add_u32 s18, s18, s41
    s_lshl_b32 s19, s4, 9
    s_add_u32 s18, s18, s19
    s_lshl_b32 s19, s6, 7
    s_add_u32 s19, s19, s41
    s_add_u32 s19, s19, 32768
    v_mfma_f32_32x32x16_bf16 v[96:111], v[28:31], a[80:83], v[96:111]
    ds_read_b128 v[16:19], v14 offset:7168
    v_mfma_f32_32x32x16_bf16 v[96:111], v[32:35], a[84:87], v[96:111]
    ds_read_b128 v[20:23], v14 offset:10240
    v_mfma_f32_32x32x16_bf16 v[96:111], v[36:39], a[88:91], v[96:111]
    ds_read_b128 v[24:27], v14 offset:13312
    s_waitcnt lgkmcnt(3)
    v_add_f32 v64, v64, v65
    v_add_f32 v66, v66, v67
    v_add_f32 v68, v68, v69
    v_add_f32 v70, v70, v71
    v_add_f32 v72, v72, v73
    v_add_f32 v74, v74, v75
    v_add_f32 v64, v64, v66
    v_add_f32 v68, v68, v70
    v_add_f32 v72, v72, v74
    buffer_atomic_add_f32 v64, v46, s[8:11], s18 offen offset:0
    buffer_atomic_add_f32 v68, v46, s[8:11], s18 offen offset:256
    s_cmp_lg_u32 s4, 0
    s_cbranch_scc1 P1_noz
    s_mov_b64 exec, 0xffffffff
    buffer_atomic_add_f32 v72, v46, s[8:11], s19 offen
    s_mov_b64 exec, -1
P1_noz:
    s_waitcnt lgkmcnt(2)
    v_mfma_f32_32x32x16_bf16 v[96:111], v[16:19], a[92:95], v[96:111]
    ds_read_b128 v[28:31], v14 offset:16384
    s_waitcnt lgkmcnt(2)
    v_mfma_f32_32x32x16_bf16 v[96:111], v[20:23], a[96:99], v[96:111]
    ds_read_b128 v[32:35], v14 offset:19456
    s_waitcnt lgkmcnt(2)
    v_mfma_f32_32x32x16_bf16 v[96:111], v[24:27], a[100:103], v[96:111]
    ds_read_b128 v[36:39], v14 offset:22528
    s_waitcnt lgkmcnt(2)
    v_mfma_f32_32x32x16_bf16 v[96:111], v[28:31], a[104:107], v[96:111]
    ds_read_b128 v[16:19], v14 offset:25600
    s_waitcnt lgkmcnt(2)
    v_mfma_f32_32x32x16_bf16 v[96:111], v[32:35], a[108:111], v[96:111]
    ds_read_b128 v[20:23], v14 offset:28672
    s_waitcnt lgkmcnt(2)
    v_mfma_f32_32x32x16_bf16 v[96:111], v[36:39], a[112:115], v[96:111]
    ds_read_b128 v[24:27], v14 offset:31744
    s_waitcnt lgkmcnt(2)
    v_mfma_f32_32x32x16_bf16 v[96:111], v[16:19], a[116:119], v[96:111]
    s_waitcnt lgkmcnt(1)
    v_mfma_f32_32x32x16_bf16 v[96:111], v[20:23], a[120:123], v[96:111]
    s_waitcnt lgkmcnt(0)
    v_mfma_f32_32x32x16_bf16 v[96:111], v[24:27], a[124:127], v[96:111]
    s_nop 11
    v_mul_f32 v40, v15, v96
    v_mul_f32 v41, v15, v97
    v_mul_f32 v42, v15, v98
    v_mul_f32 v43, v15, v99
    v_min_f32 v40, 0, v40
    v_min_f32 v41, 0, v41
    v_min_f32 v42, 0, v42
    v_min_f32 v43, 0, v43
    v_exp_f32 v40, v40
    v_exp_f32 v41, v41
    v_exp_f32 v42, v42
    v_exp_f32 v43, v43
    v_max_f32 v96, 0, v96
    v_max_f32 v97, 0, v97
    v_max_f32 v98, 0, v98
    v_max_f32 v99, 0, v99
    v_add_f32 v40, 0x358637bd, v40
    v_add_f32 v41, 0x358637bd, v41
    v_add_f32 v42, 0x358637bd, v42
    v_add_f32 v43, 0x358637bd, v43
    v_fma_f32 v96, v96, v12, v40
    v_fma_f32 v97, v97, v12, v41
    v_fma_f32 v98, v98, v12, v42
    v_fma_f32 v99, v99, v12, v43
    v_mul_f32 v40, v15, v100
    v_mul_f32 v41, v15, v101
    v_mul_f32 v42, v15, v102
    v_mul_f32 v43, v15, v103
    v_min_f32 v40, 0, v40
    v_min_f32 v41, 0, v41
    v_min_f32 v42, 0, v42
    v_min_f32 v43, 0, v43
    v_exp_f32 v40, v40
    v_exp_f32 v41, v41
    v_exp_f32 v42, v42
    v_exp_f32 v43, v43
    v_max_f32 v100, 0, v100
    v_max_f32 v101, 0, v101
    v_max_f32 v102, 0, v102
    v_max_f32 v103, 0, v103
    v_add_f32 v40, 0x358637bd, v40
    v_add_f32 v41, 0x358637bd, v41
    v_add_f32 v42, 0x358637bd, v42
    v_add_f32 v43, 0x358637bd, v43
    v_fma_f32 v100, v100, v12, v40
    v_fma_f32 v101, v101, v12, v41
    v_fma_f32 v102, v102, v12, v42
    v_fma_f32 v103, v103, v12, v43
    v_mul_f32 v40, v15, v104
    v_mul_f32 v41, v15, v105
    v_mul_f32 v42, v15, v106
    v_mul_f32 v43, v15, v107
    v_min_f32 v40, 0, v40
    v_min_f32 v41, 0, v41
    v_min_f32 v42, 0, v42
    v_min_f32 v43, 0, v43
    v_exp_f32 v40, v40
    v_exp_f32 v41, v41
    v_exp_f32 v42, v42
    v_exp_f32 v43, v43
    v_max_f32 v104, 0, v104
    v_max_f32 v105, 0, v105
    v_max_f32 v106, 0, v106
    v_max_f32 v107, 0, v107
    v_add_f32 v40, 0x358637bd, v40
    v_add_f32 v41, 0x358637bd, v41
    v_add_f32 v42, 0x358637bd, v42
    v_add_f32 v43, 0x358637bd, v43
    v_fma_f32 v104, v104, v12, v40
    v_fma_f32 v105, v105, v12, v41
    v_fma_f32 v106, v106, v12, v42
    v_fma_f32 v107, v107, v12, v43
    v_mul_f32 v40, v15, v108
    v_mul_f32 v41, v15, v109
    v_mul_f32 v42, v15, v110
    v_mul_f32 v43, v15, v111
    v_min_f32 v40, 0, v40
    v_min_f32 v41, 0, v41
    v_min_f32 v42, 0, v42
    v_min_f32 v43, 0, v43
    v_exp_f32 v40, v40
    v_exp_f32 v41, v41
    v_exp_f32 v42, v42
    v_exp_f32 v43, v43
    v_max_f32 v108, 0, v108
    v_max_f32 v109, 0, v109
    v_max_f32 v110, 0, v110
    v_max_f32 v111, 0, v111
    v_add_f32 v40, 0x358637bd, v40
    v_add_f32 v41, 0x358637bd, v41
    v_add_f32 v42, 0x358637bd, v42
    v_add_f32 v43, 0x358637bd, v43
    v_fma_f32 v108, v108, v12, v40
    v_fma_f32 v109, v109, v12, v41
    v_fma_f32 v110, v110, v12, v42
    v_fma_f32 v111, v111, v12, v43
    v_cvt_pk_bf16_f32 v32, v96, v97
    v_cvt_pk_bf16_f32 v33, v98, v99
    v_cvt_pk_bf16_f32 v34, v100, v101
    v_cvt_pk_bf16_f32 v35, v102, v103
    v_cvt_pk_bf16_f32 v36, v104, v105
    v_cvt_pk_bf16_f32 v37, v106, v107
    v_cvt_pk_bf16_f32 v38, v108, v109
    v_cvt_pk_bf16_f32 v39, v110, v111
    s_add_u32 s23, s22, 64
    v_mov_b32 v8, 0
    v_mov_b32 v9, 1
    s_waitcnt vmcnt(0)
    s_mov_b64 exec, 1
    s_cmp_eq_u32 s56, 0
    s_cbranch_scc1 FK_pb5_f
    buffer_store_byte v9, v8, s[8:11], s23 offen sc0 sc1
    s_branch FK_pb5_d
FK_pb5_f:
    buffer_store_byte v9, v8, s[8:11], s23 offen
FK_pb5_d:
    s_mov_b64 exec, -1
    s_lshl_b32 s17, s6, 11
    s_add_u32 s17, s17, s13
    s_add_u32 s17, s17, 16777216
    s_cmp_eq_u32 s56, 0
    s_cbranch_scc1 FK_ds6_f
    buffer_store_dwordx4 v[32:35], v3, s[8:11], s17 offen sc0 sc1
    buffer_store_dwordx4 v[36:39], v3, s[8:11], s17 offen offset:1024 sc0 sc1
    s_branch FK_ds6_d
FK_ds6_f:
    buffer_store_dwordx4 v[32:35], v3, s[8:11], s17 offen
    buffer_store_dwordx4 v[36:39], v3, s[8:11], s17 offen offset:1024
FK_ds6_d:
    v_mov_b32 v8, 0
    v_mov_b32 v9, 1
    s_waitcnt vmcnt(0)
    s_mov_b64 exec, 1
    s_cmp_eq_u32 s56, 0
    s_cbranch_scc1 FK_pb7_f
    buffer_store_byte v9, v8, s[8:11], s22 offen sc0 sc1
    s_branch FK_pb7_d
FK_pb7_f:
    buffer_store_byte v9, v8, s[8:11], s22 offen
FK_pb7_d:
    s_mov_b64 exec, -1
    s_mov_b32 s42, 10485760
    s_mov_b32 s43, 1
    s_mov_b32 s44, 3
    s_mov_b32 s40, 18874368
    s_add_u32 s48, s48, 16384
    s_mul_i32 s15, s53, 237568
    s_add_u32 s15, s15, 2162688
    s_lshl_b32 s16, s4, 12
    s_add_u32 s17, s15, s16
    s_barrier
    s_cmp_eq_u32 s53, 0
    s_cbranch_scc1 FK_Xl1
    s_mov_b32 m0, s16
    s_nop 0
    buffer_load_dwordx4 v3, s[8:11], s17 offen offset:0  lds
    buffer_load_dwordx4 v3, s[8:11], s17 offen offset:1024  lds
    buffer_load_dwordx4 v3, s[8:11], s17 offen offset:2048  lds
    buffer_load_dwordx4 v3, s[8:11], s17 offen offset:3072  lds
    s_add_u32 s16, s16, 16384
    s_add_u32 s17, s17, 16384
    s_mov_b32 m0, s16
    s_nop 0
    buffer_load_dwordx4 v3, s[8:11], s17 offen offset:0  lds
    buffer_load_dwordx4 v3, s[8:11], s17 offen offset:1024  lds
    buffer_load_dwordx4 v3, s[8:11], s17 offen offset:2048  lds
    buffer_load_dwordx4 v3, s[8:11], s17 offen offset:3072  lds
    s_add_u32 s16, s16, 16384
    s_add_u32 s17, s17, 16384
    s_mov_b32 m0, s16
    s_nop 0
    buffer_load_dwordx4 v3, s[8:11], s17 offen offset:0  lds
    buffer_load_dwordx4 v3, s[8:11], s17 offen offset:1024  lds
    buffer_load_dwordx4 v3, s[8:11], s17 offen offset:2048  lds
    buffer_load_dwordx4 v3, s[8:11], s17 offen offset:3072  lds
    s_add_u32 s16, s16, 16384
    s_add_u32 s17, s17, 16384
FK_Xl1:
    s_barrier
    s_cmp_lg_u32 s53, 0
    s_cbranch_scc1 FK_Xl2
    s_mov_b32 m0, s16
    s_nop 0
    buffer_load_dwordx4 v3, s[8:11], s17 offen offset:0  lds
    buffer_load_dwordx4 v3, s[8:11], s17 offen offset:1024  lds
    buffer_load_dwordx4 v3, s[8:11], s17 offen offset:2048  lds
    buffer_load_dwordx4 v3, s[8:11], s17 offen offset:3072  lds
    s_add_u32 s16, s16, 16384
    s_add_u32 s17, s17, 16384
    s_mov_b32 m0, s16
    s_nop 0
    buffer_load_dwordx4 v3, s[8:11], s17 offen offset:0  lds
    buffer_load_dwordx4 v3, s[8:11], s17 offen offset:1024  lds
    buffer_load_dwordx4 v3, s[8:11], s17 offen offset:2048  lds
    buffer_load_dwordx4 v3, s[8:11], s17 offen offset:3072  lds
    s_add_u32 s16, s16, 16384
    s_add_u32 s17, s17, 16384
    s_mov_b32 m0, s16
    s_nop 0
    buffer_load_dwordx4 v3, s[8:11], s17 offen offset:0  lds
    buffer_load_dwordx4 v3, s[8:11], s17 offen offset:1024  lds
    buffer_load_dwordx4 v3, s[8:11], s17 offen offset:2048  lds
    buffer_load_dwordx4 v3, s[8:11], s17 offen offset:3072  lds
    s_add_u32 s16, s16, 16384
    s_add_u32 s17, s17, 16384
FK_Xl2:
    s_mov_b32 m0, s16
    s_nop 0
    buffer_load_dwordx4 v3, s[8:11], s17 offen offset:0  lds
    buffer_load_dwordx4 v3, s[8:11], s17 offen offset:1024  lds
    buffer_load_dwordx4 v3, s[8:11], s17 offen offset:2048  lds
    buffer_load_dwordx4 v3, s[8:11], s17 offen offset:3072  lds
    s_add_u32 s16, s16, 16384
    s_add_u32 s17, s17, 16384
    s_mov_b32 m0, s16
    s_nop 0
    buffer_load_dwordx4 v3, s[8:11], s17 offen offset:0  lds
    buffer_load_dwordx4 v3, s[8:11], s17 offen offset:1024  lds
    buffer_load_dwordx4 v3, s[8:11], s17 offen offset:2048  lds
    buffer_load_dwordx4 v3, s[8:11], s17 offen offset:3072  lds
    s_add_u32 s16, s16, 16384
    s_add_u32 s17, s17, 16384
    s_mov_b32 m0, s16
    s_nop 0
    buffer_load_dwordx4 v3, s[8:11], s17 offen offset:0  lds
    buffer_load_dwordx4 v3, s[8:11], s17 offen offset:1024  lds
    buffer_load_dwordx4 v3, s[8:11], s17 offen offset:2048  lds
    buffer_load_dwordx4 v3, s[8:11], s17 offen offset:3072  lds
    s_add_u32 s16, s16, 16384
    s_add_u32 s17, s17, 16384
    s_mov_b32 m0, s16
    s_nop 0
    buffer_load_dwordx4 v3, s[8:11], s17 offen offset:0  lds
    buffer_load_dwordx4 v3, s[8:11], s17 offen offset:1024  lds
    buffer_load_dwordx4 v3, s[8:11], s17 offen offset:2048  lds
    buffer_load_dwordx4 v3, s[8:11], s17 offen offset:3072  lds
    s_add_u32 s16, s16, 16384
    s_add_u32 s17, s17, 16384
    s_barrier
    s_branch FK_Xc
FK_Y:
    s_setprio 3
    s_and_b32 s5, s4, 1
    s_lshr_b32 s7, s4, 1
    s_lshl_b32 s50, s52, 2
    s_lshl_b32 s16, s54, 1
    s_add_u32 s50, s50, s16
    s_add_u32 s50, s50, s7
    s_xor_b32 s51, s50, 1
    s_lshl_b32 s14, s50, 15
    s_lshl_b32 s25, s55, 12
    s_lshl_b32 s26, s5, 11
    s_add_u32 s25, s25, s26
    s_add_u32 s25, s25, s14
    s_add_u32 s27, s25, s42
    s_lshr_b32 s28, s14, 3
    s_lshl_b32 s29, s55, 9
    s_add_u32 s28, s28, s29
    s_lshl_b32 s29, s5, 3
    s_add_u32 s28, s28, s29
    s_add_u32 s29, s28, s45
    s_lshl_b32 s14, s50, 15
    s_lshl_b32 s15, s51, 15
    s_lshl_b32 s16, s4, 13
    s_add_u32 s17, s14, s16
    s_add_u32 s17, s17, s49
    s_add_u32 s18, s15, s16
    s_add_u32 s18, s18, s49
    s_add_u32 s19, s16, s41
    s_lshl_b32 s26, s4, 9
    s_add_u32 s26, s26, s41
    s_add_u32 s26, s26, 32768
    s_lshl_b32 s21, s55, 16
    s_lshl_b32 s22, s4, 14
    s_add_u32 s21, s21, s22
    s_add_u32 s21, s21, 1638400
    s_lshl_b32 s22, s5, 10
    s_add_u32 s23, s21, s22
    s_mul_i32 s20, s4, 12288
    s_add_u32 s20, s20, 114688
    s_add_u32 s31, s20, s22
    v_add_u32 v24, s31, v3
    s_xor_b32 s22, s22, 1024
    s_add_u32 s24, s21, s22
    s_add_u32 s31, s20, s22
    v_add_u32 v25, s31, v3
    s_add_u32 s21, s21, 4096
    v_lshlrev_b32 v26, 3, v2
    v_and_b32 v27, 16, v2
    v_lshrrev_b32 v28, 5, v2
    v_lshlrev_b32 v28, 3, v28
    v_add_u32 v28, v28, v27
    v_cmp_eq_u32 s[62:63], 0, v27
    s_mov_b32 s36, s46
    s_mov_b32 s37, s47
    s_mov_b32 s38, 2097152
    s_mov_b32 s39, 0x20000
    s_lshl_b32 s61, s55, 7
    s_lshl_b32 s22, s5, 6
    s_add_u32 s61, s61, s22
    s_add_u32 s61, s61, s14
    v_and_b32 v4, 31, v2
    v_lshlrev_b32 v4, 10, v4
    v_lshrrev_b32 v5, 5, v2
    v_lshlrev_b32 v5, 4, v5
    v_add_u32 v4, v4, v5
    v_lshlrev_b32 v5, 5, v2
    buffer_load_dwordx2 v[30:31], v26, s[8:11], s26 offen sc1
    buffer_load_dwordx4 v[64:67], v3, s[8:11], s19 offen offset:0 sc1
    buffer_load_dwordx4 v[68:71], v3, s[8:11], s19 offen offset:1024 sc1
    buffer_load_dwordx4 a[64:67], v3, s[8:11], s17 offen offset:0 sc1
    buffer_load_dwordx4 a[68:71], v3, s[8:11], s18 offen offset:0 sc1
    buffer_load_dwordx4 a[72:75], v3, s[8:11], s17 offen offset:1024 sc1
    buffer_load_dwordx4 a[76:79], v3, s[8:11], s18 offen offset:1024 sc1
    buffer_load_dwordx4 v[112:115], v3, s[8:11], s23 offen offset:0
    buffer_load_dwordx4 v[116:119], v3, s[8:11], s24 offen offset:0
    buffer_load_dwordx4 v[120:123], v3, s[8:11], s23 offen offset:2048
    buffer_load_dwordx4 v[124:127], v3, s[8:11], s24 offen offset:2048
    buffer_load_dwordx4 v[72:75], v3, s[8:11], s19 offen offset:2048 sc1
    buffer_load_dwordx4 v[76:79], v3, s[8:11], s19 offen offset:3072 sc1
    s_add_u32 s19, s19, 4096
    buffer_load_dwordx4 a[80:83], v3, s[8:11], s17 offen offset:2048 sc1
    buffer_load_dwordx4 a[84:87], v3, s[8:11], s18 offen offset:2048 sc1
    buffer_load_dwordx4 a[88:91], v3, s[8:11], s17 offen offset:3072 sc1
    s_add_u32 s17, s17, 4096
    buffer_load_dwordx4 a[92:95], v3, s[8:11], s18 offen offset:3072 sc1
    s_add_u32 s18, s18, 4096
    s_mov_b32 m0, s20
    s_nop 0
    buffer_load_dwordx4 v3, s[8:11], s21 offen offset:0 lds
    buffer_load_dwordx4 v3, s[8:11], s21 offen offset:1024 lds
    buffer_load_dwordx4 v3, s[8:11], s21 offen offset:2048 lds
    buffer_load_dwordx4 v3, s[8:11], s21 offen offset:3072 lds
    s_add_u32 s20, s20, 4096
    s_add_u32 s21, s21, 4096
    s_and_b32 s30, s50, 3
    s_lshl_b32 s30, s30, 4
    s_lshl_b32 s31, s55, 1
    s_add_u32 s30, s30, s31
    s_add_u32 s30, s30, s5
    s_add_u32 s30, s30, s48
    s_waitcnt vmcnt(18)
    v_cvt_pk_bf16_f32 v31, v30, v31
    v_cvt_pk_bf16_f32 v64, v64, v65
    v_cvt_pk_bf16_f32 v65, v66, v67
    v_cvt_pk_bf16_f32 v66, v68, v69
    v_cvt_pk_bf16_f32 v67, v70, v71
    ds_bpermute_b32 v68, v28, v31 offset:0
    ds_bpermute_b32 v69, v28, v31 offset:4
    ds_bpermute_b32 v70, v28, v31 offset:32
    ds_bpermute_b32 v71, v28, v31 offset:36
    s_waitcnt lgkmcnt(0)
    v_cndmask_b32 v104, v68, v64, s[62:63]
    v_cndmask_b32 v105, v69, v65, s[62:63]
    v_cndmask_b32 v106, v70, v66, s[62:63]
    v_cndmask_b32 v107, v71, v67, s[62:63]
    s_waitcnt vmcnt(16)
    s_nop 0
    v_mfma_f32_32x32x16_bf16 v[32:47], v[104:107], a[64:67], 0
    buffer_load_dwordx4 v[80:83], v3, s[8:11], s19 offen offset:0 sc1
    buffer_load_dwordx4 v[84:87], v3, s[8:11], s19 offen offset:1024 sc1
    v_cndmask_b32 v108, v64, v68, s[62:63]
    v_cndmask_b32 v109, v65, v69, s[62:63]
    v_cndmask_b32 v110, v66, v70, s[62:63]
    v_cndmask_b32 v111, v67, v71, s[62:63]
    buffer_load_dwordx4 a[96:99], v3, s[8:11], s17 offen offset:0 sc1
    buffer_load_dwordx4 a[100:103], v3, s[8:11], s18 offen offset:0 sc1
    v_mfma_f32_32x32x16_bf16 v[48:63], v[104:107], a[68:71], 0
    buffer_load_dwordx4 a[104:107], v3, s[8:11], s17 offen offset:1024 sc1
    s_nop 1
    v_add_f32 v40, 0x358637bd, v40
    v_rcp_f32 v40, v40
    s_nop 0
    v_mul_f32 v32, v32, v40
    v_mul_f32 v33, v33, v40
    v_mul_f32 v34, v34, v40
    v_mul_f32 v35, v35, v40
    v_mul_f32 v36, v36, v40
    v_mul_f32 v37, v37, v40
    v_mul_f32 v38, v38, v40
    v_mul_f32 v39, v39, v40
    v_cvt_pk_bf16_f32 v96, v32, v33
    v_cvt_pk_bf16_f32 v97, v34, v35
    v_cvt_pk_bf16_f32 v98, v36, v37
    v_cvt_pk_bf16_f32 v99, v38, v39
    s_waitcnt vmcnt(13)
    v_cvt_pk_bf16_f32 v72, v72, v73
    v_cvt_pk_bf16_f32 v73, v74, v75
    v_cvt_pk_bf16_f32 v74, v76, v77
    v_cvt_pk_bf16_f32 v75, v78, v79
    ds_bpermute_b32 v76, v28, v31 offset:64
    ds_bpermute_b32 v77, v28, v31 offset:68
    ds_bpermute_b32 v78, v28, v31 offset:96
    ds_bpermute_b32 v79, v28, v31 offset:100
    v_mfma_f32_32x32x16_bf16 v[32:47], v[108:111], a[72:75], 0
    buffer_load_dwordx4 a[108:111], v3, s[8:11], s18 offen offset:1024 sc1
    v_add_f32 v56, 0x358637bd, v56
    v_rcp_f32 v56, v56
    s_nop 0
    v_mul_f32 v48, v48, v56
    v_mul_f32 v49, v49, v56
    v_mul_f32 v50, v50, v56
    v_mul_f32 v51, v51, v56
    v_mul_f32 v52, v52, v56
    v_mfma_f32_32x32x16_bf16 a[0:15], v[112:115], v[96:99], 0
    s_mov_b32 m0, s20
    s_nop 0
    buffer_load_dwordx4 v3, s[8:11], s21 offen offset:0 lds
    v_mul_f32 v53, v53, v56
    v_mul_f32 v54, v54, v56
    v_mul_f32 v55, v55, v56
    v_cvt_pk_bf16_f32 v100, v48, v49
    v_cvt_pk_bf16_f32 v101, v50, v51
    v_cvt_pk_bf16_f32 v102, v52, v53
    v_cvt_pk_bf16_f32 v103, v54, v55
    v_mfma_f32_32x32x16_bf16 a[16:31], v[116:119], v[96:99], 0
    buffer_load_dwordx4 v3, s[8:11], s21 offen offset:1024 lds
    s_waitcnt lgkmcnt(0)
    v_cndmask_b32 v104, v76, v72, s[62:63]
    v_cndmask_b32 v105, v77, v73, s[62:63]
    v_cndmask_b32 v106, v78, v74, s[62:63]
    v_cndmask_b32 v107, v79, v75, s[62:63]
    v_mfma_f32_32x32x16_bf16 v[48:63], v[108:111], a[76:79], 0
    buffer_load_dwordx4 v3, s[8:11], s21 offen offset:2048 lds
    v_add_f32 v32, 0x358637bd, v32
    v_rcp_f32 v32, v32
    s_nop 0
    v_mul_f32 v40, v40, v32
    v_mul_f32 v41, v41, v32
    v_mul_f32 v42, v42, v32
    v_mfma_f32_32x32x16_bf16 a[32:47], v[112:115], v[100:103], 0
    buffer_load_dwordx4 v3, s[8:11], s21 offen offset:3072 lds
    s_add_u32 s20, s20, 4096
    s_add_u32 s21, s21, 4096
    v_mul_f32 v43, v43, v32
    v_mul_f32 v44, v44, v32
    v_mul_f32 v45, v45, v32
    v_mul_f32 v46, v46, v32
    v_mul_f32 v47, v47, v32
    v_mfma_f32_32x32x16_bf16 a[48:63], v[116:119], v[100:103], 0
    buffer_load_dwordx4 v[88:91], v3, s[8:11], s19 offen offset:2048 sc1
    v_cvt_pk_bf16_f32 v96, v40, v41
    v_cvt_pk_bf16_f32 v97, v42, v43
    v_cvt_pk_bf16_f32 v98, v44, v45
    v_cvt_pk_bf16_f32 v99, v46, v47
    s_waitcnt vmcnt(13)
    ds_read_b128 v[112:115], v24 offset:0
    ds_read_b128 v[116:119], v25 offset:0
    v_mfma_f32_32x32x16_bf16 v[32:47], v[104:107], a[80:83], 0
    buffer_load_dwordx4 v[92:95], v3, s[8:11], s19 offen offset:3072 sc1
    v_add_f32 v48, 0x358637bd, v48
    v_rcp_f32 v48, v48
    s_nop 0
    v_mul_f32 v56, v56, v48
    v_mul_f32 v57, v57, v48
    v_mul_f32 v58, v58, v48
    v_mul_f32 v59, v59, v48
    v_mul_f32 v60, v60, v48
    v_mfma_f32_32x32x16_bf16 a[0:15], v[120:123], v[96:99], a[0:15]
    buffer_load_dwordx4 a[112:115], v3, s[8:11], s17 offen offset:2048 sc1
    v_mul_f32 v61, v61, v48
    v_mul_f32 v62, v62, v48
    v_mul_f32 v63, v63, v48
    v_cvt_pk_bf16_f32 v100, v56, v57
    v_cvt_pk_bf16_f32 v101, v58, v59
    v_cvt_pk_bf16_f32 v102, v60, v61
    v_cvt_pk_bf16_f32 v103, v62, v63
    v_mfma_f32_32x32x16_bf16 a[16:31], v[124:127], v[96:99], a[16:31]
    buffer_load_dwordx4 a[116:119], v3, s[8:11], s18 offen offset:2048 sc1
    v_cndmask_b32 v108, v72, v76, s[62:63]
    v_cndmask_b32 v109, v73, v77, s[62:63]
    v_cndmask_b32 v110, v74, v78, s[62:63]
    v_cndmask_b32 v111, v75, v79, s[62:63]
    v_mfma_f32_32x32x16_bf16 v[48:63], v[104:107], a[84:87], 0
    buffer_load_dwordx4 a[120:123], v3, s[8:11], s17 offen offset:3072 sc1
    v_add_f32 v40, 0x358637bd, v40
    v_rcp_f32 v40, v40
    s_nop 0
    v_mul_f32 v32, v32, v40
    v_mul_f32 v33, v33, v40
    v_mul_f32 v34, v34, v40
    v_mul_f32 v35, v35, v40
    v_mul_f32 v36, v36, v40
    v_mul_f32 v37, v37, v40
    v_mfma_f32_32x32x16_bf16 a[32:47], v[120:123], v[100:103], a[32:47]
    buffer_load_dwordx4 a[124:127], v3, s[8:11], s18 offen offset:3072 sc1
    v_mul_f32 v38, v38, v40
    v_mul_f32 v39, v39, v40
    v_cvt_pk_bf16_f32 v96, v32, v33
    v_cvt_pk_bf16_f32 v97, v34, v35
    v_cvt_pk_bf16_f32 v98, v36, v37
    v_cvt_pk_bf16_f32 v99, v38, v39
    s_waitcnt vmcnt(14)
    v_cvt_pk_bf16_f32 v80, v80, v81
    v_mfma_f32_32x32x16_bf16 a[48:63], v[124:127], v[100:103], a[48:63]
    s_mov_b32 m0, s20
    s_nop 0
    buffer_load_dwordx4 v3, s[8:11], s21 offen offset:0 lds
    v_cvt_pk_bf16_f32 v81, v82, v83
    v_cvt_pk_bf16_f32 v82, v84, v85
    v_cvt_pk_bf16_f32 v83, v86, v87
    ds_bpermute_b32 v84, v28, v31 offset:128
    ds_bpermute_b32 v85, v28, v31 offset:132
    ds_bpermute_b32 v86, v28, v31 offset:160
    ds_bpermute_b32 v87, v28, v31 offset:164
    ds_read_b128 v[120:123], v24 offset:2048
    ds_read_b128 v[124:127], v25 offset:2048
    v_mfma_f32_32x32x16_bf16 v[32:47], v[108:111], a[88:91], 0
    buffer_load_dwordx4 v3, s[8:11], s21 offen offset:1024 lds
    v_add_f32 v56, 0x358637bd, v56
    v_rcp_f32 v56, v56
    s_nop 0
    v_mul_f32 v48, v48, v56
    v_mul_f32 v49, v49, v56
    v_mul_f32 v50, v50, v56
    v_mul_f32 v51, v51, v56
    v_mul_f32 v52, v52, v56
    s_waitcnt lgkmcnt(6)
    v_mfma_f32_32x32x16_bf16 a[0:15], v[112:115], v[96:99], a[0:15]
    buffer_load_dwordx4 v3, s[8:11], s21 offen offset:2048 lds
    v_mul_f32 v53, v53, v56
    v_mul_f32 v54, v54, v56
    v_mul_f32 v55, v55, v56
    v_cvt_pk_bf16_f32 v100, v48, v49
    v_cvt_pk_bf16_f32 v101, v50, v51
    v_cvt_pk_bf16_f32 v102, v52, v53
    v_cvt_pk_bf16_f32 v103, v54, v55
    v_mfma_f32_32x32x16_bf16 a[16:31], v[116:119], v[96:99], a[16:31]
    buffer_load_dwordx4 v3, s[8:11], s21 offen offset:3072 lds
    s_add_u32 s20, s20, 4096
    s_add_u32 s21, s21, 4096
    s_waitcnt lgkmcnt(2)
    v_cndmask_b32 v104, v84, v80, s[62:63]
    v_cndmask_b32 v105, v85, v81, s[62:63]
    v_cndmask_b32 v106, v86, v82, s[62:63]
    v_cndmask_b32 v107, v87, v83, s[62:63]
    v_mfma_f32_32x32x16_bf16 v[48:63], v[108:111], a[92:95], 0
    buffer_load_dwordx4 v[16:19], v4, s[36:39], s61 offen
    v_add_f32 v32, 0x358637bd, v32
    v_rcp_f32 v32, v32
    s_nop 0
    v_mul_f32 v40, v40, v32
    v_mul_f32 v41, v41, v32
    v_mul_f32 v42, v42, v32
    v_mfma_f32_32x32x16_bf16 a[32:47], v[112:115], v[100:103], a[32:47]
    buffer_load_dwordx4 v[20:23], v4, s[36:39], s61 offen offset:32
    v_mul_f32 v43, v43, v32
    v_mul_f32 v44, v44, v32
    v_mul_f32 v45, v45, v32
    v_mul_f32 v46, v46, v32
    v_mul_f32 v47, v47, v32
    v_mfma_f32_32x32x16_bf16 a[48:63], v[116:119], v[100:103], a[48:63]
    buffer_load_dword v6, v5, s[8:11], s27 offen
    v_cvt_pk_bf16_f32 v96, v40, v41
    v_cvt_pk_bf16_f32 v97, v42, v43
    v_cvt_pk_bf16_f32 v98, v44, v45
    v_cvt_pk_bf16_f32 v99, v46, v47
    s_waitcnt vmcnt(15)
    ds_read_b128 v[112:115], v24 offset:4096
    ds_read_b128 v[116:119], v25 offset:4096
    v_mfma_f32_32x32x16_bf16 v[32:47], v[104:107], a[96:99], 0
    buffer_load_dword v6, v26, s[8:11], s29 offen
    v_add_f32 v48, 0x358637bd, v48
    v_rcp_f32 v48, v48
    s_nop 0
    v_mul_f32 v56, v56, v48
    v_mul_f32 v57, v57, v48
    v_mul_f32 v58, v58, v48
    v_mul_f32 v59, v59, v48
    v_mul_f32 v60, v60, v48
    s_waitcnt lgkmcnt(2)
    v_mfma_f32_32x32x16_bf16 a[0:15], v[120:123], v[96:99], a[0:15]
    s_add_u32 s60, s48, 0x3000
    v_and_b32 v14, 15, v2
    v_lshlrev_b32 v14, 2, v14
    buffer_load_dword v15, v14, s[8:11], s60 offen sc0 sc1
    s_barrier
    v_mul_f32 v61, v61, v48
    v_mul_f32 v62, v62, v48
    v_mul_f32 v63, v63, v48
    v_cvt_pk_bf16_f32 v100, v56, v57
    v_cvt_pk_bf16_f32 v101, v58, v59
    v_cvt_pk_bf16_f32 v102, v60, v61
    v_cvt_pk_bf16_f32 v103, v62, v63
    v_mfma_f32_32x32x16_bf16 a[16:31], v[124:127], v[96:99], a[16:31]
    v_cndmask_b32 v108, v80, v84, s[62:63]
    v_cndmask_b32 v109, v81, v85, s[62:63]
    v_cndmask_b32 v110, v82, v86, s[62:63]
    v_cndmask_b32 v111, v83, v87, s[62:63]
    v_mfma_f32_32x32x16_bf16 v[48:63], v[104:107], a[100:103], 0
    v_add_f32 v40, 0x358637bd, v40
    v_rcp_f32 v40, v40
    s_nop 0
    v_mul_f32 v32, v32, v40
    v_mul_f32 v33, v33, v40
    v_mul_f32 v34, v34, v40
    v_mul_f32 v35, v35, v40
    v_mul_f32 v36, v36, v40
    v_mul_f32 v37, v37, v40
    v_mfma_f32_32x32x16_bf16 a[32:47], v[120:123], v[100:103], a[32:47]
    v_mul_f32 v38, v38, v40
    v_mul_f32 v39, v39, v40
    v_cvt_pk_bf16_f32 v96, v32, v33
    v_cvt_pk_bf16_f32 v97, v34, v35
    v_cvt_pk_bf16_f32 v98, v36, v37
    v_cvt_pk_bf16_f32 v99, v38, v39
    s_waitcnt vmcnt(13)
    v_cvt_pk_bf16_f32 v88, v88, v89
    v_mfma_f32_32x32x16_bf16 a[48:63], v[124:127], v[100:103], a[48:63]
    v_cvt_pk_bf16_f32 v89, v90, v91
    v_cvt_pk_bf16_f32 v90, v92, v93
    v_cvt_pk_bf16_f32 v91, v94, v95
    ds_bpermute_b32 v92, v28, v31 offset:192
    ds_bpermute_b32 v93, v28, v31 offset:196
    ds_bpermute_b32 v94, v28, v31 offset:224
    ds_bpermute_b32 v95, v28, v31 offset:228
    ds_read_b128 v[120:123], v24 offset:6144
    ds_read_b128 v[124:127], v25 offset:6144
    v_mfma_f32_32x32x16_bf16 v[32:47], v[108:111], a[104:107], 0
    v_add_f32 v56, 0x358637bd, v56
    v_rcp_f32 v56, v56
    s_nop 0
    v_mul_f32 v48, v48, v56
    v_mul_f32 v49, v49, v56
    v_mul_f32 v50, v50, v56
    v_mul_f32 v51, v51, v56
    v_mul_f32 v52, v52, v56
    s_waitcnt lgkmcnt(6)
    v_mfma_f32_32x32x16_bf16 a[0:15], v[112:115], v[96:99], a[0:15]
    v_mul_f32 v53, v53, v56
    v_mul_f32 v54, v54, v56
    v_mul_f32 v55, v55, v56
    v_cvt_pk_bf16_f32 v100, v48, v49
    v_cvt_pk_bf16_f32 v101, v50, v51
    v_cvt_pk_bf16_f32 v102, v52, v53
    v_cvt_pk_bf16_f32 v103, v54, v55
    v_mfma_f32_32x32x16_bf16 a[16:31], v[116:119], v[96:99], a[16:31]
    s_waitcnt lgkmcnt(2)
    v_cndmask_b32 v104, v92, v88, s[62:63]
    v_cndmask_b32 v105, v93, v89, s[62:63]
    v_cndmask_b32 v106, v94, v90, s[62:63]
    v_cndmask_b32 v107, v95, v91, s[62:63]
    v_mfma_f32_32x32x16_bf16 v[48:63], v[108:111], a[108:111], 0
    v_add_f32 v32, 0x358637bd, v32
    v_rcp_f32 v32, v32
    s_nop 0
    v_mul_f32 v40, v40, v32
    v_mul_f32 v41, v41, v32
    v_mul_f32 v42, v42, v32
    v_mfma_f32_32x32x16_bf16 a[32:47], v[112:115], v[100:103], a[32:47]
    v_mul_f32 v43, v43, v32
    v_mul_f32 v44, v44, v32
    v_mul_f32 v45, v45, v32
    v_mul_f32 v46, v46, v32
    v_mul_f32 v47, v47, v32
    v_mfma_f32_32x32x16_bf16 a[48:63], v[116:119], v[100:103], a[48:63]
    v_cvt_pk_bf16_f32 v96, v40, v41
    v_cvt_pk_bf16_f32 v97, v42, v43
    v_cvt_pk_bf16_f32 v98, v44, v45
    v_cvt_pk_bf16_f32 v99, v46, v47
    s_waitcnt vmcnt(7)
    ds_read_b128 v[112:115], v24 offset:8192
    ds_read_b128 v[116:119], v25 offset:8192
    v_mfma_f32_32x32x16_bf16 v[32:47], v[104:107], a[112:115], 0
    v_add_f32 v48, 0x358637bd, v48
    v_rcp_f32 v48, v48
    s_nop 0
    v_mul_f32 v56, v56, v48
    v_mul_f32 v57, v57, v48
    v_mul_f32 v58, v58, v48
    v_mul_f32 v59, v59, v48
    v_mul_f32 v60, v60, v48
    s_waitcnt lgkmcnt(2)
    v_mfma_f32_32x32x16_bf16 a[0:15], v[120:123], v[96:99], a[0:15]
    v_mul_f32 v61, v61, v48
    v_mul_f32 v62, v62, v48
    v_mul_f32 v63, v63, v48
    v_cvt_pk_bf16_f32 v100, v56, v57
    v_cvt_pk_bf16_f32 v101, v58, v59
    v_cvt_pk_bf16_f32 v102, v60, v61
    v_cvt_pk_bf16_f32 v103, v62, v63
    v_mfma_f32_32x32x16_bf16 a[16:31], v[124:127], v[96:99], a[16:31]
    v_cndmask_b32 v108, v88, v92, s[62:63]
    v_cndmask_b32 v109, v89, v93, s[62:63]
    v_cndmask_b32 v110, v90, v94, s[62:63]
    v_cndmask_b32 v111, v91, v95, s[62:63]
    v_mfma_f32_32x32x16_bf16 v[48:63], v[104:107], a[116:119], 0
    v_add_f32 v40, 0x358637bd, v40
    v_rcp_f32 v40, v40
    s_nop 0
    v_mul_f32 v32, v32, v40
    v_mul_f32 v33, v33, v40
    v_mul_f32 v34, v34, v40
    v_mfma_f32_32x32x16_bf16 a[32:47], v[120:123], v[100:103], a[32:47]
    v_mul_f32 v35, v35, v40
    v_mul_f32 v36, v36, v40
    v_mul_f32 v37, v37, v40
    v_mul_f32 v38, v38, v40
    v_mul_f32 v39, v39, v40
    v_mfma_f32_32x32x16_bf16 a[48:63], v[124:127], v[100:103], a[48:63]
    v_cvt_pk_bf16_f32 v96, v32, v33
    v_cvt_pk_bf16_f32 v97, v34, v35
    v_cvt_pk_bf16_f32 v98, v36, v37
    v_cvt_pk_bf16_f32 v99, v38, v39
    s_waitcnt vmcnt(5)
    ds_read_b128 v[120:123], v24 offset:10240
    ds_read_b128 v[124:127], v25 offset:10240
    v_mfma_f32_32x32x16_bf16 v[32:47], v[108:111], a[120:123], 0
    v_add_f32 v56, 0x358637bd, v56
    v_rcp_f32 v56, v56
    s_nop 0
    v_mul_f32 v48, v48, v56
    v_mul_f32 v49, v49, v56
    v_mul_f32 v50, v50, v56
    s_waitcnt lgkmcnt(2)
    v_mfma_f32_32x32x16_bf16 a[0:15], v[112:115], v[96:99], a[0:15]
    v_mul_f32 v51, v51, v56
    v_mul_f32 v52, v52, v56
    v_mul_f32 v53, v53, v56
    v_mul_f32 v54, v54, v56
    v_mul_f32 v55, v55, v56
    v_mfma_f32_32x32x16_bf16 a[16:31], v[116:119], v[96:99], a[16:31]
    v_cvt_pk_bf16_f32 v100, v48, v49
    v_cvt_pk_bf16_f32 v101, v50, v51
    v_cvt_pk_bf16_f32 v102, v52, v53
    v_cvt_pk_bf16_f32 v103, v54, v55
    v_mfma_f32_32x32x16_bf16 v[48:63], v[108:111], a[124:127], 0
    v_add_f32 v32, 0x358637bd, v32
    v_rcp_f32 v32, v32
    s_nop 0
    v_mul_f32 v40, v40, v32
    v_mul_f32 v41, v41, v32
    v_mul_f32 v42, v42, v32
    v_mfma_f32_32x32x16_bf16 a[32:47], v[112:115], v[100:103], a[32:47]
    v_mul_f32 v43, v43, v32
    v_mul_f32 v44, v44, v32
    v_mul_f32 v45, v45, v32
    v_mul_f32 v46, v46, v32
    v_mul_f32 v47, v47, v32
    v_mfma_f32_32x32x16_bf16 a[48:63], v[116:119], v[100:103], a[48:63]
    v_cvt_pk_bf16_f32 v96, v40, v41
    v_cvt_pk_bf16_f32 v97, v42, v43
    v_cvt_pk_bf16_f32 v98, v44, v45
    v_cvt_pk_bf16_f32 v99, v46, v47
    s_waitcnt lgkmcnt(0)
    s_nop 0
    v_mfma_f32_32x32x16_bf16 a[0:15], v[120:123], v[96:99], a[0:15]
    v_add_f32 v48, 0x358637bd, v48
    v_rcp_f32 v48, v48
    s_nop 0
    v_mul_f32 v56, v56, v48
    v_mul_f32 v57, v57, v48
    v_mul_f32 v58, v58, v48
    v_mul_f32 v59, v59, v48
    v_mul_f32 v60, v60, v48
    v_mfma_f32_32x32x16_bf16 a[16:31], v[124:127], v[96:99], a[16:31]
    v_mul_f32 v61, v61, v48
    v_mul_f32 v62, v62, v48
    v_mul_f32 v63, v63, v48
    v_cvt_pk_bf16_f32 v100, v56, v57
    v_cvt_pk_bf16_f32 v101, v58, v59
    v_cvt_pk_bf16_f32 v102, v60, v61
    v_cvt_pk_bf16_f32 v103, v62, v63
    s_nop 1
    v_mfma_f32_32x32x16_bf16 a[32:47], v[120:123], v[100:103], a[32:47]
    v_mfma_f32_32x32x16_bf16 a[48:63], v[124:127], v[100:103], a[48:63]
    s_waitcnt vmcnt(0)
    s_getreg_b32 s57, hwreg(HW_REG_XCC_ID, 0, 4)
    s_add_u32 s57, s57, 1
    s_mov_b32 s59, 0
FK_mc8:
    v_cmp_eq_u32 vcc, 0, v15
    s_cbranch_vccz FK_mc8_out
    s_add_u32 s59, s59, 1
    s_cmp_gt_u32 s59, 0x40000
    s_cbranch_scc1 FK_mc8_out
    buffer_load_dword v15, v14, s[8:11], s60 offen sc0 sc1
    s_waitcnt vmcnt(0)
    s_branch FK_mc8
FK_mc8_out:
    v_cmp_ne_u32 vcc, s57, v15
    s_nop 1
    s_cmp_lg_u32 vcc_lo, 0
    s_cselect_b32 s56, 1, 0
    v_permlane32_swap_b32 v16, v18
    v_permlane32_swap_b32 v17, v19
    v_permlane32_swap_b32 v20, v22
    v_permlane32_swap_b32 v21, v23
    s_waitcnt vmcnt(0) lgkmcnt(0)
FK_Yc:
    s_mul_i32 s20, s4, 12288
    s_add_u32 s20, s20, 114688
    v_add_u32 v4, s20, v3
    ds_write_b128 v4, a[16:19] offset:0
    ds_write_b128 v4, a[20:23] offset:1024
    ds_write_b128 v4, a[24:27] offset:2048
    ds_write_b128 v4, a[28:31] offset:3072
    s_nop 1
    ds_write_b128 v4, a[32:35] offset:4096
    ds_write_b128 v4, a[36:39] offset:5120
    ds_write_b128 v4, a[40:43] offset:6144
    ds_write_b128 v4, a[44:47] offset:7168
    ds_write_b128 v4, a[48:51] offset:8192
    ds_write_b128 v4, a[52:55] offset:9216
    ds_write_b128 v4, a[56:59] offset:10240
    ds_write_b128 v4, a[60:63] offset:11264
    s_xor_b32 s20, s4, 1
    s_mul_i32 s20, s20, 12288
    s_add_u32 s20, s20, 114688
    v_add_u32 v5, s20, v3
    s_xor_b32 s20, s4, 2
    s_mul_i32 s20, s20, 12288
    s_add_u32 s20, s20, 118784
    v_add_u32 v6, s20, v3
    s_xor_b32 s20, s4, 3
    s_mul_i32 s20, s20, 12288
    s_add_u32 s20, s20, 122880
    v_add_u32 v7, s20, v3
    v_accvgpr_read_b32 v32, a0
    v_accvgpr_read_b32 v33, a1
    v_accvgpr_read_b32 v34, a2
    v_accvgpr_read_b32 v35, a3
    v_accvgpr_read_b32 v36, a4
    v_accvgpr_read_b32 v37, a5
    v_accvgpr_read_b32 v38, a6
    v_accvgpr_read_b32 v39, a7
    v_accvgpr_read_b32 v40, a8
    v_accvgpr_read_b32 v41, a9
    v_accvgpr_read_b32 v42, a10
    v_accvgpr_read_b32 v43, a11
    v_accvgpr_read_b32 v44, a12
    v_accvgpr_read_b32 v45, a13
    v_accvgpr_read_b32 v46, a14
    v_accvgpr_read_b32 v47, a15
    v_lshlrev_b32 v8, 16, v16
    v_and_b32 v9, 0xffff0000, v16
    v_add_f32 v32, v32, v8
    v_add_f32 v33, v33, v9
    v_lshlrev_b32 v10, 16, v17
    v_and_b32 v11, 0xffff0000, v17
    v_add_f32 v34, v34, v10
    v_add_f32 v35, v35, v11
    v_lshlrev_b32 v8, 16, v18
    v_and_b32 v9, 0xffff0000, v18
    v_add_f32 v36, v36, v8
    v_add_f32 v37, v37, v9
    v_lshlrev_b32 v10, 16, v19
    v_and_b32 v11, 0xffff0000, v19
    v_add_f32 v38, v38, v10
    v_add_f32 v39, v39, v11
    v_lshlrev_b32 v8, 16, v20
    v_and_b32 v9, 0xffff0000, v20
    v_add_f32 v40, v40, v8
    v_add_f32 v41, v41, v9
    v_lshlrev_b32 v10, 16, v21
    v_and_b32 v11, 0xffff0000, v21
    v_add_f32 v42, v42, v10
    v_add_f32 v43, v43, v11
    v_lshlrev_b32 v8, 16, v22
    v_and_b32 v9, 0xffff0000, v22
    v_add_f32 v44, v44, v8
    v_add_f32 v45, v45, v9
    v_lshlrev_b32 v10, 16, v23
    v_and_b32 v11, 0xffff0000, v23
    v_add_f32 v46, v46, v10
    v_add_f32 v47, v47, v11
    s_waitcnt lgkmcnt(0)
    s_barrier
    ds_read_b128 v[64:67], v5 offset:0
    ds_read_b128 v[68:71], v5 offset:1024
    ds_read_b128 v[72:75], v5 offset:2048
    ds_read_b128 v[76:79], v5 offset:3072
    ds_read_b128 v[80:83], v6 offset:0
    ds_read_b128 v[84:87], v6 offset:1024
    ds_read_b128 v[88:91], v6 offset:2048
    ds_read_b128 v[92:95], v6 offset:3072
    ds_read_b128 v[96:99], v7 offset:0
    ds_read_b128 v[100:103], v7 offset:1024
    ds_read_b128 v[104:107], v7 offset:2048
    ds_read_b128 v[108:111], v7 offset:3072
    v_mov_b32 v8, 0
    v_mov_b32 v9, 0
    v_mov_b32 v12, 0x3f803f80
    s_waitcnt lgkmcnt(8)
    v_add_f32 v32, v32, v64
    v_add_f32 v33, v33, v65
    v_add_f32 v34, v34, v66
    v_add_f32 v35, v35, v67
    v_add_f32 v36, v36, v68
    v_add_f32 v37, v37, v69
    v_add_f32 v38, v38, v70
    v_add_f32 v39, v39, v71
    v_add_f32 v40, v40, v72
    v_add_f32 v41, v41, v73
    v_add_f32 v42, v42, v74
    v_add_f32 v43, v43, v75
    v_add_f32 v44, v44, v76
    v_add_f32 v45, v45, v77
    v_add_f32 v46, v46, v78
    v_add_f32 v47, v47, v79
    s_waitcnt lgkmcnt(4)
    v_add_f32 v32, v32, v80
    v_add_f32 v33, v33, v81
    v_add_f32 v34, v34, v82
    v_add_f32 v35, v35, v83
    v_add_f32 v36, v36, v84
    v_add_f32 v37, v37, v85
    v_add_f32 v38, v38, v86
    v_add_f32 v39, v39, v87
    v_add_f32 v40, v40, v88
    v_add_f32 v41, v41, v89
    v_add_f32 v42, v42, v90
    v_add_f32 v43, v43, v91
    v_add_f32 v44, v44, v92
    v_add_f32 v45, v45, v93
    v_add_f32 v46, v46, v94
    v_add_f32 v47, v47, v95
    s_waitcnt lgkmcnt(0)
    v_add_f32 v32, v32, v96
    v_add_f32 v33, v33, v97
    v_add_f32 v34, v34, v98
    v_add_f32 v35, v35, v99
    v_add_f32 v36, v36, v100
    v_add_f32 v37, v37, v101
    v_add_f32 v38, v38, v102
    v_add_f32 v39, v39, v103
    v_add_f32 v40, v40, v104
    v_add_f32 v41, v41, v105
    v_add_f32 v42, v42, v106
    v_add_f32 v43, v43, v107
    v_add_f32 v44, v44, v108
    v_add_f32 v45, v45, v109
    v_add_f32 v46, v46, v110
    v_add_f32 v47, v47, v111
    v_cvt_pk_bf16_f32 v16, v32, v33
    v_cvt_pk_bf16_f32 v17, v34, v35
    v_cvt_pk_bf16_f32 v18, v36, v37
    v_cvt_pk_bf16_f32 v19, v38, v39
    v_cvt_pk_bf16_f32 v20, v40, v41
    v_cvt_pk_bf16_f32 v21, v42, v43
    v_cvt_pk_bf16_f32 v22, v44, v45
    v_cvt_pk_bf16_f32 v23, v46, v47
    s_cmp_eq_u32 s56, 0
    s_cbranch_scc1 FK_ds9_f
    buffer_store_dwordx4 v[16:19], v3, s[8:11], s27 offen sc0 sc1
    buffer_store_dwordx4 v[20:23], v3, s[8:11], s27 offen offset:1024 sc0 sc1
    s_branch FK_ds9_d
FK_ds9_f:
    buffer_store_dwordx4 v[16:19], v3, s[8:11], s27 offen
    buffer_store_dwordx4 v[20:23], v3, s[8:11], s27 offen offset:1024
FK_ds9_d:
    v_dot2_f32_bf16 v8, v16, v12, v8
    v_dot2_f32_bf16 v9, v16, v16, v9
    v_dot2_f32_bf16 v8, v17, v12, v8
    v_dot2_f32_bf16 v9, v17, v17, v9
    v_dot2_f32_bf16 v8, v18, v12, v8
    v_dot2_f32_bf16 v9, v18, v18, v9
    v_dot2_f32_bf16 v8, v19, v12, v8
    v_dot2_f32_bf16 v9, v19, v19, v9
    v_dot2_f32_bf16 v8, v20, v12, v8
    v_dot2_f32_bf16 v9, v20, v20, v9
    v_dot2_f32_bf16 v8, v21, v12, v8
    v_dot2_f32_bf16 v9, v21, v21, v9
    v_dot2_f32_bf16 v8, v22, v12, v8
    v_dot2_f32_bf16 v9, v22, v22, v9
    v_dot2_f32_bf16 v8, v23, v12, v8
    v_dot2_f32_bf16 v9, v23, v23, v9
    s_nop 1
    v_mov_b32 v10, v8
    v_mov_b32 v11, v9
    s_nop 0
    v_permlane32_swap_b32 v8, v10
    v_permlane32_swap_b32 v9, v11
    v_add_f32 v8, v8, v10
    v_add_f32 v9, v9, v11
    s_mov_b64 exec, 0xffffffff
    s_cmp_eq_u32 s56, 0
    s_cbranch_scc1 FK_ds10_f
    buffer_store_dwordx2 v[8:9], v3, s[8:11], s29 offen sc0 sc1
    s_branch FK_ds10_d
FK_ds10_f:
    buffer_store_dwordx2 v[8:9], v3, s[8:11], s29 offen
FK_ds10_d:
    s_mov_b64 exec, -1
    v_mov_b32 v8, 0
    v_mov_b32 v9, 1
    s_waitcnt vmcnt(0)
    s_mov_b64 exec, 1
    s_cmp_eq_u32 s56, 0
    s_cbranch_scc1 FK_pb11_f
    buffer_store_byte v9, v8, s[8:11], s30 offen sc0 sc1
    s_branch FK_pb11_d
FK_pb11_f:
    buffer_store_byte v9, v8, s[8:11], s30 offen
FK_pb11_d:
    s_mov_b64 exec, -1
    s_add_u32 s14, s13, s42
    s_mul_i32 s15, s53, 237568
    s_add_u32 s15, s15, 2277376
    s_lshl_b32 s16, s4, 12
    s_add_u32 s17, s15, s16
    s_lshl_b32 s18, s4, 11
    s_add_u32 s18, s18, 114688
    s_mul_i32 s21, s55, 229376
    s_mul_i32 s22, s4, 57344
    s_add_u32 s21, s21, s22
    s_add_u32 s21, s21, 5963776
    s_lshl_b32 s22, s5, 10
    s_add_u32 s23, s21, s22
    s_xor_b32 s22, s22, 1024
    s_add_u32 s24, s21, s22
    s_add_u32 s23, s23, 32768
    s_add_u32 s24, s24, 32768
    s_setprio 0
    s_barrier
    s_barrier
    s_add_u32 s19, s16, 114688
    s_mov_b32 m0, s19
    s_nop 0
    buffer_load_dwordx4 v3, s[8:11], s17 offen offset:0  lds
    buffer_load_dwordx4 v3, s[8:11], s17 offen offset:1024  lds
    buffer_load_dwordx4 v3, s[8:11], s17 offen offset:2048  lds
    buffer_load_dwordx4 v3, s[8:11], s17 offen offset:3072  lds
    s_add_u32 s17, s17, 16384
    s_add_u32 s19, s16, 131072
    s_mov_b32 m0, s19
    s_nop 0
    buffer_load_dwordx4 v3, s[8:11], s17 offen offset:0  lds
    buffer_load_dwordx4 v3, s[8:11], s17 offen offset:1024  lds
    buffer_load_dwordx4 v3, s[8:11], s17 offen offset:2048  lds
    buffer_load_dwordx4 v3, s[8:11], s17 offen offset:3072  lds
    s_add_u32 s17, s17, 16384
    s_barrier
    s_add_u32 s19, s16, 147456
    s_mov_b32 m0, s19
    s_nop 0
    buffer_load_dwordx4 v3, s[8:11], s17 offen offset:0  lds
    buffer_load_dwordx4 v3, s[8:11], s17 offen offset:1024  lds
    buffer_load_dwordx4 v3, s[8:11], s17 offen offset:2048  lds
    buffer_load_dwordx4 v3, s[8:11], s17 offen offset:3072  lds
    s_add_u32 s17, s17, 16384
    s_add_u32 s19, s16, 0
    s_mov_b32 m0, s19
    s_nop 0
    buffer_load_dwordx4 v3, s[8:11], s17 offen offset:0  lds
    buffer_load_dwordx4 v3, s[8:11], s17 offen offset:1024  lds
    buffer_load_dwordx4 v3, s[8:11], s17 offen offset:2048  lds
    buffer_load_dwordx4 v3, s[8:11], s17 offen offset:3072  lds
    s_add_u32 s17, s17, 16384
    s_add_u32 s19, s16, 16384
    s_mov_b32 m0, s19
    s_nop 0
    buffer_load_dwordx4 v3, s[8:11], s17 offen offset:0  lds
    buffer_load_dwordx4 v3, s[8:11], s17 offen offset:1024  lds
    buffer_load_dwordx4 v3, s[8:11], s17 offen offset:2048  lds
    buffer_load_dwordx4 v3, s[8:11], s17 offen offset:3072  lds
    s_add_u32 s17, s17, 16384
    s_waitcnt vmcnt(16)
    s_barrier
    s_add_u32 s19, s16, 32768
    s_mov_b32 m0, s19
    s_nop 0
    buffer_load_dwordx4 v3, s[8:11], s17 offen offset:0  lds
    buffer_load_dwordx4 v3, s[8:11], s17 offen offset:1024  lds
    buffer_load_dwordx4 v3, s[8:11], s17 offen offset:2048  lds
    buffer_load_dwordx4 v3, s[8:11], s17 offen offset:3072  lds
    s_add_u32 s17, s17, 16384
    s_add_u32 s19, s16, 49152
    s_mov_b32 m0, s19
    s_nop 0
    buffer_load_dwordx4 v3, s[8:11], s17 offen offset:0  lds
    buffer_load_dwordx4 v3, s[8:11], s17 offen offset:1024  lds
    buffer_load_dwordx4 v3, s[8:11], s17 offen offset:2048  lds
    buffer_load_dwordx4 v3, s[8:11], s17 offen offset:3072  lds
    s_add_u32 s17, s17, 16384
    s_lshr_b32 s18, s16, 1
    s_add_u32 s19, s18, 65536
    s_sub_u32 s17, s17, s18
    s_mov_b32 m0, s19
    s_nop 0
    buffer_load_dwordx4 v3, s[8:11], s17 offen offset:0 lds
    buffer_load_dwordx4 v3, s[8:11], s17 offen offset:1024 lds
    s_waitcnt vmcnt(22)
    s_waitcnt vmcnt(18)
    s_barrier
    s_add_u32 s19, s16, 81920
    s_mov_b32 m0, s19
    s_nop 0
    buffer_load_dwordx4 v3, s[8:11], s21 offen offset:0 lds
    buffer_load_dwordx4 v3, s[8:11], s21 offen offset:1024 lds
    buffer_load_dwordx4 v3, s[8:11], s21 offen offset:2048 lds
    buffer_load_dwordx4 v3, s[8:11], s21 offen offset:3072 lds
    s_add_u32 s21, s21, 4096
    buffer_load_dwordx4 v[32:35], v3, s[8:11], s23 offen offset:0
    buffer_load_dwordx4 v[36:39], v3, s[8:11], s24 offen offset:0
    buffer_load_dwordx4 v[40:43], v3, s[8:11], s23 offen offset:2048
    buffer_load_dwordx4 v[44:47], v3, s[8:11], s24 offen offset:2048
    s_add_u32 s23, s23, 4096
    s_add_u32 s24, s24, 4096
    s_add_u32 s19, s16, 98304
    s_mov_b32 m0, s19
    s_nop 0
    buffer_load_dwordx4 v3, s[8:11], s21 offen offset:0 lds
    buffer_load_dwordx4 v3, s[8:11], s21 offen offset:1024 lds
    buffer_load_dwordx4 v3, s[8:11], s21 offen offset:2048 lds
    buffer_load_dwordx4 v3, s[8:11], s21 offen offset:3072 lds
    s_add_u32 s21, s21, 4096
    s_waitcnt vmcnt(26)
    s_waitcnt vmcnt(22)
    s_barrier
    s_add_u32 s19, s16, 114688
    s_mov_b32 m0, s19
    s_nop 0
    buffer_load_dwordx4 v3, s[8:11], s21 offen offset:0 lds
    buffer_load_dwordx4 v3, s[8:11], s21 offen offset:1024 lds
    buffer_load_dwordx4 v3, s[8:11], s21 offen offset:2048 lds
    buffer_load_dwordx4 v3, s[8:11], s21 offen offset:3072 lds
    s_add_u32 s21, s21, 4096
    buffer_load_dwordx4 v[48:51], v3, s[8:11], s23 offen offset:0
    buffer_load_dwordx4 v[52:55], v3, s[8:11], s24 offen offset:0
    buffer_load_dwordx4 v[56:59], v3, s[8:11], s23 offen offset:2048
    buffer_load_dwordx4 v[60:63], v3, s[8:11], s24 offen offset:2048
    s_add_u32 s23, s23, 4096
    s_add_u32 s24, s24, 4096
    s_add_u32 s19, s16, 131072
    s_mov_b32 m0, s19
    s_nop 0
    buffer_load_dwordx4 v3, s[8:11], s21 offen offset:0 lds
    buffer_load_dwordx4 v3, s[8:11], s21 offen offset:1024 lds
    buffer_load_dwordx4 v3, s[8:11], s21 offen offset:2048 lds
    buffer_load_dwordx4 v3, s[8:11], s21 offen offset:3072 lds
    s_add_u32 s21, s21, 4096
    s_waitcnt vmcnt(30)
    s_waitcnt vmcnt(26)
    s_barrier
    s_add_u32 s19, s16, 147456
    s_mov_b32 m0, s19
    s_nop 0
    buffer_load_dwordx4 v3, s[8:11], s21 offen offset:0 lds
    buffer_load_dwordx4 v3, s[8:11], s21 offen offset:1024 lds
    buffer_load_dwordx4 v3, s[8:11], s21 offen offset:2048 lds
    buffer_load_dwordx4 v3, s[8:11], s21 offen offset:3072 lds
    s_add_u32 s21, s21, 4096
    buffer_load_dwordx4 v[64:67], v3, s[8:11], s23 offen offset:0
    buffer_load_dwordx4 v[68:71], v3, s[8:11], s24 offen offset:0
    buffer_load_dwordx4 v[72:75], v3, s[8:11], s23 offen offset:2048
    buffer_load_dwordx4 v[76:79], v3, s[8:11], s24 offen offset:2048
    s_add_u32 s23, s23, 4096
    s_add_u32 s24, s24, 4096
    s_add_u32 s19, s16, 0
    s_mov_b32 m0, s19
    s_nop 0
    buffer_load_dwordx4 v3, s[8:11], s21 offen offset:0 lds
    buffer_load_dwordx4 v3, s[8:11], s21 offen offset:1024 lds
    buffer_load_dwordx4 v3, s[8:11], s21 offen offset:2048 lds
    buffer_load_dwordx4 v3, s[8:11], s21 offen offset:3072 lds
    s_add_u32 s21, s21, 4096
    s_waitcnt vmcnt(36)
    s_barrier
    buffer_load_dwordx4 v[80:83], v3, s[8:11], s23 offen offset:0
    buffer_load_dwordx4 v[84:87], v3, s[8:11], s24 offen offset:0
    buffer_load_dwordx4 v[88:91], v3, s[8:11], s23 offen offset:2048
    buffer_load_dwordx4 v[92:95], v3, s[8:11], s24 offen offset:2048
    s_add_u32 s23, s23, 4096
    s_add_u32 s24, s24, 4096
    s_add_u32 s19, s16, 16384
    s_mov_b32 m0, s19
    s_nop 0
    buffer_load_dwordx4 v3, s[8:11], s21 offen offset:0 lds
    buffer_load_dwordx4 v3, s[8:11], s21 offen offset:1024 lds
    buffer_load_dwordx4 v3, s[8:11], s21 offen offset:2048 lds
    buffer_load_dwordx4 v3, s[8:11], s21 offen offset:3072 lds
    s_add_u32 s21, s21, 4096
    buffer_load_dwordx4 v[96:99], v3, s[8:11], s23 offen offset:0
    buffer_load_dwordx4 v[100:103], v3, s[8:11], s24 offen offset:0
    buffer_load_dwordx4 v[104:107], v3, s[8:11], s23 offen offset:2048
    buffer_load_dwordx4 v[108:111], v3, s[8:11], s24 offen offset:2048
    s_add_u32 s23, s23, 4096
    s_add_u32 s24, s24, 4096
    s_add_u32 s19, s16, 32768
    s_mov_b32 m0, s19
    s_nop 0
    buffer_load_dwordx4 v3, s[8:11], s21 offen offset:0 lds
    buffer_load_dwordx4 v3, s[8:11], s21 offen offset:1024 lds
    buffer_load_dwordx4 v3, s[8:11], s21 offen offset:2048 lds
    buffer_load_dwordx4 v3, s[8:11], s21 offen offset:3072 lds
    s_add_u32 s21, s21, 4096
    buffer_load_dwordx4 v[112:115], v3, s[8:11], s23 offen offset:0
    buffer_load_dwordx4 v[116:119], v3, s[8:11], s24 offen offset:0
    buffer_load_dwordx4 v[120:123], v3, s[8:11], s23 offen offset:2048
    buffer_load_dwordx4 v[124:127], v3, s[8:11], s24 offen offset:2048
    s_add_u32 s23, s23, 4096
    s_add_u32 s24, s24, 4096
    s_lshl_b32 s19, s54, 5
    s_lshl_b32 s20, s4, 3
    s_add_u32 s19, s19, s20
    s_add_u32 s19, s19, s48
    s_add_u32 s19, s19, 0x1000
    s_mul_i32 s16, s4, 28672
    s_mul_i32 s17, s50, 114688
    s_add_u32 s17, s17, s16
    s_add_u32 s17, s17, s40
    s_mul_i32 s18, s51, 114688
    s_add_u32 s18, s18, s16
    s_add_u32 s18, s18, s40
    s_lshl_b32 s20, s4, 12
    s_lshl_b32 s22, s5, 10
    s_add_u32 s14, s20, s22
    s_xor_b32 s22, s22, 1024
    s_add_u32 s15, s20, s22
    v_add_u32 v24, s14, v3
    v_add_u32 v25, s15, v3
    v_add_u32 v26, 0x10000, v24
    v_add_u32 v27, 0x10000, v25
    v_add_u32 v28, 0x20000, v24
    v_add_u32 v29, 0x20000, v25
    s_setprio 3
    s_waitcnt lgkmcnt(0)
    v_mov_b32 v12, 0
    s_mov_b32 s59, 0
    s_mov_b64 exec, 1
FK_pl12:
    buffer_load_dwordx2 v[8:9], v12, s[8:11], s19 offen sc1
    s_waitcnt vmcnt(0)
    v_and_b32 v8, v8, v9
    s_nop 0
    v_readfirstlane_b32 s58, v8
    s_add_u32 s59, s59, 1
    s_cmp_gt_u32 s59, 0x40000
    s_cbranch_scc1 FK_pl12_out
    s_cmp_lg_u32 s58, 0x01010101
    s_cbranch_scc1 FK_pl12
FK_pl12_out:
    s_mov_b64 exec, -1
    s_add_u32 s61, s17, 16384
    s_add_u32 s62, s18, 16384
    buffer_load_dwordx4 a[112:115], v3, s[8:11], s61 offen offset:0 sc1
    buffer_load_dwordx4 a[116:119], v3, s[8:11], s62 offen offset:0 sc1
    buffer_load_dwordx4 a[120:123], v3, s[8:11], s61 offen offset:1024 sc1
    buffer_load_dwordx4 a[124:127], v3, s[8:11], s62 offen offset:1024 sc1
    buffer_load_dwordx4 a[64:67], v3, s[8:11], s61 offen offset:2048 sc1
    buffer_load_dwordx4 a[68:71], v3, s[8:11], s62 offen offset:2048 sc1
    buffer_load_dwordx4 a[72:75], v3, s[8:11], s61 offen offset:3072 sc1
    buffer_load_dwordx4 a[76:79], v3, s[8:11], s62 offen offset:3072 sc1
    s_add_u32 s61, s61, 4096
    s_add_u32 s62, s62, 4096
    buffer_load_dwordx4 a[80:83], v3, s[8:11], s61 offen offset:0 sc1
    buffer_load_dwordx4 a[84:87], v3, s[8:11], s62 offen offset:0 sc1
    buffer_load_dwordx4 a[88:91], v3, s[8:11], s61 offen offset:1024 sc1
    buffer_load_dwordx4 a[92:95], v3, s[8:11], s62 offen offset:1024 sc1
    v_lshlrev_b32 v5, 5, v2
    v_lshlrev_b32 v7, 3, v2
    buffer_load_dword v6, v5, s[8:11], s27 offen
    buffer_load_dword v6, v7, s[8:11], s29 offen
    s_waitcnt vmcnt(12)
    v_mfma_f32_32x32x16_bf16 a[0:15], v[32:35], a[112:115], 0
    v_mfma_f32_32x32x16_bf16 a[16:31], v[36:39], a[112:115], 0
    v_mfma_f32_32x32x16_bf16 a[32:47], v[32:35], a[116:119], 0
    v_mfma_f32_32x32x16_bf16 a[48:63], v[36:39], a[116:119], 0
    s_waitcnt vmcnt(10)
    v_mfma_f32_32x32x16_bf16 a[0:15], v[40:43], a[120:123], a[0:15]
    buffer_load_dwordx4 a[96:99], v3, s[8:11], s17 offen offset:0 sc1
    v_mfma_f32_32x32x16_bf16 a[16:31], v[44:47], a[120:123], a[16:31]
    v_mfma_f32_32x32x16_bf16 a[32:47], v[40:43], a[124:127], a[32:47]
    buffer_load_dwordx4 a[100:103], v3, s[8:11], s18 offen offset:0 sc1
    v_mfma_f32_32x32x16_bf16 a[48:63], v[44:47], a[124:127], a[48:63]
    s_waitcnt vmcnt(10)
    v_mfma_f32_32x32x16_bf16 a[0:15], v[48:51], a[64:67], a[0:15]
    buffer_load_dwordx4 a[104:107], v3, s[8:11], s17 offen offset:1024 sc1
    v_mfma_f32_32x32x16_bf16 a[16:31], v[52:55], a[64:67], a[16:31]
    v_mfma_f32_32x32x16_bf16 a[32:47], v[48:51], a[68:71], a[32:47]
    buffer_load_dwordx4 a[108:111], v3, s[8:11], s18 offen offset:1024 sc1
    v_mfma_f32_32x32x16_bf16 a[48:63], v[52:55], a[68:71], a[48:63]
    s_waitcnt vmcnt(10)
    v_mfma_f32_32x32x16_bf16 a[0:15], v[56:59], a[72:75], a[0:15]
    buffer_load_dwordx4 v[32:35], v3, s[8:11], s17 offen offset:2048 sc1
    v_mfma_f32_32x32x16_bf16 a[16:31], v[60:63], a[72:75], a[16:31]
    v_mfma_f32_32x32x16_bf16 a[32:47], v[56:59], a[76:79], a[32:47]
    buffer_load_dwordx4 v[36:39], v3, s[8:11], s18 offen offset:2048 sc1
    v_mfma_f32_32x32x16_bf16 a[48:63], v[60:63], a[76:79], a[48:63]
    s_waitcnt vmcnt(10)
    v_mfma_f32_32x32x16_bf16 a[0:15], v[64:67], a[80:83], a[0:15]
    buffer_load_dwordx4 v[40:43], v3, s[8:11], s17 offen offset:3072 sc1
    v_mfma_f32_32x32x16_bf16 a[16:31], v[68:71], a[80:83], a[16:31]
    v_mfma_f32_32x32x16_bf16 a[32:47], v[64:67], a[84:87], a[32:47]
    buffer_load_dwordx4 v[44:47], v3, s[8:11], s18 offen offset:3072 sc1
    s_add_u32 s17, s17, 4096
    s_add_u32 s18, s18, 4096
    v_mfma_f32_32x32x16_bf16 a[48:63], v[68:71], a[84:87], a[48:63]
    s_waitcnt vmcnt(10)
    v_mfma_f32_32x32x16_bf16 a[0:15], v[72:75], a[88:91], a[0:15]
    buffer_load_dwordx4 a[64:67], v3, s[8:11], s17 offen offset:0 sc1
    v_mfma_f32_32x32x16_bf16 a[16:31], v[76:79], a[88:91], a[16:31]
    ds_read_b128 a[112:115], v26 offset:16384
    ds_read_b128 a[116:119], v27 offset:16384
    v_mfma_f32_32x32x16_bf16 a[32:47], v[72:75], a[92:95], a[32:47]
    buffer_load_dwordx4 a[68:71], v3, s[8:11], s18 offen offset:0 sc1
    v_mfma_f32_32x32x16_bf16 a[48:63], v[76:79], a[92:95], a[48:63]
    s_waitcnt vmcnt(8)
    s_waitcnt lgkmcnt(0)
    v_mfma_f32_32x32x16_bf16 a[0:15], a[112:115], a[96:99], a[0:15]
    buffer_load_dwordx4 v[48:51], v3, s[8:11], s17 offen offset:1024 sc1
    v_mfma_f32_32x32x16_bf16 a[16:31], a[116:119], a[96:99], a[16:31]
    ds_read_b128 a[120:123], v26 offset:18432
    ds_read_b128 a[124:127], v27 offset:18432
    v_mfma_f32_32x32x16_bf16 a[32:47], a[112:115], a[100:103], a[32:47]
    buffer_load_dwordx4 v[52:55], v3, s[8:11], s18 offen offset:1024 sc1
    v_mfma_f32_32x32x16_bf16 a[48:63], a[116:119], a[100:103], a[48:63]
    s_waitcnt vmcnt(8)
    s_waitcnt lgkmcnt(0)
    v_mfma_f32_32x32x16_bf16 a[0:15], a[120:123], a[104:107], a[0:15]
    buffer_load_dwordx4 a[72:75], v3, s[8:11], s17 offen offset:2048 sc1
    v_mfma_f32_32x32x16_bf16 a[16:31], a[124:127], a[104:107], a[16:31]
    ds_read_b128 a[112:115], v26 offset:32768
    ds_read_b128 a[116:119], v27 offset:32768
    v_mfma_f32_32x32x16_bf16 a[32:47], a[120:123], a[108:111], a[32:47]
    buffer_load_dwordx4 a[76:79], v3, s[8:11], s18 offen offset:2048 sc1
    v_mfma_f32_32x32x16_bf16 a[48:63], a[124:127], a[108:111], a[48:63]
    s_waitcnt vmcnt(8)
    s_waitcnt lgkmcnt(0)
    v_mfma_f32_32x32x16_bf16 a[0:15], a[112:115], v[32:35], a[0:15]
    buffer_load_dwordx4 v[56:59], v3, s[8:11], s17 offen offset:3072 sc1
    v_mfma_f32_32x32x16_bf16 a[16:31], a[116:119], v[32:35], a[16:31]
    ds_read_b128 a[120:123], v26 offset:34816
    ds_read_b128 a[124:127], v27 offset:34816
    v_mfma_f32_32x32x16_bf16 a[32:47], a[112:115], v[36:39], a[32:47]
    buffer_load_dwordx4 v[60:63], v3, s[8:11], s18 offen offset:3072 sc1
    s_add_u32 s17, s17, 4096
    s_add_u32 s18, s18, 4096
    v_mfma_f32_32x32x16_bf16 a[48:63], a[116:119], v[36:39], a[48:63]
    s_waitcnt vmcnt(8)
    s_waitcnt lgkmcnt(0)
    v_mfma_f32_32x32x16_bf16 a[0:15], a[120:123], v[40:43], a[0:15]
    buffer_load_dwordx4 a[80:83], v3, s[8:11], s17 offen offset:0 sc1
    v_mfma_f32_32x32x16_bf16 a[16:31], a[124:127], v[40:43], a[16:31]
    ds_read_b128 a[112:115], v26 offset:49152
    ds_read_b128 a[116:119], v27 offset:49152
    v_mfma_f32_32x32x16_bf16 a[32:47], a[120:123], v[44:47], a[32:47]
    buffer_load_dwordx4 a[84:87], v3, s[8:11], s18 offen offset:0 sc1
    v_mfma_f32_32x32x16_bf16 a[48:63], a[124:127], v[44:47], a[48:63]
    s_waitcnt vmcnt(8)
    s_waitcnt lgkmcnt(0)
    v_mfma_f32_32x32x16_bf16 a[0:15], a[112:115], a[64:67], a[0:15]
    buffer_load_dwordx4 v[64:67], v3, s[8:11], s17 offen offset:1024 sc1
    v_mfma_f32_32x32x16_bf16 a[16:31], a[116:119], a[64:67], a[16:31]
    ds_read_b128 a[120:123], v26 offset:51200
    ds_read_b128 a[124:127], v27 offset:51200
    v_mfma_f32_32x32x16_bf16 a[32:47], a[112:115], a[68:71], a[32:47]
    buffer_load_dwordx4 v[68:71], v3, s[8:11], s18 offen offset:1024 sc1
    v_mfma_f32_32x32x16_bf16 a[48:63], a[116:119], a[68:71], a[48:63]
    s_waitcnt vmcnt(8)
    s_waitcnt lgkmcnt(0)
    v_mfma_f32_32x32x16_bf16 a[0:15], a[120:123], v[48:51], a[0:15]
    buffer_load_dwordx4 a[88:91], v3, s[8:11], s17 offen offset:2048 sc1
    v_mfma_f32_32x32x16_bf16 a[16:31], a[124:127], v[48:51], a[16:31]
    ds_read_b128 a[112:115], v28 offset:0
    ds_read_b128 a[116:119], v29 offset:0
    v_mfma_f32_32x32x16_bf16 a[32:47], a[120:123], v[52:55], a[32:47]
    buffer_load_dwordx4 a[92:95], v3, s[8:11], s18 offen offset:2048 sc1
    v_mfma_f32_32x32x16_bf16 a[48:63], a[124:127], v[52:55], a[48:63]
    s_waitcnt vmcnt(8)
    s_waitcnt lgkmcnt(0)
    v_mfma_f32_32x32x16_bf16 a[0:15], a[112:115], a[72:75], a[0:15]
    buffer_load_dwordx4 v[72:75], v3, s[8:11], s17 offen offset:3072 sc1
    v_mfma_f32_32x32x16_bf16 a[16:31], a[116:119], a[72:75], a[16:31]
    ds_read_b128 a[120:123], v28 offset:2048
    ds_read_b128 a[124:127], v29 offset:2048
    v_mfma_f32_32x32x16_bf16 a[32:47], a[112:115], a[76:79], a[32:47]
    buffer_load_dwordx4 v[76:79], v3, s[8:11], s18 offen offset:3072 sc1
    s_add_u32 s17, s17, 4096
    s_add_u32 s18, s18, 4096
    v_mfma_f32_32x32x16_bf16 a[48:63], a[116:119], a[76:79], a[48:63]
    s_waitcnt vmcnt(8)
    s_waitcnt lgkmcnt(0)
    v_mfma_f32_32x32x16_bf16 a[0:15], a[120:123], v[56:59], a[0:15]
    buffer_load_dwordx4 a[96:99], v3, s[8:11], s17 offen offset:0 sc1
    v_mfma_f32_32x32x16_bf16 a[16:31], a[124:127], v[56:59], a[16:31]
    ds_read_b128 a[112:115], v28 offset:16384
    ds_read_b128 a[116:119], v29 offset:16384
    v_mfma_f32_32x32x16_bf16 a[32:47], a[120:123], v[60:63], a[32:47]
    buffer_load_dwordx4 a[100:103], v3, s[8:11], s18 offen offset:0 sc1
    v_mfma_f32_32x32x16_bf16 a[48:63], a[124:127], v[60:63], a[48:63]
    s_waitcnt vmcnt(8)
    s_waitcnt lgkmcnt(0)
    v_mfma_f32_32x32x16_bf16 a[0:15], a[112:115], a[80:83], a[0:15]
    buffer_load_dwordx4 a[104:107], v3, s[8:11], s17 offen offset:1024 sc1
    v_mfma_f32_32x32x16_bf16 a[16:31], a[116:119], a[80:83], a[16:31]
    ds_read_b128 a[120:123], v28 offset:18432
    ds_read_b128 a[124:127], v29 offset:18432
    v_mfma_f32_32x32x16_bf16 a[32:47], a[112:115], a[84:87], a[32:47]
    buffer_load_dwordx4 a[108:111], v3, s[8:11], s18 offen offset:1024 sc1
    v_mfma_f32_32x32x16_bf16 a[48:63], a[116:119], a[84:87], a[48:63]
    s_waitcnt vmcnt(8)
    s_waitcnt lgkmcnt(0)
    v_mfma_f32_32x32x16_bf16 a[0:15], a[120:123], v[64:67], a[0:15]
    buffer_load_dwordx4 v[32:35], v3, s[8:11], s17 offen offset:2048 sc1
    v_mfma_f32_32x32x16_bf16 a[16:31], a[124:127], v[64:67], a[16:31]
    ds_read_b128 a[112:115], v24 offset:0
    ds_read_b128 a[116:119], v25 offset:0
    v_mfma_f32_32x32x16_bf16 a[32:47], a[120:123], v[68:71], a[32:47]
    buffer_load_dwordx4 v[36:39], v3, s[8:11], s18 offen offset:2048 sc1
    v_mfma_f32_32x32x16_bf16 a[48:63], a[124:127], v[68:71], a[48:63]
    s_waitcnt vmcnt(8)
    s_waitcnt lgkmcnt(0)
    v_mfma_f32_32x32x16_bf16 a[0:15], a[112:115], a[88:91], a[0:15]
    buffer_load_dwordx4 v[40:43], v3, s[8:11], s17 offen offset:3072 sc1
    v_mfma_f32_32x32x16_bf16 a[16:31], a[116:119], a[88:91], a[16:31]
    ds_read_b128 a[120:123], v24 offset:2048
    ds_read_b128 a[124:127], v25 offset:2048
    v_mfma_f32_32x32x16_bf16 a[32:47], a[112:115], a[92:95], a[32:47]
    buffer_load_dwordx4 v[44:47], v3, s[8:11], s18 offen offset:3072 sc1
    s_add_u32 s17, s17, 4096
    s_add_u32 s18, s18, 4096
    v_mfma_f32_32x32x16_bf16 a[48:63], a[116:119], a[92:95], a[48:63]
    s_waitcnt vmcnt(8)
    s_waitcnt lgkmcnt(0)
    v_mfma_f32_32x32x16_bf16 a[0:15], a[120:123], v[72:75], a[0:15]
    buffer_load_dwordx4 a[64:67], v3, s[8:11], s61 offen offset:2048 sc1
    v_mfma_f32_32x32x16_bf16 a[16:31], a[124:127], v[72:75], a[16:31]
    ds_read_b128 a[112:115], v24 offset:16384
    ds_read_b128 a[116:119], v25 offset:16384
    v_mfma_f32_32x32x16_bf16 a[32:47], a[120:123], v[76:79], a[32:47]
    buffer_load_dwordx4 a[68:71], v3, s[8:11], s62 offen offset:2048 sc1
    v_mfma_f32_32x32x16_bf16 a[48:63], a[124:127], v[76:79], a[48:63]
    s_waitcnt vmcnt(8)
    s_waitcnt lgkmcnt(0)
    v_mfma_f32_32x32x16_bf16 a[0:15], a[112:115], a[96:99], a[0:15]
    buffer_load_dwordx4 v[48:51], v3, s[8:11], s61 offen offset:3072 sc1
    v_mfma_f32_32x32x16_bf16 a[16:31], a[116:119], a[96:99], a[16:31]
    ds_read_b128 a[120:123], v24 offset:18432
    ds_read_b128 a[124:127], v25 offset:18432
    v_mfma_f32_32x32x16_bf16 a[32:47], a[112:115], a[100:103], a[32:47]
    buffer_load_dwordx4 v[52:55], v3, s[8:11], s62 offen offset:3072 sc1
    s_add_u32 s61, s61, 4096
    s_add_u32 s62, s62, 4096
    v_mfma_f32_32x32x16_bf16 a[48:63], a[116:119], a[100:103], a[48:63]
    s_waitcnt vmcnt(8)
    s_waitcnt lgkmcnt(0)
    v_mfma_f32_32x32x16_bf16 a[0:15], a[120:123], a[104:107], a[0:15]
    buffer_load_dwordx4 a[72:75], v3, s[8:11], s61 offen offset:0 sc1
    v_mfma_f32_32x32x16_bf16 a[16:31], a[124:127], a[104:107], a[16:31]
    ds_read_b128 a[112:115], v24 offset:32768
    ds_read_b128 a[116:119], v25 offset:32768
    v_mfma_f32_32x32x16_bf16 a[32:47], a[120:123], a[108:111], a[32:47]
    buffer_load_dwordx4 a[76:79], v3, s[8:11], s62 offen offset:0 sc1
    v_mfma_f32_32x32x16_bf16 a[48:63], a[124:127], a[108:111], a[48:63]
    s_waitcnt vmcnt(8)
    s_waitcnt lgkmcnt(0)
    v_mfma_f32_32x32x16_bf16 a[0:15], a[112:115], v[32:35], a[0:15]
    buffer_load_dwordx4 v[56:59], v3, s[8:11], s61 offen offset:1024 sc1
    v_mfma_f32_32x32x16_bf16 a[16:31], a[116:119], v[32:35], a[16:31]
    ds_read_b128 a[120:123], v24 offset:34816
    ds_read_b128 a[124:127], v25 offset:34816
    v_mfma_f32_32x32x16_bf16 a[32:47], a[112:115], v[36:39], a[32:47]
    buffer_load_dwordx4 v[60:63], v3, s[8:11], s62 offen offset:1024 sc1
    v_mfma_f32_32x32x16_bf16 a[48:63], a[116:119], v[36:39], a[48:63]
    s_waitcnt vmcnt(8)
    s_waitcnt lgkmcnt(0)
    v_mfma_f32_32x32x16_bf16 a[0:15], a[120:123], v[40:43], a[0:15]
    buffer_load_dwordx4 a[80:83], v3, s[8:11], s61 offen offset:2048 sc1
    v_mfma_f32_32x32x16_bf16 a[16:31], a[124:127], v[40:43], a[16:31]
    v_mfma_f32_32x32x16_bf16 a[32:47], a[120:123], v[44:47], a[32:47]
    buffer_load_dwordx4 a[84:87], v3, s[8:11], s62 offen offset:2048 sc1
    v_mfma_f32_32x32x16_bf16 a[48:63], a[124:127], v[44:47], a[48:63]
    s_waitcnt vmcnt(8)
    v_mfma_f32_32x32x16_bf16 a[0:15], v[80:83], a[64:67], a[0:15]
    buffer_load_dwordx4 v[64:67], v3, s[8:11], s61 offen offset:3072 sc1
    v_mfma_f32_32x32x16_bf16 a[16:31], v[84:87], a[64:67], a[16:31]
    v_mfma_f32_32x32x16_bf16 a[32:47], v[80:83], a[68:71], a[32:47]
    buffer_load_dwordx4 v[68:71], v3, s[8:11], s62 offen offset:3072 sc1
    s_add_u32 s61, s61, 4096
    s_add_u32 s62, s62, 4096
    v_mfma_f32_32x32x16_bf16 a[48:63], v[84:87], a[68:71], a[48:63]
    s_barrier
    s_waitcnt vmcnt(8)
    v_mfma_f32_32x32x16_bf16 a[0:15], v[88:91], v[48:51], a[0:15]
    v_mfma_f32_32x32x16_bf16 a[16:31], v[92:95], v[48:51], a[16:31]
    v_mfma_f32_32x32x16_bf16 a[32:47], v[88:91], v[52:55], a[32:47]
    v_mfma_f32_32x32x16_bf16 a[48:63], v[92:95], v[52:55], a[48:63]
    s_waitcnt vmcnt(6)
    v_mfma_f32_32x32x16_bf16 a[0:15], v[96:99], a[72:75], a[0:15]
    v_mfma_f32_32x32x16_bf16 a[16:31], v[100:103], a[72:75], a[16:31]
    v_mfma_f32_32x32x16_bf16 a[32:47], v[96:99], a[76:79], a[32:47]
    v_mfma_f32_32x32x16_bf16 a[48:63], v[100:103], a[76:79], a[48:63]
    s_waitcnt vmcnt(4)
    v_mfma_f32_32x32x16_bf16 a[0:15], v[104:107], v[56:59], a[0:15]
    v_mfma_f32_32x32x16_bf16 a[16:31], v[108:111], v[56:59], a[16:31]
    v_mfma_f32_32x32x16_bf16 a[32:47], v[104:107], v[60:63], a[32:47]
    v_mfma_f32_32x32x16_bf16 a[48:63], v[108:111], v[60:63], a[48:63]
    s_waitcnt vmcnt(2)
    v_mfma_f32_32x32x16_bf16 a[0:15], v[112:115], a[80:83], a[0:15]
    v_mfma_f32_32x32x16_bf16 a[16:31], v[116:119], a[80:83], a[16:31]
    v_mfma_f32_32x32x16_bf16 a[32:47], v[112:115], a[84:87], a[32:47]
    v_mfma_f32_32x32x16_bf16 a[48:63], v[116:119], a[84:87], a[48:63]
    s_waitcnt vmcnt(0)
    v_mfma_f32_32x32x16_bf16 a[0:15], v[120:123], v[64:67], a[0:15]
    v_mfma_f32_32x32x16_bf16 a[16:31], v[124:127], v[64:67], a[16:31]
    v_mfma_f32_32x32x16_bf16 a[32:47], v[120:123], v[68:71], a[32:47]
    v_mfma_f32_32x32x16_bf16 a[48:63], v[124:127], v[68:71], a[48:63]
    s_mul_i32 s20, s4, 12288
    s_add_u32 s20, s20, 114688
    v_add_u32 v4, s20, v3
    s_nop 6
    ds_write_b128 v4, a[16:19] offset:0
    ds_write_b128 v4, a[20:23] offset:1024
    ds_write_b128 v4, a[24:27] offset:2048
    ds_write_b128 v4, a[28:31] offset:3072
    ds_write_b128 v4, a[32:35] offset:4096
    ds_write_b128 v4, a[36:39] offset:5120
    ds_write_b128 v4, a[40:43] offset:6144
    ds_write_b128 v4, a[44:47] offset:7168
    ds_write_b128 v4, a[48:51] offset:8192
    ds_write_b128 v4, a[52:55] offset:9216
    ds_write_b128 v4, a[56:59] offset:10240
    ds_write_b128 v4, a[60:63] offset:11264
    s_xor_b32 s20, s4, 1
    s_mul_i32 s20, s20, 12288
    s_add_u32 s20, s20, 114688
    v_add_u32 v5, s20, v3
    s_xor_b32 s20, s4, 2
    s_mul_i32 s20, s20, 12288
    s_add_u32 s20, s20, 118784
    v_add_u32 v6, s20, v3
    s_xor_b32 s20, s4, 3
    s_mul_i32 s20, s20, 12288
    s_add_u32 s20, s20, 122880
    v_add_u32 v7, s20, v3
    v_accvgpr_read_b32 v32, a0
    v_accvgpr_read_b32 v33, a1
    v_accvgpr_read_b32 v34, a2
    v_accvgpr_read_b32 v35, a3
    v_accvgpr_read_b32 v36, a4
    v_accvgpr_read_b32 v37, a5
    v_accvgpr_read_b32 v38, a6
    v_accvgpr_read_b32 v39, a7
    v_accvgpr_read_b32 v40, a8
    v_accvgpr_read_b32 v41, a9
    v_accvgpr_read_b32 v42, a10
    v_accvgpr_read_b32 v43, a11
    v_accvgpr_read_b32 v44, a12
    v_accvgpr_read_b32 v45, a13
    v_accvgpr_read_b32 v46, a14
    v_accvgpr_read_b32 v47, a15
    v_lshlrev_b32 v8, 16, v16
    v_and_b32 v9, 0xffff0000, v16
    v_add_f32 v32, v32, v8
    v_add_f32 v33, v33, v9
    v_lshlrev_b32 v10, 16, v17
    v_and_b32 v11, 0xffff0000, v17
    v_add_f32 v34, v34, v10
    v_add_f32 v35, v35, v11
    v_lshlrev_b32 v8, 16, v18
    v_and_b32 v9, 0xffff0000, v18
    v_add_f32 v36, v36, v8
    v_add_f32 v37, v37, v9
    v_lshlrev_b32 v10, 16, v19
    v_and_b32 v11, 0xffff0000, v19
    v_add_f32 v38, v38, v10
    v_add_f32 v39, v39, v11
    v_lshlrev_b32 v8, 16, v20
    v_and_b32 v9, 0xffff0000, v20
    v_add_f32 v40, v40, v8
    v_add_f32 v41, v41, v9
    v_lshlrev_b32 v10, 16, v21
    v_and_b32 v11, 0xffff0000, v21
    v_add_f32 v42, v42, v10
    v_add_f32 v43, v43, v11
    v_lshlrev_b32 v8, 16, v22
    v_and_b32 v9, 0xffff0000, v22
    v_add_f32 v44, v44, v8
    v_add_f32 v45, v45, v9
    v_lshlrev_b32 v10, 16, v23
    v_and_b32 v11, 0xffff0000, v23
    v_add_f32 v46, v46, v10
    v_add_f32 v47, v47, v11
    s_waitcnt lgkmcnt(0)
    s_barrier
    ds_read_b128 v[64:67], v5 offset:0
    ds_read_b128 v[68:71], v5 offset:1024
    ds_read_b128 v[72:75], v5 offset:2048
    ds_read_b128 v[76:79], v5 offset:3072
    ds_read_b128 v[80:83], v6 offset:0
    ds_read_b128 v[84:87], v6 offset:1024
    ds_read_b128 v[88:91], v6 offset:2048
    ds_read_b128 v[92:95], v6 offset:3072
    ds_read_b128 v[96:99], v7 offset:0
    ds_read_b128 v[100:103], v7 offset:1024
    ds_read_b128 v[104:107], v7 offset:2048
    ds_read_b128 v[108:111], v7 offset:3072
    v_mov_b32 v8, 0
    v_mov_b32 v9, 0
    v_mov_b32 v12, 0x3f803f80
    s_waitcnt lgkmcnt(8)
    v_add_f32 v32, v32, v64
    v_add_f32 v33, v33, v65
    v_add_f32 v34, v34, v66
    v_add_f32 v35, v35, v67
    v_add_f32 v36, v36, v68
    v_add_f32 v37, v37, v69
    v_add_f32 v38, v38, v70
    v_add_f32 v39, v39, v71
    v_add_f32 v40, v40, v72
    v_add_f32 v41, v41, v73
    v_add_f32 v42, v42, v74
    v_add_f32 v43, v43, v75
    v_add_f32 v44, v44, v76
    v_add_f32 v45, v45, v77
    v_add_f32 v46, v46, v78
    v_add_f32 v47, v47, v79
    s_waitcnt lgkmcnt(4)
    v_add_f32 v32, v32, v80
    v_add_f32 v33, v33, v81
    v_add_f32 v34, v34, v82
    v_add_f32 v35, v35, v83
    v_add_f32 v36, v36, v84
    v_add_f32 v37, v37, v85
    v_add_f32 v38, v38, v86
    v_add_f32 v39, v39, v87
    v_add_f32 v40, v40, v88
    v_add_f32 v41, v41, v89
    v_add_f32 v42, v42, v90
    v_add_f32 v43, v43, v91
    v_add_f32 v44, v44, v92
    v_add_f32 v45, v45, v93
    v_add_f32 v46, v46, v94
    v_add_f32 v47, v47, v95
    s_waitcnt lgkmcnt(0)
    v_add_f32 v32, v32, v96
    v_add_f32 v33, v33, v97
    v_add_f32 v34, v34, v98
    v_add_f32 v35, v35, v99
    v_add_f32 v36, v36, v100
    v_add_f32 v37, v37, v101
    v_add_f32 v38, v38, v102
    v_add_f32 v39, v39, v103
    v_add_f32 v40, v40, v104
    v_add_f32 v41, v41, v105
    v_add_f32 v42, v42, v106
    v_add_f32 v43, v43, v107
    v_add_f32 v44, v44, v108
    v_add_f32 v45, v45, v109
    v_add_f32 v46, v46, v110
    v_add_f32 v47, v47, v111
    v_cvt_pk_bf16_f32 v16, v32, v33
    v_cvt_pk_bf16_f32 v17, v34, v35
    v_cvt_pk_bf16_f32 v18, v36, v37
    v_cvt_pk_bf16_f32 v19, v38, v39
    v_cvt_pk_bf16_f32 v20, v40, v41
    v_cvt_pk_bf16_f32 v21, v42, v43
    v_cvt_pk_bf16_f32 v22, v44, v45
    v_cvt_pk_bf16_f32 v23, v46, v47
    s_cmp_eq_u32 s43, 1
    s_cbranch_scc1 FK_final
    s_add_u32 s30, s30, 0x2000
    s_cmp_eq_u32 s56, 0
    s_cbranch_scc1 FK_ds13_f
    buffer_store_dwordx4 v[16:19], v3, s[8:11], s27 offen sc0 sc1
    buffer_store_dwordx4 v[20:23], v3, s[8:11], s27 offen offset:1024 sc0 sc1
    s_branch FK_ds13_d
FK_ds13_f:
    buffer_store_dwordx4 v[16:19], v3, s[8:11], s27 offen
    buffer_store_dwordx4 v[20:23], v3, s[8:11], s27 offen offset:1024
FK_ds13_d:
    v_dot2_f32_bf16 v8, v16, v12, v8
    v_dot2_f32_bf16 v9, v16, v16, v9
    v_dot2_f32_bf16 v8, v17, v12, v8
    v_dot2_f32_bf16 v9, v17, v17, v9
    v_dot2_f32_bf16 v8, v18, v12, v8
    v_dot2_f32_bf16 v9, v18, v18, v9
    v_dot2_f32_bf16 v8, v19, v12, v8
    v_dot2_f32_bf16 v9, v19, v19, v9
    v_dot2_f32_bf16 v8, v20, v12, v8
    v_dot2_f32_bf16 v9, v20, v20, v9
    v_dot2_f32_bf16 v8, v21, v12, v8
    v_dot2_f32_bf16 v9, v21, v21, v9
    v_dot2_f32_bf16 v8, v22, v12, v8
    v_dot2_f32_bf16 v9, v22, v22, v9
    v_dot2_f32_bf16 v8, v23, v12, v8
    v_dot2_f32_bf16 v9, v23, v23, v9
    s_nop 1
    v_mov_b32 v10, v8
    v_mov_b32 v11, v9
    s_nop 0
    v_permlane32_swap_b32 v8, v10
    v_permlane32_swap_b32 v9, v11
    v_add_f32 v8, v8, v10
    v_add_f32 v9, v9, v11
    s_mov_b64 exec, 0xffffffff
    s_cmp_eq_u32 s56, 0
    s_cbranch_scc1 FK_ds14_f
    buffer_store_dwordx2 v[8:9], v3, s[8:11], s29 offen sc0 sc1
    s_branch FK_ds14_d
FK_ds14_f:
    buffer_store_dwordx2 v[8:9], v3, s[8:11], s29 offen
FK_ds14_d:
    s_mov_b64 exec, -1
    v_mov_b32 v8, 0
    v_mov_b32 v9, 1
    s_waitcnt vmcnt(0)
    s_mov_b64 exec, 1
    s_cmp_eq_u32 s56, 0
    s_cbranch_scc1 FK_pb15_f
    buffer_store_byte v9, v8, s[8:11], s30 offen sc0 sc1
    s_branch FK_pb15_d
FK_pb15_f:
    buffer_store_byte v9, v8, s[8:11], s30 offen
FK_pb15_d:
    s_mov_b64 exec, -1
    s_mov_b32 s43, 1
    s_mov_b32 s44, 3
    s_mov_b32 s40, 18874368
    s_mov_b32 s41, 27328512
    s_lshl_b32 s14, s50, 15
    s_lshl_b32 s15, s51, 15
    s_lshl_b32 s16, s4, 13
    s_add_u32 s17, s14, s16
    s_add_u32 s17, s17, s49
    s_add_u32 s18, s15, s16
    s_add_u32 s18, s18, s49
    s_add_u32 s19, s16, s41
    s_lshl_b32 s26, s4, 9
    s_add_u32 s26, s26, s41
    s_add_u32 s26, s26, 32768
    s_lshl_b32 s21, s55, 16
    s_lshl_b32 s22, s4, 14
    s_add_u32 s21, s21, s22
    s_add_u32 s21, s21, 1638400
    s_lshl_b32 s22, s5, 10
    s_add_u32 s23, s21, s22
    s_mul_i32 s20, s4, 12288
    s_add_u32 s20, s20, 114688
    s_add_u32 s31, s20, s22
    v_add_u32 v24, s31, v3
    s_xor_b32 s22, s22, 1024
    s_add_u32 s24, s21, s22
    s_add_u32 s31, s20, s22
    v_add_u32 v25, s31, v3
    s_add_u32 s21, s21, 4096
    v_lshlrev_b32 v26, 3, v2
    v_and_b32 v27, 16, v2
    v_lshrrev_b32 v28, 5, v2
    v_lshlrev_b32 v28, 3, v28
    v_add_u32 v28, v28, v27
    v_cmp_eq_u32 s[62:63], 0, v27
    s_setprio 0
    s_barrier
    s_barrier
    buffer_load_dwordx4 v[112:115], v3, s[8:11], s23 offen offset:0
    buffer_load_dwordx4 v[116:119], v3, s[8:11], s24 offen offset:0
    buffer_load_dwordx4 v[120:123], v3, s[8:11], s23 offen offset:2048
    buffer_load_dwordx4 v[124:127], v3, s[8:11], s24 offen offset:2048
    s_mov_b32 m0, s20
    s_nop 0
    buffer_load_dwordx4 v3, s[8:11], s21 offen offset:0 lds
    buffer_load_dwordx4 v3, s[8:11], s21 offen offset:1024 lds
    buffer_load_dwordx4 v3, s[8:11], s21 offen offset:2048 lds
    buffer_load_dwordx4 v3, s[8:11], s21 offen offset:3072 lds
    s_add_u32 s20, s20, 4096
    s_add_u32 s21, s21, 4096
    s_mov_b32 m0, s20
    s_nop 0
    buffer_load_dwordx4 v3, s[8:11], s21 offen offset:0 lds
    buffer_load_dwordx4 v3, s[8:11], s21 offen offset:1024 lds
    buffer_load_dwordx4 v3, s[8:11], s21 offen offset:2048 lds
    buffer_load_dwordx4 v3, s[8:11], s21 offen offset:3072 lds
    s_add_u32 s20, s20, 4096
    s_add_u32 s21, s21, 4096
    s_mov_b32 m0, s20
    s_nop 0
    buffer_load_dwordx4 v3, s[8:11], s21 offen offset:0 lds
    buffer_load_dwordx4 v3, s[8:11], s21 offen offset:1024 lds
    buffer_load_dwordx4 v3, s[8:11], s21 offen offset:2048 lds
    buffer_load_dwordx4 v3, s[8:11], s21 offen offset:3072 lds
    s_add_u32 s20, s20, 4096
    s_add_u32 s21, s21, 4096
    s_barrier
    s_setprio 3
    s_lshl_b32 s31, s54, 5
    s_lshl_b32 s22, s4, 3
    s_add_u32 s31, s31, s22
    s_add_u32 s31, s31, s48
    s_add_u32 s31, s31, 0x2800
    s_or_b32 s22, s53, s4
    s_cmp_lg_u32 s22, 0
    s_cbranch_scc1 FK_nolead
    s_add_u32 s22, s48, 0x2840
    v_lshlrev_b32 v12, 2, v2
    s_mov_b32 s59, 0
    s_mov_b64 exec, 0xffff
FK_lead:
    buffer_load_dword v8, v12, s[8:11], s22 offen sc1
    s_waitcnt vmcnt(0)
    s_add_u32 s59, s59, 1
    s_cmp_gt_u32 s59, 0x40000
    s_cbranch_scc1 FK_lead_out
    v_cmp_ne_u32 vcc, 0x01010101, v8
    s_cbranch_vccnz FK_lead
FK_lead_out:
    s_lshl_b32 s22, s52, 7
    s_add_u32 s22, s22, 27408384
    v_mov_b32 v8, 0
    v_mov_b32 v9, 1
    s_mov_b64 exec, 1
    buffer_store_dword v9, v8, s[8:11], s22 offen sc0 sc1
    s_mov_b64 exec, -1
FK_nolead:
    s_barrier
    v_mov_b32 v12, 0
    s_mov_b32 s59, 0
    s_mov_b64 exec, 1
FK_pl16:
    buffer_load_dwordx2 v[8:9], v12, s[8:11], s31 offen sc1
    s_waitcnt vmcnt(0)
    v_and_b32 v8, v8, v9
    s_nop 0
    v_readfirstlane_b32 s58, v8
    s_add_u32 s59, s59, 1
    s_cmp_gt_u32 s59, 0x40000
    s_cbranch_scc1 FK_pl16_out
    s_cmp_lg_u32 s58, 0x01010101
    s_cbranch_scc1 FK_pl16
FK_pl16_out:
    s_mov_b64 exec, -1
    buffer_load_dwordx4 a[64:67], v3, s[8:11], s17 offen offset:0 sc1
    buffer_load_dwordx4 a[68:71], v3, s[8:11], s18 offen offset:0 sc1
    buffer_load_dwordx4 a[72:75], v3, s[8:11], s17 offen offset:1024 sc1
    buffer_load_dwordx4 a[76:79], v3, s[8:11], s18 offen offset:1024 sc1
    buffer_load_dwordx4 a[80:83], v3, s[8:11], s17 offen offset:2048 sc1
    buffer_load_dwordx4 a[84:87], v3, s[8:11], s18 offen offset:2048 sc1
    buffer_load_dwordx4 a[88:91], v3, s[8:11], s17 offen offset:3072 sc1
    s_add_u32 s17, s17, 4096
    buffer_load_dwordx4 a[92:95], v3, s[8:11], s18 offen offset:3072 sc1
    s_add_u32 s18, s18, 4096
    buffer_load_dwordx4 a[96:99], v3, s[8:11], s17 offen offset:0 sc1
    buffer_load_dwordx4 a[100:103], v3, s[8:11], s18 offen offset:0 sc1
    buffer_load_dwordx4 a[104:107], v3, s[8:11], s17 offen offset:1024 sc1
    buffer_load_dwordx4 a[108:111], v3, s[8:11], s18 offen offset:1024 sc1
    buffer_load_dwordx4 a[112:115], v3, s[8:11], s17 offen offset:2048 sc1
    buffer_load_dwordx4 a[116:119], v3, s[8:11], s18 offen offset:2048 sc1
    buffer_load_dwordx4 a[120:123], v3, s[8:11], s17 offen offset:3072 sc1
    buffer_load_dwordx4 a[124:127], v3, s[8:11], s18 offen offset:3072 sc1
    s_add_u32 s31, s48, 28672
    s_or_b32 s22, s53, s4
    s_cmp_lg_u32 s22, 0
    s_cbranch_scc1 FK_nolead2
    s_mov_b32 s22, 27408384
    v_lshlrev_b32 v12, 7, v2
    s_mov_b32 s59, 0
    s_mov_b64 exec, 0xffff
FK_lead2:
    buffer_load_dword v8, v12, s[8:11], s22 offen sc1
    s_waitcnt vmcnt(0)
    s_add_u32 s59, s59, 1
    s_cmp_gt_u32 s59, 0x40000
    s_cbranch_scc1 FK_lead2_out
    v_cmp_ne_u32 vcc, 1, v8
    s_cbranch_vccnz FK_lead2
FK_lead2_out:
    v_mov_b32 v8, 0
    v_mov_b32 v10, 0x01010101
    v_mov_b32 v11, 0x01010101
    s_mov_b64 exec, 1
    s_cmp_eq_u32 s56, 0
    s_cbranch_scc1 FK_lead2_f
    buffer_store_dwordx2 v[10:11], v8, s[8:11], s31 offen sc0 sc1
    s_branch FK_lead2_d
FK_lead2_f:
    buffer_store_dwordx2 v[10:11], v8, s[8:11], s31 offen
FK_lead2_d:
    s_mov_b64 exec, -1
FK_nolead2:
    s_add_u32 s48, s48, 16384
    v_mov_b32 v12, 0
    s_mov_b32 s59, 0
    s_mov_b64 exec, 1
FK_pl17:
    buffer_load_dwordx2 v[8:9], v12, s[8:11], s31 offen sc1
    s_waitcnt vmcnt(0)
    v_and_b32 v8, v8, v9
    s_nop 0
    v_readfirstlane_b32 s58, v8
    s_add_u32 s59, s59, 1
    s_cmp_gt_u32 s59, 0x40000
    s_cbranch_scc1 FK_pl17_out
    s_cmp_lg_u32 s58, 0x01010101
    s_cbranch_scc1 FK_pl17
FK_pl17_out:
    s_mov_b64 exec, -1
    buffer_load_dwordx2 v[30:31], v26, s[8:11], s26 offen sc1
    buffer_load_dwordx4 v[64:67], v3, s[8:11], s19 offen offset:0 sc1
    buffer_load_dwordx4 v[68:71], v3, s[8:11], s19 offen offset:1024 sc1
    buffer_load_dwordx4 v[72:75], v3, s[8:11], s19 offen offset:2048 sc1
    buffer_load_dwordx4 v[76:79], v3, s[8:11], s19 offen offset:3072 sc1
    s_add_u32 s19, s19, 4096
    buffer_load_dwordx4 v[80:83], v3, s[8:11], s19 offen offset:0 sc1
    buffer_load_dwordx4 v[84:87], v3, s[8:11], s19 offen offset:1024 sc1
    buffer_load_dwordx4 v[88:91], v3, s[8:11], s19 offen offset:2048 sc1
    buffer_load_dwordx4 v[92:95], v3, s[8:11], s19 offen offset:3072 sc1
    v_lshlrev_b32 v5, 5, v2
    buffer_load_dword v6, v5, s[8:11], s27 offen
    buffer_load_dword v6, v26, s[8:11], s29 offen
    s_barrier
    s_and_b32 s30, s50, 3
    s_lshl_b32 s30, s30, 4
    s_lshl_b32 s31, s55, 1
    s_add_u32 s30, s30, s31
    s_add_u32 s30, s30, s5
    s_add_u32 s30, s30, s48
    s_waitcnt vmcnt(8)
    v_cvt_pk_bf16_f32 v31, v30, v31
    v_cvt_pk_bf16_f32 v64, v64, v65
    v_cvt_pk_bf16_f32 v65, v66, v67
    v_cvt_pk_bf16_f32 v66, v68, v69
    v_cvt_pk_bf16_f32 v67, v70, v71
    ds_bpermute_b32 v68, v28, v31 offset:0
    ds_bpermute_b32 v69, v28, v31 offset:4
    ds_bpermute_b32 v70, v28, v31 offset:32
    ds_bpermute_b32 v71, v28, v31 offset:36
    s_waitcnt lgkmcnt(0)
    v_cndmask_b32 v104, v68, v64, s[62:63]
    v_cndmask_b32 v105, v69, v65, s[62:63]
    v_cndmask_b32 v106, v70, v66, s[62:63]
    v_cndmask_b32 v107, v71, v67, s[62:63]
    s_nop 1
    v_mfma_f32_32x32x16_bf16 v[32:47], v[104:107], a[64:67], 0
    v_cndmask_b32 v108, v64, v68, s[62:63]
    v_cndmask_b32 v109, v65, v69, s[62:63]
    v_cndmask_b32 v110, v66, v70, s[62:63]
    v_cndmask_b32 v111, v67, v71, s[62:63]
    v_mfma_f32_32x32x16_bf16 v[48:63], v[104:107], a[68:71], 0
    s_nop 6
    v_add_f32 v40, 0x358637bd, v40
    v_rcp_f32 v40, v40
    s_nop 0
    v_mul_f32 v32, v32, v40
    v_mul_f32 v33, v33, v40
    v_mul_f32 v34, v34, v40
    v_mul_f32 v35, v35, v40
    v_mul_f32 v36, v36, v40
    v_mul_f32 v37, v37, v40
    v_mul_f32 v38, v38, v40
    v_mul_f32 v39, v39, v40
    v_cvt_pk_bf16_f32 v96, v32, v33
    v_cvt_pk_bf16_f32 v97, v34, v35
    v_cvt_pk_bf16_f32 v98, v36, v37
    v_cvt_pk_bf16_f32 v99, v38, v39
    s_waitcnt vmcnt(6)
    v_cvt_pk_bf16_f32 v72, v72, v73
    v_cvt_pk_bf16_f32 v73, v74, v75
    v_cvt_pk_bf16_f32 v74, v76, v77
    v_cvt_pk_bf16_f32 v75, v78, v79
    ds_bpermute_b32 v76, v28, v31 offset:64
    ds_bpermute_b32 v77, v28, v31 offset:68
    ds_bpermute_b32 v78, v28, v31 offset:96
    ds_bpermute_b32 v79, v28, v31 offset:100
    v_mfma_f32_32x32x16_bf16 v[32:47], v[108:111], a[72:75], 0
    v_add_f32 v56, 0x358637bd, v56
    v_rcp_f32 v56, v56
    s_nop 0
    v_mul_f32 v48, v48, v56
    v_mul_f32 v49, v49, v56
    v_mul_f32 v50, v50, v56
    v_mul_f32 v51, v51, v56
    v_mul_f32 v52, v52, v56
    v_mfma_f32_32x32x16_bf16 a[0:15], v[112:115], v[96:99], 0
    v_mul_f32 v53, v53, v56
    v_mul_f32 v54, v54, v56
    v_mul_f32 v55, v55, v56
    v_cvt_pk_bf16_f32 v100, v48, v49
    v_cvt_pk_bf16_f32 v101, v50, v51
    v_cvt_pk_bf16_f32 v102, v52, v53
    v_cvt_pk_bf16_f32 v103, v54, v55
    v_mfma_f32_32x32x16_bf16 a[16:31], v[116:119], v[96:99], 0
    s_waitcnt lgkmcnt(0)
    v_cndmask_b32 v104, v76, v72, s[62:63]
    v_cndmask_b32 v105, v77, v73, s[62:63]
    v_cndmask_b32 v106, v78, v74, s[62:63]
    v_cndmask_b32 v107, v79, v75, s[62:63]
    v_mfma_f32_32x32x16_bf16 v[48:63], v[108:111], a[76:79], 0
    v_add_f32 v32, 0x358637bd, v32
    v_rcp_f32 v32, v32
    s_nop 0
    v_mul_f32 v40, v40, v32
    v_mul_f32 v41, v41, v32
    v_mul_f32 v42, v42, v32
    v_mfma_f32_32x32x16_bf16 a[32:47], v[112:115], v[100:103], 0
    v_mul_f32 v43, v43, v32
    v_mul_f32 v44, v44, v32
    v_mul_f32 v45, v45, v32
    v_mul_f32 v46, v46, v32
    v_mul_f32 v47, v47, v32
    v_mfma_f32_32x32x16_bf16 a[48:63], v[116:119], v[100:103], 0
    v_cvt_pk_bf16_f32 v96, v40, v41
    v_cvt_pk_bf16_f32 v97, v42, v43
    v_cvt_pk_bf16_f32 v98, v44, v45
    v_cvt_pk_bf16_f32 v99, v46, v47
    ds_read_b128 v[112:115], v24 offset:0
    ds_read_b128 v[116:119], v25 offset:0
    v_mfma_f32_32x32x16_bf16 v[32:47], v[104:107], a[80:83], 0
    v_add_f32 v48, 0x358637bd, v48
    v_rcp_f32 v48, v48
    s_nop 0
    v_mul_f32 v56, v56, v48
    v_mul_f32 v57, v57, v48
    v_mul_f32 v58, v58, v48
    v_mul_f32 v59, v59, v48
    v_mul_f32 v60, v60, v48
    v_mfma_f32_32x32x16_bf16 a[0:15], v[120:123], v[96:99], a[0:15]
    v_mul_f32 v61, v61, v48
    v_mul_f32 v62, v62, v48
    v_mul_f32 v63, v63, v48
    v_cvt_pk_bf16_f32 v100, v56, v57
    v_cvt_pk_bf16_f32 v101, v58, v59
    v_cvt_pk_bf16_f32 v102, v60, v61
    v_cvt_pk_bf16_f32 v103, v62, v63
    v_mfma_f32_32x32x16_bf16 a[16:31], v[124:127], v[96:99], a[16:31]
    v_cndmask_b32 v108, v72, v76, s[62:63]
    v_cndmask_b32 v109, v73, v77, s[62:63]
    v_cndmask_b32 v110, v74, v78, s[62:63]
    v_cndmask_b32 v111, v75, v79, s[62:63]
    v_mfma_f32_32x32x16_bf16 v[48:63], v[104:107], a[84:87], 0
    v_add_f32 v40, 0x358637bd, v40
    v_rcp_f32 v40, v40
    s_nop 0
    v_mul_f32 v32, v32, v40
    v_mul_f32 v33, v33, v40
    v_mul_f32 v34, v34, v40
    v_mul_f32 v35, v35, v40
    v_mul_f32 v36, v36, v40
    v_mul_f32 v37, v37, v40
    v_mfma_f32_32x32x16_bf16 a[32:47], v[120:123], v[100:103], a[32:47]
    v_mul_f32 v38, v38, v40
    v_mul_f32 v39, v39, v40
    v_cvt_pk_bf16_f32 v96, v32, v33
    v_cvt_pk_bf16_f32 v97, v34, v35
    v_cvt_pk_bf16_f32 v98, v36, v37
    v_cvt_pk_bf16_f32 v99, v38, v39
    s_waitcnt vmcnt(4)
    v_cvt_pk_bf16_f32 v80, v80, v81
    v_mfma_f32_32x32x16_bf16 a[48:63], v[124:127], v[100:103], a[48:63]
    v_cvt_pk_bf16_f32 v81, v82, v83
    v_cvt_pk_bf16_f32 v82, v84, v85
    v_cvt_pk_bf16_f32 v83, v86, v87
    ds_bpermute_b32 v84, v28, v31 offset:128
    ds_bpermute_b32 v85, v28, v31 offset:132
    ds_bpermute_b32 v86, v28, v31 offset:160
    ds_bpermute_b32 v87, v28, v31 offset:164
    ds_read_b128 v[120:123], v24 offset:2048
    ds_read_b128 v[124:127], v25 offset:2048
    v_mfma_f32_32x32x16_bf16 v[32:47], v[108:111], a[88:91], 0
    v_add_f32 v56, 0x358637bd, v56
    v_rcp_f32 v56, v56
    s_nop 0
    v_mul_f32 v48, v48, v56
    v_mul_f32 v49, v49, v56
    v_mul_f32 v50, v50, v56
    v_mul_f32 v51, v51, v56
    v_mul_f32 v52, v52, v56
    s_waitcnt lgkmcnt(6)
    v_mfma_f32_32x32x16_bf16 a[0:15], v[112:115], v[96:99], a[0:15]
    v_mul_f32 v53, v53, v56
    v_mul_f32 v54, v54, v56
    v_mul_f32 v55, v55, v56
    v_cvt_pk_bf16_f32 v100, v48, v49
    v_cvt_pk_bf16_f32 v101, v50, v51
    v_cvt_pk_bf16_f32 v102, v52, v53
    v_cvt_pk_bf16_f32 v103, v54, v55
    v_mfma_f32_32x32x16_bf16 a[16:31], v[116:119], v[96:99], a[16:31]
    s_waitcnt lgkmcnt(2)
    v_cndmask_b32 v104, v84, v80, s[62:63]
    v_cndmask_b32 v105, v85, v81, s[62:63]
    v_cndmask_b32 v106, v86, v82, s[62:63]
    v_cndmask_b32 v107, v87, v83, s[62:63]
    v_mfma_f32_32x32x16_bf16 v[48:63], v[108:111], a[92:95], 0
    v_add_f32 v32, 0x358637bd, v32
    v_rcp_f32 v32, v32
    s_nop 0
    v_mul_f32 v40, v40, v32
    v_mul_f32 v41, v41, v32
    v_mul_f32 v42, v42, v32
    v_mfma_f32_32x32x16_bf16 a[32:47], v[112:115], v[100:103], a[32:47]
    v_mul_f32 v43, v43, v32
    v_mul_f32 v44, v44, v32
    v_mul_f32 v45, v45, v32
    v_mul_f32 v46, v46, v32
    v_mul_f32 v47, v47, v32
    v_mfma_f32_32x32x16_bf16 a[48:63], v[116:119], v[100:103], a[48:63]
    v_cvt_pk_bf16_f32 v96, v40, v41
    v_cvt_pk_bf16_f32 v97, v42, v43
    v_cvt_pk_bf16_f32 v98, v44, v45
    v_cvt_pk_bf16_f32 v99, v46, v47
    ds_read_b128 v[112:115], v24 offset:4096
    ds_read_b128 v[116:119], v25 offset:4096
    v_mfma_f32_32x32x16_bf16 v[32:47], v[104:107], a[96:99], 0
    v_add_f32 v48, 0x358637bd, v48
    v_rcp_f32 v48, v48
    s_nop 0
    v_mul_f32 v56, v56, v48
    v_mul_f32 v57, v57, v48
    v_mul_f32 v58, v58, v48
    v_mul_f32 v59, v59, v48
    v_mul_f32 v60, v60, v48
    s_waitcnt lgkmcnt(2)
    v_mfma_f32_32x32x16_bf16 a[0:15], v[120:123], v[96:99], a[0:15]
    v_mul_f32 v61, v61, v48
    v_mul_f32 v62, v62, v48
    v_mul_f32 v63, v63, v48
    v_cvt_pk_bf16_f32 v100, v56, v57
    v_cvt_pk_bf16_f32 v101, v58, v59
    v_cvt_pk_bf16_f32 v102, v60, v61
    v_cvt_pk_bf16_f32 v103, v62, v63
    v_mfma_f32_32x32x16_bf16 a[16:31], v[124:127], v[96:99], a[16:31]
    v_cndmask_b32 v108, v80, v84, s[62:63]
    v_cndmask_b32 v109, v81, v85, s[62:63]
    v_cndmask_b32 v110, v82, v86, s[62:63]
    v_cndmask_b32 v111, v83, v87, s[62:63]
    v_mfma_f32_32x32x16_bf16 v[48:63], v[104:107], a[100:103], 0
    v_add_f32 v40, 0x358637bd, v40
    v_rcp_f32 v40, v40
    s_nop 0
    v_mul_f32 v32, v32, v40
    v_mul_f32 v33, v33, v40
    v_mul_f32 v34, v34, v40
    v_mul_f32 v35, v35, v40
    v_mul_f32 v36, v36, v40
    v_mul_f32 v37, v37, v40
    v_mfma_f32_32x32x16_bf16 a[32:47], v[120:123], v[100:103], a[32:47]
    v_mul_f32 v38, v38, v40
    v_mul_f32 v39, v39, v40
    v_cvt_pk_bf16_f32 v96, v32, v33
    v_cvt_pk_bf16_f32 v97, v34, v35
    v_cvt_pk_bf16_f32 v98, v36, v37
    v_cvt_pk_bf16_f32 v99, v38, v39
    s_waitcnt vmcnt(2)
    v_cvt_pk_bf16_f32 v88, v88, v89
    v_mfma_f32_32x32x16_bf16 a[48:63], v[124:127], v[100:103], a[48:63]
    v_cvt_pk_bf16_f32 v89, v90, v91
    v_cvt_pk_bf16_f32 v90, v92, v93
    v_cvt_pk_bf16_f32 v91, v94, v95
    ds_bpermute_b32 v92, v28, v31 offset:192
    ds_bpermute_b32 v93, v28, v31 offset:196
    ds_bpermute_b32 v94, v28, v31 offset:224
    ds_bpermute_b32 v95, v28, v31 offset:228
    ds_read_b128 v[120:123], v24 offset:6144
    ds_read_b128 v[124:127], v25 offset:6144
    v_mfma_f32_32x32x16_bf16 v[32:47], v[108:111], a[104:107], 0
    v_add_f32 v56, 0x358637bd, v56
    v_rcp_f32 v56, v56
    s_nop 0
    v_mul_f32 v48, v48, v56
    v_mul_f32 v49, v49, v56
    v_mul_f32 v50, v50, v56
    v_mul_f32 v51, v51, v56
    v_mul_f32 v52, v52, v56
    s_waitcnt lgkmcnt(6)
    v_mfma_f32_32x32x16_bf16 a[0:15], v[112:115], v[96:99], a[0:15]
    v_mul_f32 v53, v53, v56
    v_mul_f32 v54, v54, v56
    v_mul_f32 v55, v55, v56
    v_cvt_pk_bf16_f32 v100, v48, v49
    v_cvt_pk_bf16_f32 v101, v50, v51
    v_cvt_pk_bf16_f32 v102, v52, v53
    v_cvt_pk_bf16_f32 v103, v54, v55
    v_mfma_f32_32x32x16_bf16 a[16:31], v[116:119], v[96:99], a[16:31]
    s_waitcnt lgkmcnt(2)
    v_cndmask_b32 v104, v92, v88, s[62:63]
    v_cndmask_b32 v105, v93, v89, s[62:63]
    v_cndmask_b32 v106, v94, v90, s[62:63]
    v_cndmask_b32 v107, v95, v91, s[62:63]
    v_mfma_f32_32x32x16_bf16 v[48:63], v[108:111], a[108:111], 0
    v_add_f32 v32, 0x358637bd, v32
    v_rcp_f32 v32, v32
    s_nop 0
    v_mul_f32 v40, v40, v32
    v_mul_f32 v41, v41, v32
    v_mul_f32 v42, v42, v32
    v_mfma_f32_32x32x16_bf16 a[32:47], v[112:115], v[100:103], a[32:47]
    v_mul_f32 v43, v43, v32
    v_mul_f32 v44, v44, v32
    v_mul_f32 v45, v45, v32
    v_mul_f32 v46, v46, v32
    v_mul_f32 v47, v47, v32
    v_mfma_f32_32x32x16_bf16 a[48:63], v[116:119], v[100:103], a[48:63]
    v_cvt_pk_bf16_f32 v96, v40, v41
    v_cvt_pk_bf16_f32 v97, v42, v43
    v_cvt_pk_bf16_f32 v98, v44, v45
    v_cvt_pk_bf16_f32 v99, v46, v47
    ds_read_b128 v[112:115], v24 offset:8192
    ds_read_b128 v[116:119], v25 offset:8192
    v_mfma_f32_32x32x16_bf16 v[32:47], v[104:107], a[112:115], 0
    v_add_f32 v48, 0x358637bd, v48
    v_rcp_f32 v48, v48
    s_nop 0
    v_mul_f32 v56, v56, v48
    v_mul_f32 v57, v57, v48
    v_mul_f32 v58, v58, v48
    v_mul_f32 v59, v59, v48
    v_mul_f32 v60, v60, v48
    s_waitcnt lgkmcnt(2)
    v_mfma_f32_32x32x16_bf16 a[0:15], v[120:123], v[96:99], a[0:15]
    v_mul_f32 v61, v61, v48
    v_mul_f32 v62, v62, v48
    v_mul_f32 v63, v63, v48
    v_cvt_pk_bf16_f32 v100, v56, v57
    v_cvt_pk_bf16_f32 v101, v58, v59
    v_cvt_pk_bf16_f32 v102, v60, v61
    v_cvt_pk_bf16_f32 v103, v62, v63
    v_mfma_f32_32x32x16_bf16 a[16:31], v[124:127], v[96:99], a[16:31]
    v_cndmask_b32 v108, v88, v92, s[62:63]
    v_cndmask_b32 v109, v89, v93, s[62:63]
    v_cndmask_b32 v110, v90, v94, s[62:63]
    v_cndmask_b32 v111, v91, v95, s[62:63]
    v_mfma_f32_32x32x16_bf16 v[48:63], v[104:107], a[116:119], 0
    v_add_f32 v40, 0x358637bd, v40
    v_rcp_f32 v40, v40
    s_nop 0
    v_mul_f32 v32, v32, v40
    v_mul_f32 v33, v33, v40
    v_mul_f32 v34, v34, v40
    v_mfma_f32_32x32x16_bf16 a[32:47], v[120:123], v[100:103], a[32:47]
    v_mul_f32 v35, v35, v40
    v_mul_f32 v36, v36, v40
    v_mul_f32 v37, v37, v40
    v_mul_f32 v38, v38, v40
    v_mul_f32 v39, v39, v40
    v_mfma_f32_32x32x16_bf16 a[48:63], v[124:127], v[100:103], a[48:63]
    v_cvt_pk_bf16_f32 v96, v32, v33
    v_cvt_pk_bf16_f32 v97, v34, v35
    v_cvt_pk_bf16_f32 v98, v36, v37
    v_cvt_pk_bf16_f32 v99, v38, v39
    ds_read_b128 v[120:123], v24 offset:10240
    ds_read_b128 v[124:127], v25 offset:10240
    v_mfma_f32_32x32x16_bf16 v[32:47], v[108:111], a[120:123], 0
    v_add_f32 v56, 0x358637bd, v56
    v_rcp_f32 v56, v56
    s_nop 0
    v_mul_f32 v48, v48, v56
    v_mul_f32 v49, v49, v56
    v_mul_f32 v50, v50, v56
    s_waitcnt lgkmcnt(2)
    v_mfma_f32_32x32x16_bf16 a[0:15], v[112:115], v[96:99], a[0:15]
    v_mul_f32 v51, v51, v56
    v_mul_f32 v52, v52, v56
    v_mul_f32 v53, v53, v56
    v_mul_f32 v54, v54, v56
    v_mul_f32 v55, v55, v56
    v_mfma_f32_32x32x16_bf16 a[16:31], v[116:119], v[96:99], a[16:31]
    v_cvt_pk_bf16_f32 v100, v48, v49
    v_cvt_pk_bf16_f32 v101, v50, v51
    v_cvt_pk_bf16_f32 v102, v52, v53
    v_cvt_pk_bf16_f32 v103, v54, v55
    v_mfma_f32_32x32x16_bf16 v[48:63], v[108:111], a[124:127], 0
    v_add_f32 v32, 0x358637bd, v32
    v_rcp_f32 v32, v32
    s_nop 0
    v_mul_f32 v40, v40, v32
    v_mul_f32 v41, v41, v32
    v_mul_f32 v42, v42, v32
    v_mfma_f32_32x32x16_bf16 a[32:47], v[112:115], v[100:103], a[32:47]
    v_mul_f32 v43, v43, v32
    v_mul_f32 v44, v44, v32
    v_mul_f32 v45, v45, v32
    v_mul_f32 v46, v46, v32
    v_mul_f32 v47, v47, v32
    v_mfma_f32_32x32x16_bf16 a[48:63], v[116:119], v[100:103], a[48:63]
    v_cvt_pk_bf16_f32 v96, v40, v41
    v_cvt_pk_bf16_f32 v97, v42, v43
    v_cvt_pk_bf16_f32 v98, v44, v45
    v_cvt_pk_bf16_f32 v99, v46, v47
    s_waitcnt lgkmcnt(0)
    s_nop 0
    v_mfma_f32_32x32x16_bf16 a[0:15], v[120:123], v[96:99], a[0:15]
    v_add_f32 v48, 0x358637bd, v48
    v_rcp_f32 v48, v48
    s_nop 0
    v_mul_f32 v56, v56, v48
    v_mul_f32 v57, v57, v48
    v_mul_f32 v58, v58, v48
    v_mul_f32 v59, v59, v48
    v_mul_f32 v60, v60, v48
    v_mfma_f32_32x32x16_bf16 a[16:31], v[124:127], v[96:99], a[16:31]
    v_mul_f32 v61, v61, v48
    v_mul_f32 v62, v62, v48
    v_mul_f32 v63, v63, v48
    v_cvt_pk_bf16_f32 v100, v56, v57
    v_cvt_pk_bf16_f32 v101, v58, v59
    v_cvt_pk_bf16_f32 v102, v60, v61
    v_cvt_pk_bf16_f32 v103, v62, v63
    s_nop 1
    v_mfma_f32_32x32x16_bf16 a[32:47], v[120:123], v[100:103], a[32:47]
    v_mfma_f32_32x32x16_bf16 a[48:63], v[124:127], v[100:103], a[48:63]
    s_waitcnt vmcnt(0) lgkmcnt(0)
    s_branch FK_Yc
FK_final:
    s_mov_b32 s36, s34
    s_mov_b32 s37, s35
    s_mov_b32 s38, 2097152
    s_mov_b32 s39, 0x20000
    v_permlane32_swap_b32 v16, v18
    v_permlane32_swap_b32 v17, v19
    v_permlane32_swap_b32 v20, v22
    v_permlane32_swap_b32 v21, v23
    v_and_b32 v4, 31, v2
    v_lshlrev_b32 v4, 10, v4
    v_lshrrev_b32 v5, 5, v2
    v_lshlrev_b32 v5, 4, v5
    v_add_u32 v4, v4, v5
    s_lshl_b32 s20, s55, 7
    s_lshl_b32 s21, s5, 6
    s_add_u32 s20, s20, s21
    s_lshl_b32 s21, s50, 15
    s_add_u32 s20, s20, s21
    buffer_store_dwordx4 v[16:19], v4, s[36:39], s20 offen
    buffer_store_dwordx4 v[20:23], v4, s[36:39], s20 offen offset:32
FK_done:
    s_endpgm
CODE_END:
    s_endpgm
.section .rodata,"a"
.p2align 6
.amdhsa_kernel f1_kernel
  .amdhsa_next_free_vgpr 256
  .amdhsa_next_free_sgpr 102
  .amdhsa_accum_offset 256
  .amdhsa_group_segment_fixed_size 0
  .amdhsa_kernarg_size 80
  .amdhsa_user_sgpr_count 2
  .amdhsa_user_sgpr_kernarg_segment_ptr 1
  .amdhsa_system_sgpr_workgroup_id_x 1
.end_amdhsa_kernel
.p2align 6
.amdhsa_kernel fk_kernel
  .amdhsa_next_free_vgpr 256
  .amdhsa_next_free_sgpr 102
  .amdhsa_accum_offset 128
  .amdhsa_group_segment_fixed_size 0
  .amdhsa_kernarg_size 80
  .amdhsa_user_sgpr_count 2
  .amdhsa_user_sgpr_kernarg_segment_ptr 1
  .amdhsa_system_sgpr_workgroup_id_x 1
.end_amdhsa_kernel
```
